```python
import torch

def _softmax(x, axis=-1):
    return torch.softmax(x, dim=axis)
def _gelu(x):
    return torch.nn.functional.gelu(x, approximate="tanh")
def _silu(x):
    return torch.nn.functional.silu(x)
def _sigmoid(x):
    return torch.sigmoid(x)
def _layernorm(x, axis=-1, eps=1e-5):
    m = x.mean(dim=axis, keepdim=True)
    v = x.var(dim=axis, keepdim=True, unbiased=False)
    return (x - m) / torch.sqrt(v + eps)
def _scatter_add(tgt, idx, src, axis=0):
    return tgt.clone().index_add_(axis, idx, src)
def _segment_sum(src, seg, n):
    out = torch.zeros((n,) + src.shape[1:], dtype=src.dtype)
    return out.index_add_(0, seg, src)
def _pad(x, pw):
    flat = tuple(v for pair in reversed(pw) for v in pair)
    return torch.nn.functional.pad(x, flat)

kernel_name = 'standalone__modern_conv_block_replknet__vision'

def setup_inputs():

    _w = (lambda a: (lambda t: t.to(torch.bfloat16) if t.is_floating_point() else t)(torch.as_tensor(a)))
    H = W = 224
    C = 192
    K = 3
    return {
        "x": _w((lambda *s: torch.randn(*s, dtype=torch.bfloat16) * 0.05)(1, H, W, C)),
        "dw_large": _w((lambda *s: torch.randn(*s, dtype=torch.bfloat16) * 0.4)(K, K, C) * (1.0 / K)),
        "dw_small": _w((lambda *s: torch.randn(*s, dtype=torch.bfloat16) * 0.4)(5, 5, C) * 0.2),
        "w1": _w((lambda *s: torch.randn(*s, dtype=torch.bfloat16) * 0.4)(C, 4 * C) * (C ** -0.5)),
        "w2": _w((lambda *s: torch.randn(*s, dtype=torch.bfloat16) * 0.1)(4 * C, C) * ((4 * C) ** -0.5)),
    }

def reference(x, dw_large, dw_small, w1, w2):
    B, H, W, C = x.shape
    Kl = dw_large.shape[0]
    pl = (Kl - 1) // 2
    xpl = _pad(x, ((0,0),(pl,pl),(pl,pl),(0,0)))
    out = torch.zeros_like(x)
    for i in range(Kl):
        for j in range(Kl):
            out = out + xpl[:, i:i+H, j:j+W, :] * dw_large[i, j][None, None, None, :]
    Ks = dw_small.shape[0]
    ps = (Ks - 1) // 2
    xps = _pad(x, ((0,0),(ps,ps),(ps,ps),(0,0)))
    for i in range(Ks):
        for j in range(Ks):
            out = out + xps[:, i:i+H, j:j+W, :] * dw_small[i, j][None, None, None, :]
    h = _layernorm(out, axis=-1)
    h = _gelu(torch.einsum('bhwc,ce->bhwe', h, w1))
    h = torch.einsum('bhwe,ec->bhwc', h, w2)
    return x + h
```

```asm
; @launch grid=(256,1,1) block=(512,1,1) lds=163840
.amdgcn_target "amdgcn-amd-amdhsa--gfx950"
.text
.globl standalone__modern_conv_block_replknet__vision_kernel
.p2align 8
.type standalone__modern_conv_block_replknet__vision_kernel,@function
standalone__modern_conv_block_replknet__vision_kernel:
    s_cmp_ge_u32 s2, 256
    s_cbranch_scc1 L_end
    s_load_dwordx8 s[4:11], s[0:1], 0
    s_load_dwordx4 s[12:15], s[0:1], 32
    s_getpc_b64 s[48:49]
L_pc:
    s_mov_b32 s50, L_code_end-L_pc
    s_mov_b32 s51, 0x20000
    s_bfe_u32 s26, s2, 0x20003
    s_mul_i32 s26, s26, 16384
    v_lshl_add_u32 v139, v0, 7, s26
    v_cmp_gt_u32 vcc, 128, v0
    v_mov_b32 v138, 0x80000000
    s_nop 0
    v_cndmask_b32 v139, v138, v139, vcc
    buffer_load_dword v90, v139, s[48:51], 0 offen
    v_lshrrev_b32 v10, 6, v0
    v_and_b32 v9, 63, v0
    s_lshr_b32 s27, s2, 3
    s_bfe_u32 s28, s2, 0x20001
    s_and_b32 s26, s2, 1
    s_cmp_lt_u32 s27, 28
    s_cbranch_scc0 L_extra
    s_mul_i32 s29, s28, 50
    s_lshr_b32 s28, s28, 1
    s_mul_i32 s28, s28, 12
    s_add_u32 s29, s29, s28
    s_mul_i32 s28, s26, 25
    s_add_u32 s29, s29, s28
    s_sub_u32 s28, 13, s26
    s_xor_b32 s23, s26, 1
    s_branch L_decoded
L_extra:
    s_add_u32 s29, s26, 31
    s_cmp_ge_u32 s27, s29
    s_cbranch_scc1 L_end
    s_mul_i32 s28, s28, 7
    s_mul_i32 s26, s26, 3
    s_add_u32 s27, s27, s28
    s_add_u32 s27, s27, s26
    s_sub_u32 s27, s27, 28
    s_mov_b32 s29, 99
    s_mov_b32 s28, 112
    s_mov_b32 s23, 0
L_decoded:
    s_cmp_ge_u32 s27, 14
    s_cselect_b32 s28, s28, 0
    s_cselect_b32 s26, 14, 0
    s_add_u32 s21, s29, s28
    s_sub_u32 s27, s27, s26
    s_lshl_b32 s22, s27, 4
    v_readfirstlane_b32 s20, v10
    v_mul_u32_u24 v145, 43, v9
    v_lshrrev_b32 v145, 7, v145
    v_mul_u32_u24 v146, 3, v145
    v_sub_u32 v146, v9, v146
    v_lshlrev_b32 v146, 4, v146
    s_mul_i32 s26, s20, 48
    v_mul_u32_u24 v10, 384, v145
    v_add3_u32 v10, v10, v146, s26
    v_mul_u32_u24 v147, 13, v145
    v_lshrrev_b32 v147, 6, v147
    v_mul_u32_u24 v148, 5, v147
    v_sub_u32 v148, v145, v148
    v_mov_b32 v3, 0x80000000
    v_subrev_u32 v4, 1, v147
    v_subrev_u32 v5, 1, v148
    v_max_u32 v6, v4, v5
    v_cmp_gt_u32 vcc, 3, v6
    v_mul_u32_u24 v4, 3, v4
    v_add_u32 v4, v4, v5
    v_mul_u32_u24 v11, 384, v4
    v_add3_u32 v11, v11, v146, s26
    s_bfe_u32 s24, s20, 0x10001
    s_and_b32 s25, s20, 1
    v_cndmask_b32 v11, v3, v11, vcc
    v_lshrrev_b32 v4, 4, v0
    v_mul_u32_u24 v5, 43, v4
    v_lshrrev_b32 v5, 7, v5
    v_mul_u32_u24 v6, 3, v5
    v_sub_u32 v4, v4, v6
    v_and_b32 v6, 7, v0
    v_lshl_add_u32 v4, v4, 3, v6
    v_bfe_u32 v6, v0, 3, 1
    v_lshl_add_u32 v5, v5, 1, v6
    s_sub_u32 s27, s22, 2
    v_add_u32 v6, s27, v5
    v_mul_u32_u24 v1, 384, v6
    v_lshl_add_u32 v1, v4, 4, v1
    v_cmp_gt_u32 vcc, 224, v6
    s_waitcnt lgkmcnt(0)
    s_nop 0
    v_cndmask_b32 v1, v3, v1, vcc
    v_cmp_gt_u32 vcc, 480, v0
    s_mov_b32 s56, s8
    s_mov_b32 s57, s9
    s_mov_b32 s58, 9600
    s_mov_b32 s59, 0x20000
    s_mov_b32 s52, s6
    s_mov_b32 s53, s7
    s_mov_b32 s54, 3456
    s_mov_b32 s55, 0x20000
    s_mov_b32 s32, s4
    s_mov_b32 s33, s5
    s_mov_b32 s34, 19267584
    s_mov_b32 s35, 0x20000
    v_cndmask_b32 v1, v3, v1, vcc
    s_mov_b32 s27, 8064
    buffer_load_dwordx4 v[108:111], v10, s[56:59], 0 offen
    buffer_load_dwordx4 v[116:119], v11, s[52:55], 0 offen
    buffer_load_dwordx4 v[112:115], v10, s[56:59], s27 offen
    s_sub_u32 s30, s21, 2
    s_mul_i32 s26, s30, 86016
    s_cmp_lt_u32 s30, 224
    s_cselect_b32 s26, s26, 0
    s_cselect_b32 s34, 19267584, 0
    s_cmp_eq_u32 s23, 1
    s_cselect_b32 s34, s34, 0
    buffer_load_dwordx4 v[36:39], v1, s[32:35], s26 offen
    s_add_u32 s30, s30, 1
    s_mul_i32 s26, s30, 86016
    s_cmp_lt_u32 s30, 224
    s_cselect_b32 s26, s26, 0
    s_cselect_b32 s34, 19267584, 0
    buffer_load_dwordx4 v[40:43], v1, s[32:35], s26 offen
    s_add_u32 s30, s30, 1
    s_mul_i32 s26, s30, 86016
    s_cmp_lt_u32 s30, 224
    s_cselect_b32 s26, s26, 0
    s_cselect_b32 s34, 19267584, 0
    buffer_load_dwordx4 v[44:47], v1, s[32:35], s26 offen
    s_add_u32 s30, s30, 1
    v_mul_u32_u24 v2, 1296, v4
    v_lshl_add_u32 v2, v5, 3, v2
    v_add_u32 v140, 125120, v2
    v_mov_b32 v3, 163840
    v_cndmask_b32 v2, v3, v2, vcc
    v_cndmask_b32 v140, v3, v140, vcc
    s_mul_i32 s27, s20, 3360
    s_add_u32 s27, s27, 93696
    v_mul_u32_u24 v147, 672, v147
    v_mul_u32_u24 v148, 112, v148
    v_lshl_add_u32 v147, v146, 1, v147
    v_add3_u32 v147, v147, v148, s27
    v_mul_u32_u24 v149, 112, v145
    v_lshl_add_u32 v149, v146, 1, v149
    v_add_u32 v149, s27, v149
    v_add_u32 v149, 2800, v149
    v_cmp_gt_u32 s[70:71], 4, v145
    v_mov_b32 v10, 163840
    v_mul_u32_u24 v150, 43, v9
    v_cndmask_b32 v149, v10, v149, s[70:71]
    v_lshrrev_b32 v150, 9, v150
    v_mul_u32_u24 v150, 576, v150
    v_lshl_add_u32 v150, v9, 3, v150
    v_add_u32 v150, s27, v150
    v_mov_b32 v10, 0
    v_mov_b32 v11, 0
    ds_write_b64 v150, v[10:11] offset:560
    v_bfe_u32 v4, v9, 2, 2
    v_and_b32 v5, 3, v9
    v_lshrrev_b32 v6, 4, v9
    v_mul_u32_u24 v8, 0x5555, v5
    v_lshl_add_u32 v5, v5, 2, s27
    v_lshrrev_b32 v10, 1, v6
    v_mul_u32_u24 v10, 672, v10
    v_add_u32 v10, v10, v5
    v_and_b32 v11, 1, v6
    v_lshlrev_b32 v11, 2, v11
    v_sub_u32 v11, v11, v4
    s_mov_b32 s28, 112
    v_add_u32 v132, 0, v11
    v_min_u32 v132, 5, v132
    v_mad_u32_u24 v132, v132, s28, v10
    v_add_u32 v133, 1, v11
    v_min_u32 v133, 5, v133
    v_mad_u32_u24 v133, v133, s28, v10
    v_add_u32 v134, 2, v11
    v_min_u32 v134, 5, v134
    v_mad_u32_u24 v134, v134, s28, v10
    v_add_u32 v135, 3, v11
    v_min_u32 v135, 5, v135
    v_mad_u32_u24 v135, v135, s28, v10
    v_lshlrev_b32 v11, 1, v6
    v_sub_u32 v11, v11, v4
    v_add_u32 v5, 2688, v5
    v_add_u32 v136, 0, v11
    v_min_u32 v136, 5, v136
    v_mad_u32_u24 v136, v136, s28, v5
    v_add_u32 v137, 1, v11
    v_min_u32 v137, 5, v137
    v_mad_u32_u24 v137, v137, s28, v5
    v_bfe_u32 v12, v9, 2, 2
    v_and_b32 v10, 3, v9
    v_lshrrev_b32 v11, 4, v9
    v_lshl_add_u32 v13, v10, 1, v11
    s_mul_i32 s27, s20, 3888
    v_lshl_add_u32 v13, v13, 4, s27
    v_add_u32 v18, 125120, v13
    v_mov_b32 v19, v13
    s_setprio 3
    s_mul_i32 s26, s30, 86016
    s_mov_b32 s34, 19267584
    buffer_load_dwordx4 v[48:51], v1, s[32:35], s26 offen
    s_add_u32 s30, s30, 1
    s_mul_i32 s26, s30, 86016
    buffer_load_dwordx4 v[52:55], v1, s[32:35], s26 offen
    s_add_u32 s30, s30, 1
    s_mov_b32 s27, 0x05040100
    s_mov_b32 s28, 0x07060302
    s_waitcnt vmcnt(5)
    v_perm_b32 v120, v116, v108, s27
    v_perm_b32 v121, v116, v108, s28
    v_perm_b32 v122, v117, v109, s27
    v_perm_b32 v123, v117, v109, s28
    ds_write_b128 v147, v[120:123] offset:0
    v_perm_b32 v124, v118, v110, s27
    v_perm_b32 v125, v118, v110, s28
    v_perm_b32 v126, v119, v111, s27
    v_perm_b32 v127, v119, v111, s28
    ds_write_b128 v147, v[124:127] offset:16
    v_and_b32 v108, 0xffff, v112
    v_lshrrev_b32 v109, 16, v112
    v_and_b32 v110, 0xffff, v113
    v_lshrrev_b32 v111, 16, v113
    ds_write_b128 v149, v[108:111] offset:0
    v_and_b32 v116, 0xffff, v114
    v_lshrrev_b32 v117, 16, v114
    v_and_b32 v118, 0xffff, v115
    v_lshrrev_b32 v119, 16, v115
    ds_write_b128 v149, v[116:119] offset:16
    s_mul_i32 s26, s30, 86016
    buffer_load_dwordx4 v[20:23], v1, s[32:35], s26 offen
    s_add_u32 s30, s30, 1
    s_setprio 2
    ds_read_b32 v172, v132 offset:0
    ds_read_b32 v173, v133 offset:0
    ds_read_b32 v174, v134 offset:0
    ds_read_b32 v175, v135 offset:0
    ds_read_b32 v176, v132 offset:1344
    ds_read_b32 v177, v133 offset:1344
    ds_read_b32 v178, v134 offset:1344
    ds_read_b32 v179, v135 offset:1344
    ds_read_b32 v180, v136 offset:0
    ds_read_b32 v181, v137 offset:0
    s_mul_i32 s26, s30, 86016
    buffer_load_dwordx4 v[24:27], v1, s[32:35], s26 offen
    s_add_u32 s30, s30, 1
    ds_read_b32 v182, v132 offset:16
    ds_read_b32 v183, v133 offset:16
    ds_read_b32 v184, v134 offset:16
    ds_read_b32 v185, v135 offset:16
    ds_read_b32 v186, v132 offset:1360
    ds_read_b32 v187, v133 offset:1360
    ds_read_b32 v188, v134 offset:1360
    ds_read_b32 v189, v135 offset:1360
    ds_read_b32 v190, v136 offset:16
    ds_read_b32 v191, v137 offset:16
    s_setprio 1
    ds_read_b32 v192, v132 offset:32
    ds_read_b32 v193, v133 offset:32
    ds_read_b32 v194, v134 offset:32
    ds_read_b32 v195, v135 offset:32
    ds_read_b32 v196, v132 offset:1376
    ds_read_b32 v197, v133 offset:1376
    ds_read_b32 v198, v134 offset:1376
    ds_read_b32 v199, v135 offset:1376
    ds_read_b32 v200, v136 offset:32
    ds_read_b32 v201, v137 offset:32
    s_mul_i32 s26, s30, 86016
    buffer_load_dwordx4 v[28:31], v1, s[32:35], s26 offen
    s_add_u32 s30, s30, 1
    ds_read_b32 v202, v132 offset:48
    ds_read_b32 v203, v133 offset:48
    ds_read_b32 v204, v134 offset:48
    ds_read_b32 v205, v135 offset:48
    ds_read_b32 v206, v132 offset:1392
    ds_read_b32 v207, v133 offset:1392
    ds_read_b32 v208, v134 offset:1392
    ds_read_b32 v209, v135 offset:1392
    ds_read_b32 v210, v136 offset:48
    ds_read_b32 v211, v137 offset:48
    s_setprio 0
    ds_read_b32 v212, v132 offset:64
    ds_read_b32 v213, v133 offset:64
    ds_read_b32 v214, v134 offset:64
    ds_read_b32 v215, v135 offset:64
    ds_read_b32 v216, v132 offset:1408
    ds_read_b32 v217, v133 offset:1408
    ds_read_b32 v218, v134 offset:1408
    ds_read_b32 v219, v135 offset:1408
    ds_read_b32 v220, v136 offset:64
    ds_read_b32 v221, v137 offset:64
    s_mul_i32 s26, s30, 86016
    buffer_load_dwordx4 v[32:35], v1, s[32:35], s26 offen
    s_add_u32 s30, s30, 1
    ds_read_b32 v222, v132 offset:80
    ds_read_b32 v223, v133 offset:80
    ds_read_b32 v224, v134 offset:80
    ds_read_b32 v225, v135 offset:80
    ds_read_b32 v226, v132 offset:1424
    ds_read_b32 v227, v133 offset:1424
    ds_read_b32 v228, v134 offset:1424
    ds_read_b32 v229, v135 offset:1424
    ds_read_b32 v230, v136 offset:80
    ds_read_b32 v231, v137 offset:80
    v_lshlrev_b32 v0, 4, v9
    v_add_u32 v0, 155648, v0
    v_lshrrev_b32 v16, 1, v12
    v_xor_b32 v16, v16, v12
    v_and_b32 v10, 3, v9
    v_lshrrev_b32 v11, 4, v9
    v_lshl_add_u32 v10, v11, 2, v10
    s_mul_i32 s27, s20, 768
    v_lshl_add_u32 v10, v10, 4, s27
    s_mov_b32 s18, 0x3baaaaab
    v_lshrrev_b32 v14, 1, v12
    v_mul_u32_u24 v14, 31232, v14
    v_and_b32 v15, 1, v12
    v_mul_u32_u24 v15, 12352, v15
    v_add3_u32 v91, v14, v15, v10
    v_add_u32 v91, 31232, v91
    v_cmp_eq_u32 vcc, 0, v12
    v_lshl_add_u32 v15, v12, 8, v10
    v_add_u32 v15, 149504, v15
    v_mov_b32 v11, 163840
    v_cndmask_b32 v84, v11, v15, vcc
    v_mul_u32_u24 v15, 6176, v16
    v_add_u32 v85, v15, v10
    v_lshlrev_b32 v10, 1, v12
    v_add_u32 v14, 4, v10
    v_lshrrev_b32 v15, 2, v14
    v_mul_u32_u24 v15, 29952, v15
    v_mul_u32_u24 v86, 320, v14
    v_add3_u32 v86, v86, v15, v13
    v_add_u32 v14, 0, v16
    v_lshrrev_b32 v15, 2, v14
    v_mul_u32_u24 v15, 29952, v15
    v_mul_u32_u24 v3, 320, v14
    v_add3_u32 v3, v3, v15, v13
    v_add_u32 v14, 5, v10
    v_lshrrev_b32 v15, 2, v14
    v_mul_u32_u24 v15, 29952, v15
    v_mul_u32_u24 v87, 320, v14
    v_add3_u32 v87, v87, v15, v13
    v_add_u32 v14, 1, v16
    v_lshrrev_b32 v15, 2, v14
    v_mul_u32_u24 v15, 29952, v15
    v_mul_u32_u24 v4, 320, v14
    v_add3_u32 v4, v4, v15, v13
    v_add_u32 v14, 6, v10
    v_lshrrev_b32 v15, 2, v14
    v_mul_u32_u24 v15, 29952, v15
    v_mul_u32_u24 v88, 320, v14
    v_add3_u32 v88, v88, v15, v13
    v_add_u32 v14, 2, v16
    v_lshrrev_b32 v15, 2, v14
    v_mul_u32_u24 v15, 29952, v15
    v_mul_u32_u24 v5, 320, v14
    v_add3_u32 v5, v5, v15, v13
    v_add_u32 v14, 7, v10
    v_lshrrev_b32 v15, 2, v14
    v_mul_u32_u24 v15, 29952, v15
    v_mul_u32_u24 v89, 320, v14
    v_add3_u32 v89, v89, v15, v13
    v_add_u32 v14, 3, v16
    v_lshrrev_b32 v15, 2, v14
    v_mul_u32_u24 v15, 29952, v15
    v_mul_u32_u24 v6, 320, v14
    v_add3_u32 v6, v6, v15, v13
    s_and_b32 s26, s20, 3
    v_lshrrev_b32 v10, 2, v9
    v_mul_u32_u24 v7, 1536, v10
    v_lshrrev_b32 v10, 5, v9
    v_lshlrev_b32 v10, 1, v10
    v_xor_b32 v10, v10, v9
    v_and_b32 v10, 3, v10
    v_lshl_add_u32 v7, v10, 4, v7
    s_mul_i32 s65, s26, 73728
    s_mul_i32 s67, s26, 3072
    s_add_u32 s70, s65, 1536
    s_lshr_b32 s29, s2, 3
    s_mul_i32 s31, s29, 43
    s_lshr_b32 s31, s31, 9
    s_mul_i32 s31, s31, 12
    s_sub_u32 s29, s29, s31
    s_mul_i32 s29, s29, 2
    s_lshl_b32 s31, s29, 6
    s_add_u32 s65, s65, s31
    s_mov_b32 s40, s10
    s_mov_b32 s41, s11
    s_mov_b32 s42, 294912
    s_mov_b32 s43, 0x20000
    s_mov_b32 s44, s12
    s_mov_b32 s45, s13
    s_mov_b32 s46, 294912
    s_mov_b32 s47, 0x20000
    s_mov_b32 s36, s14
    s_mov_b32 s37, s15
    s_mov_b32 s38, 19267584
    s_mov_b32 s39, 0x20000
    s_mov_b32 s60, 0x44ea44ea
    s_mov_b32 s61, 0x37803780
    v_mov_b64 v[60:61], 0
    v_mov_b64 v[62:63], 0
    v_mov_b64 v[64:65], 0
    v_mov_b64 v[66:67], 0
    v_mov_b64 v[68:69], 0
    v_mov_b64 v[70:71], 0
    v_mov_b64 v[72:73], 0
    v_mov_b64 v[74:75], 0
    v_mov_b64 v[76:77], 0
    v_mov_b64 v[78:79], 0
    v_mov_b64 v[80:81], 0
    v_mov_b64 v[82:83], 0
    v_mov_b64 v[232:233], 0
    v_mov_b64 v[234:235], 0
    v_mov_b64 v[236:237], 0
    v_mov_b64 v[238:239], 0
    v_mov_b64 v[240:241], 0
    v_mov_b64 v[242:243], 0
    v_mov_b64 v[244:245], 0
    v_mov_b64 v[246:247], 0
    v_mov_b64 v[248:249], 0
    v_mov_b64 v[250:251], 0
    v_mov_b64 v[252:253], 0
    v_mov_b64 v[254:255], 0
    s_waitcnt vmcnt(4)
    ds_write2_b64 v140, v[36:37], v[38:39] offset0:0 offset1:20
    ds_write2_b64 v2, v[40:41], v[42:43] offset0:0 offset1:20
    ds_write2_b64 v2, v[44:45], v[46:47] offset0:40 offset1:60
    ds_write2_b64 v2, v[48:49], v[50:51] offset0:80 offset1:100
    ds_write2_b64 v2, v[52:53], v[54:55] offset0:120 offset1:140
    v_add_u32 v2, 31232, v2
    s_waitcnt lgkmcnt(0)
    s_barrier
    s_cmp_eq_u32 s23, 0
    s_cbranch_scc1 L_noL1
    s_setprio 3
    ds_read_b128 v[108:111], v18 offset:0
    ds_read_b128 v[112:115], v19 offset:0
    ds_read_b128 v[116:119], v19 offset:320
    ds_read_b128 v[120:123], v19 offset:640
    ds_read_b128 v[124:127], v19 offset:960
    ds_read_b128 v[132:135], v18 offset:160
    ds_read_b128 v[136:139], v19 offset:160
    ds_read_b128 v[140:143], v19 offset:480
    ds_read_b128 v[144:147], v19 offset:800
    ds_read_b128 v[148:151], v19 offset:1120
    s_setprio 2
    s_waitcnt lgkmcnt(5)
    v_smfmac_f32_16x16x64_bf16 v[60:63], v[172:175], v[108:115], v8
    v_smfmac_f32_16x16x64_bf16 v[60:63], v[176:179], v[116:123], v8
    ds_read_b128 v[108:111], v18 offset:1296
    ds_read_b128 v[112:115], v19 offset:1296
    ds_read_b128 v[116:119], v19 offset:1616
    ds_read_b128 v[120:123], v19 offset:1936
    s_nop 1
    v_smfmac_f32_16x16x32_bf16 v[60:63], v[180:181], v[124:127], v8
    ds_read_b128 v[124:127], v19 offset:2256
    s_mul_i32 s26, s30, 86016
    buffer_load_dwordx4 v[92:95], v1, s[32:35], s26 offen
    s_add_u32 s30, s30, 1
    s_waitcnt lgkmcnt(5)
    v_smfmac_f32_16x16x64_bf16 v[64:67], v[182:185], v[132:139], v8
    v_smfmac_f32_16x16x64_bf16 v[64:67], v[186:189], v[140:147], v8
    ds_read_b128 v[132:135], v18 offset:1456
    ds_read_b128 v[136:139], v19 offset:1456
    ds_read_b128 v[140:143], v19 offset:1776
    ds_read_b128 v[144:147], v19 offset:2096
    v_mov_b32 v52, v60
    v_mul_f32 v53, v60, v60
    v_add_f32 v52, v52, v61
    v_fmac_f32 v53, v61, v61
    v_add_f32 v52, v52, v62
    v_fmac_f32 v53, v62, v62
    v_add_f32 v52, v52, v63
    v_fmac_f32 v53, v63, v63
    v_smfmac_f32_16x16x32_bf16 v[64:67], v[190:191], v[148:151], v8
    ds_read_b128 v[148:151], v19 offset:2416
    s_mul_i32 s26, s30, 86016
    buffer_load_dwordx4 v[96:99], v1, s[32:35], s26 offen
    s_add_u32 s30, s30, 1
    s_setprio 1
    s_waitcnt lgkmcnt(5)
    v_smfmac_f32_16x16x64_bf16 v[68:71], v[192:195], v[108:115], v8
    v_smfmac_f32_16x16x64_bf16 v[68:71], v[196:199], v[116:123], v8
    ds_read_b128 v[108:111], v18 offset:2592
    ds_read_b128 v[112:115], v19 offset:2592
    ds_read_b128 v[116:119], v19 offset:2912
    ds_read_b128 v[120:123], v19 offset:3232
    v_add_f32 v52, v52, v64
    v_fmac_f32 v53, v64, v64
    v_add_f32 v52, v52, v65
    v_fmac_f32 v53, v65, v65
    v_add_f32 v52, v52, v66
    v_fmac_f32 v53, v66, v66
    v_add_f32 v52, v52, v67
    v_fmac_f32 v53, v67, v67
    v_smfmac_f32_16x16x32_bf16 v[68:71], v[200:201], v[124:127], v8
    ds_read_b128 v[124:127], v19 offset:3552
    s_mul_i32 s26, s30, 86016
    buffer_load_dwordx4 v[100:103], v1, s[32:35], s26 offen
    s_add_u32 s30, s30, 1
    s_waitcnt lgkmcnt(5)
    v_smfmac_f32_16x16x64_bf16 v[72:75], v[202:205], v[132:139], v8
    v_smfmac_f32_16x16x64_bf16 v[72:75], v[206:209], v[140:147], v8
    ds_read_b128 v[132:135], v18 offset:2752
    ds_read_b128 v[136:139], v19 offset:2752
    ds_read_b128 v[140:143], v19 offset:3072
    ds_read_b128 v[144:147], v19 offset:3392
    v_add_f32 v52, v52, v68
    v_fmac_f32 v53, v68, v68
    v_add_f32 v52, v52, v69
    v_fmac_f32 v53, v69, v69
    v_add_f32 v52, v52, v70
    v_fmac_f32 v53, v70, v70
    v_add_f32 v52, v52, v71
    v_fmac_f32 v53, v71, v71
    v_smfmac_f32_16x16x32_bf16 v[72:75], v[210:211], v[148:151], v8
    ds_read_b128 v[148:151], v19 offset:3712
    s_mul_i32 s26, s30, 86016
    buffer_load_dwordx4 v[104:107], v1, s[32:35], s26 offen
    s_add_u32 s30, s30, 1
    s_setprio 0
    s_waitcnt lgkmcnt(5)
    v_smfmac_f32_16x16x64_bf16 v[76:79], v[212:215], v[108:115], v8
    v_smfmac_f32_16x16x64_bf16 v[76:79], v[216:219], v[116:123], v8
    v_add_f32 v52, v52, v72
    v_fmac_f32 v53, v72, v72
    v_add_f32 v52, v52, v73
    v_fmac_f32 v53, v73, v73
    v_add_f32 v52, v52, v74
    v_fmac_f32 v53, v74, v74
    v_add_f32 v52, v52, v75
    v_fmac_f32 v53, v75, v75
    v_smfmac_f32_16x16x32_bf16 v[76:79], v[220:221], v[124:127], v8
    s_waitcnt vmcnt(6)
    ds_write2_b64 v2, v[20:21], v[22:23] offset0:0 offset1:20
    ds_write2_b64 v2, v[24:25], v[26:27] offset0:40 offset1:60
    s_waitcnt lgkmcnt(2)
    v_smfmac_f32_16x16x64_bf16 v[80:83], v[222:225], v[132:139], v8
    v_smfmac_f32_16x16x64_bf16 v[80:83], v[226:229], v[140:147], v8
    s_nop 1
    v_add_f32 v52, v52, v76
    v_fmac_f32 v53, v76, v76
    v_add_f32 v52, v52, v77
    v_fmac_f32 v53, v77, v77
    v_add_f32 v52, v52, v78
    v_fmac_f32 v53, v78, v78
    v_add_f32 v52, v52, v79
    v_fmac_f32 v53, v79, v79
    v_smfmac_f32_16x16x32_bf16 v[80:83], v[230:231], v[148:151], v8
    s_waitcnt vmcnt(4)
    ds_write2_b64 v2, v[28:29], v[30:31] offset0:80 offset1:100
    ds_write2_b64 v2, v[32:33], v[34:35] offset0:120 offset1:140
    s_nop 4
    v_add_f32 v52, v52, v80
    v_fmac_f32 v53, v80, v80
    v_add_f32 v52, v52, v81
    v_fmac_f32 v53, v81, v81
    v_add_f32 v52, v52, v82
    v_fmac_f32 v53, v82, v82
    v_add_f32 v52, v52, v83
    v_fmac_f32 v53, v83, v83
    s_branch L_noL2
L_noL1:
    s_mul_i32 s26, s30, 86016
    buffer_load_dwordx4 v[92:95], v1, s[32:35], s26 offen
    s_add_u32 s30, s30, 1
    s_mul_i32 s26, s30, 86016
    buffer_load_dwordx4 v[96:99], v1, s[32:35], s26 offen
    s_add_u32 s30, s30, 1
    s_mul_i32 s26, s30, 86016
    buffer_load_dwordx4 v[100:103], v1, s[32:35], s26 offen
    s_add_u32 s30, s30, 1
    s_mul_i32 s26, s30, 86016
    buffer_load_dwordx4 v[104:107], v1, s[32:35], s26 offen
    s_add_u32 s30, s30, 1
    s_waitcnt vmcnt(6)
    ds_write2_b64 v2, v[20:21], v[22:23] offset0:0 offset1:20
    ds_write2_b64 v2, v[24:25], v[26:27] offset0:40 offset1:60
    s_waitcnt vmcnt(4)
    ds_write2_b64 v2, v[28:29], v[30:31] offset0:80 offset1:100
    ds_write2_b64 v2, v[32:33], v[34:35] offset0:120 offset1:140
L_noL2:
    v_add_u32 v2, 31232, v2
    s_waitcnt lgkmcnt(0)
    s_barrier
    s_cmp_ge_u32 s20, 4
    s_cbranch_scc1 L_Q
    s_setprio 3
    ds_read_b128 v[108:111], v3 offset:0
    ds_read_b128 v[112:115], v4 offset:0
    ds_read_b128 v[116:119], v5 offset:0
    ds_read_b128 v[120:123], v6 offset:0
    ds_read_b128 v[124:127], v3 offset:31232
    ds_read_b128 v[132:135], v3 offset:160
    ds_read_b128 v[136:139], v4 offset:160
    ds_read_b128 v[140:143], v5 offset:160
    ds_read_b128 v[144:147], v6 offset:160
    ds_read_b128 v[148:151], v3 offset:31392
    s_setprio 2
    s_waitcnt lgkmcnt(5)
    v_smfmac_f32_16x16x64_bf16 v[232:235], v[172:175], v[108:115], v8
    v_smfmac_f32_16x16x64_bf16 v[232:235], v[176:179], v[116:123], v8
    ds_read_b128 v[108:111], v3 offset:1296
    ds_read_b128 v[112:115], v4 offset:1296
    ds_read_b128 v[116:119], v5 offset:1296
    ds_read_b128 v[120:123], v6 offset:1296
    s_nop 1
    v_smfmac_f32_16x16x32_bf16 v[232:235], v[180:181], v[124:127], v8
    ds_read_b128 v[124:127], v3 offset:32528
    s_mul_i32 s26, s30, 86016
    buffer_load_dwordx4 v[156:159], v1, s[32:35], s26 offen
    s_add_u32 s30, s30, 1
    s_waitcnt lgkmcnt(5)
    v_smfmac_f32_16x16x64_bf16 v[236:239], v[182:185], v[132:139], v8
    v_smfmac_f32_16x16x64_bf16 v[236:239], v[186:189], v[140:147], v8
    ds_read_b128 v[132:135], v3 offset:1456
    ds_read_b128 v[136:139], v4 offset:1456
    ds_read_b128 v[140:143], v5 offset:1456
    ds_read_b128 v[144:147], v6 offset:1456
    v_mov_b32 v54, v232
    v_mul_f32 v55, v232, v232
    v_add_f32 v54, v54, v233
    v_fmac_f32 v55, v233, v233
    v_add_f32 v54, v54, v234
    v_fmac_f32 v55, v234, v234
    v_add_f32 v54, v54, v235
    v_fmac_f32 v55, v235, v235
    v_smfmac_f32_16x16x32_bf16 v[236:239], v[190:191], v[148:151], v8
    ds_read_b128 v[148:151], v3 offset:32688
    s_mul_i32 s26, s30, 86016
    buffer_load_dwordx4 v[160:163], v1, s[32:35], s26 offen
    s_add_u32 s30, s30, 1
    s_setprio 1
    s_waitcnt lgkmcnt(5)
    v_smfmac_f32_16x16x64_bf16 v[240:243], v[192:195], v[108:115], v8
    v_smfmac_f32_16x16x64_bf16 v[240:243], v[196:199], v[116:123], v8
    ds_read_b128 v[108:111], v3 offset:2592
    ds_read_b128 v[112:115], v4 offset:2592
    ds_read_b128 v[116:119], v5 offset:2592
    ds_read_b128 v[120:123], v6 offset:2592
    v_add_f32 v54, v54, v236
    v_fmac_f32 v55, v236, v236
    v_add_f32 v54, v54, v237
    v_fmac_f32 v55, v237, v237
    v_add_f32 v54, v54, v238
    v_fmac_f32 v55, v238, v238
    v_add_f32 v54, v54, v239
    v_fmac_f32 v55, v239, v239
    v_smfmac_f32_16x16x32_bf16 v[240:243], v[200:201], v[124:127], v8
    ds_read_b128 v[124:127], v3 offset:33824
    s_mul_i32 s26, s30, 86016
    s_cmp_lt_u32 s30, 224
    s_cselect_b32 s26, s26, 0
    s_cselect_b32 s34, 19267584, 0
    buffer_load_dwordx4 v[164:167], v1, s[32:35], s26 offen
    s_add_u32 s30, s30, 1
    s_waitcnt lgkmcnt(5)
    v_smfmac_f32_16x16x64_bf16 v[244:247], v[202:205], v[132:139], v8
    v_smfmac_f32_16x16x64_bf16 v[244:247], v[206:209], v[140:147], v8
    ds_read_b128 v[132:135], v3 offset:2752
    ds_read_b128 v[136:139], v4 offset:2752
    ds_read_b128 v[140:143], v5 offset:2752
    ds_read_b128 v[144:147], v6 offset:2752
    v_add_f32 v54, v54, v240
    v_fmac_f32 v55, v240, v240
    v_add_f32 v54, v54, v241
    v_fmac_f32 v55, v241, v241
    v_add_f32 v54, v54, v242
    v_fmac_f32 v55, v242, v242
    v_add_f32 v54, v54, v243
    v_fmac_f32 v55, v243, v243
    v_smfmac_f32_16x16x32_bf16 v[244:247], v[210:211], v[148:151], v8
    ds_read_b128 v[148:151], v3 offset:33984
    s_mul_i32 s26, s30, 86016
    s_cmp_lt_u32 s30, 224
    s_cselect_b32 s26, s26, 0
    s_cselect_b32 s34, 19267584, 0
    buffer_load_dwordx4 v[168:171], v1, s[32:35], s26 offen
    s_add_u32 s30, s30, 1
    v_mov_b32 v1, v91
    s_setprio 0
    s_waitcnt lgkmcnt(5)
    v_smfmac_f32_16x16x64_bf16 v[248:251], v[212:215], v[108:115], v8
    v_smfmac_f32_16x16x64_bf16 v[248:251], v[216:219], v[116:123], v8
    v_add_f32 v54, v54, v244
    v_fmac_f32 v55, v244, v244
    v_add_f32 v54, v54, v245
    v_fmac_f32 v55, v245, v245
    v_add_f32 v54, v54, v246
    v_fmac_f32 v55, v246, v246
    v_add_f32 v54, v54, v247
    v_fmac_f32 v55, v247, v247
    v_smfmac_f32_16x16x32_bf16 v[248:251], v[220:221], v[124:127], v8
    s_waitcnt vmcnt(6)
    ds_write2_b64 v2, v[92:93], v[94:95] offset0:0 offset1:20
    ds_write2_b64 v2, v[96:97], v[98:99] offset0:40 offset1:60
    s_waitcnt lgkmcnt(2)
    v_smfmac_f32_16x16x64_bf16 v[252:255], v[222:225], v[132:139], v8
    v_smfmac_f32_16x16x64_bf16 v[252:255], v[226:229], v[140:147], v8
    s_nop 1
    v_add_f32 v54, v54, v248
    v_fmac_f32 v55, v248, v248
    v_add_f32 v54, v54, v249
    v_fmac_f32 v55, v249, v249
    v_add_f32 v54, v54, v250
    v_fmac_f32 v55, v250, v250
    v_add_f32 v54, v54, v251
    v_fmac_f32 v55, v251, v251
    v_smfmac_f32_16x16x32_bf16 v[252:255], v[230:231], v[148:151], v8
    s_waitcnt vmcnt(4)
    ds_write2_b64 v2, v[100:101], v[102:103] offset0:80 offset1:100
    ds_write2_b64 v2, v[104:105], v[106:107] offset0:120 offset1:140
    v_add_u32 v2, 31232, v2
    s_lshl_b32 s26, s20, 10
    v_add_u32 v108, s26, v0
    s_nop 1
    v_add_f32 v54, v54, v252
    v_fmac_f32 v55, v252, v252
    v_add_f32 v54, v54, v253
    v_fmac_f32 v55, v253, v253
    v_add_f32 v54, v54, v254
    v_fmac_f32 v55, v254, v254
    v_add_f32 v54, v54, v255
    v_fmac_f32 v55, v255, v255
    ds_write_b128 v108, v[52:55]
    v_mov_b32 v3, v86
    v_mov_b32 v4, v87
    v_mov_b32 v5, v88
    v_mov_b32 v6, v89
    s_waitcnt lgkmcnt(0)
    s_barrier
    s_setprio 3
    ds_read_b128 v[108:111], v0 offset:0
    ds_read_b128 v[112:115], v0 offset:1024
    ds_read_b128 v[116:119], v0 offset:2048
    ds_read_b128 v[120:123], v0 offset:3072
    ds_read_b128 v[124:127], v0 offset:4096
    ds_read_b128 v[128:131], v0 offset:5120
    ds_read_b128 v[132:135], v0 offset:6144
    ds_read_b128 v[136:139], v0 offset:7168
    s_waitcnt lgkmcnt(0)
    v_pk_add_f32 v[108:109], v[108:109], v[112:113]
    v_pk_add_f32 v[110:111], v[110:111], v[114:115]
    v_pk_add_f32 v[116:117], v[116:117], v[120:121]
    v_pk_add_f32 v[118:119], v[118:119], v[122:123]
    v_pk_add_f32 v[124:125], v[124:125], v[128:129]
    v_pk_add_f32 v[126:127], v[126:127], v[130:131]
    v_pk_add_f32 v[132:133], v[132:133], v[136:137]
    v_pk_add_f32 v[134:135], v[134:135], v[138:139]
    v_pk_add_f32 v[108:109], v[108:109], v[116:117]
    v_pk_add_f32 v[110:111], v[110:111], v[118:119]
    v_pk_add_f32 v[124:125], v[124:125], v[132:133]
    v_pk_add_f32 v[126:127], v[126:127], v[134:135]
    v_pk_add_f32 v[24:25], v[108:109], v[124:125]
    v_pk_add_f32 v[26:27], v[110:111], v[126:127]
    v_mul_f32 v24, s18, v24
    v_mul_f32 v25, s18, v25
    v_mul_f32 v26, s18, v26
    v_mul_f32 v27, s18, v27
    v_fma_f32 v25, -v24, v24, v25
    v_fma_f32 v27, -v26, v26, v27
    v_max_f32 v25, 0, v25
    v_max_f32 v27, 0, v27
    v_add_f32 v25, 0x3727c5ac, v25
    v_add_f32 v27, 0x3727c5ac, v27
    v_rsq_f32 v25, v25
    v_rsq_f32 v27, v27
    v_mul_f32 v25, 0x3eeff558, v25
    v_mul_f32 v27, 0x3eeff558, v27
    v_mul_f32_e64 v24, -v24, v25
    v_mul_f32_e64 v26, -v26, v27
    s_cmp_eq_u32 s23, 0
    s_cbranch_scc1 L_ln0P
    v_pk_fma_f32 v[60:61], v[60:61], v[24:25], v[24:25] op_sel:[0,1,0] op_sel_hi:[1,1,0]
    v_pk_fma_f32 v[62:63], v[62:63], v[24:25], v[24:25] op_sel:[0,1,0] op_sel_hi:[1,1,0]
    v_pk_fma_f32 v[64:65], v[64:65], v[24:25], v[24:25] op_sel:[0,1,0] op_sel_hi:[1,1,0]
    v_pk_fma_f32 v[66:67], v[66:67], v[24:25], v[24:25] op_sel:[0,1,0] op_sel_hi:[1,1,0]
    v_cvt_pk_bf16_f32 v60, v60, v61
    v_cvt_pk_bf16_f32 v61, v62, v63
    v_cvt_pk_bf16_f32 v62, v64, v65
    v_cvt_pk_bf16_f32 v63, v66, v67
    ds_write_b128 v84, v[60:63] offset:0
    v_pk_fma_f32 v[68:69], v[68:69], v[24:25], v[24:25] op_sel:[0,1,0] op_sel_hi:[1,1,0]
    v_pk_fma_f32 v[70:71], v[70:71], v[24:25], v[24:25] op_sel:[0,1,0] op_sel_hi:[1,1,0]
    v_pk_fma_f32 v[72:73], v[72:73], v[24:25], v[24:25] op_sel:[0,1,0] op_sel_hi:[1,1,0]
    v_pk_fma_f32 v[74:75], v[74:75], v[24:25], v[24:25] op_sel:[0,1,0] op_sel_hi:[1,1,0]
    v_cvt_pk_bf16_f32 v68, v68, v69
    v_cvt_pk_bf16_f32 v69, v70, v71
    v_cvt_pk_bf16_f32 v70, v72, v73
    v_cvt_pk_bf16_f32 v71, v74, v75
    ds_write_b128 v84, v[68:71] offset:256
    v_pk_fma_f32 v[76:77], v[76:77], v[24:25], v[24:25] op_sel:[0,1,0] op_sel_hi:[1,1,0]
    v_pk_fma_f32 v[78:79], v[78:79], v[24:25], v[24:25] op_sel:[0,1,0] op_sel_hi:[1,1,0]
    v_pk_fma_f32 v[80:81], v[80:81], v[24:25], v[24:25] op_sel:[0,1,0] op_sel_hi:[1,1,0]
    v_pk_fma_f32 v[82:83], v[82:83], v[24:25], v[24:25] op_sel:[0,1,0] op_sel_hi:[1,1,0]
    v_cvt_pk_bf16_f32 v76, v76, v77
    v_cvt_pk_bf16_f32 v77, v78, v79
    v_cvt_pk_bf16_f32 v78, v80, v81
    v_cvt_pk_bf16_f32 v79, v82, v83
    ds_write_b128 v84, v[76:79] offset:512
L_ln0P:
    v_pk_fma_f32 v[232:233], v[232:233], v[26:27], v[26:27] op_sel:[0,1,0] op_sel_hi:[1,1,0]
    v_pk_fma_f32 v[234:235], v[234:235], v[26:27], v[26:27] op_sel:[0,1,0] op_sel_hi:[1,1,0]
    v_pk_fma_f32 v[236:237], v[236:237], v[26:27], v[26:27] op_sel:[0,1,0] op_sel_hi:[1,1,0]
    v_pk_fma_f32 v[238:239], v[238:239], v[26:27], v[26:27] op_sel:[0,1,0] op_sel_hi:[1,1,0]
    v_cvt_pk_bf16_f32 v232, v232, v233
    v_cvt_pk_bf16_f32 v233, v234, v235
    v_cvt_pk_bf16_f32 v234, v236, v237
    v_cvt_pk_bf16_f32 v235, v238, v239
    ds_write_b128 v85, v[232:235] offset:0
    v_pk_fma_f32 v[240:241], v[240:241], v[26:27], v[26:27] op_sel:[0,1,0] op_sel_hi:[1,1,0]
    v_pk_fma_f32 v[242:243], v[242:243], v[26:27], v[26:27] op_sel:[0,1,0] op_sel_hi:[1,1,0]
    v_pk_fma_f32 v[244:245], v[244:245], v[26:27], v[26:27] op_sel:[0,1,0] op_sel_hi:[1,1,0]
    v_pk_fma_f32 v[246:247], v[246:247], v[26:27], v[26:27] op_sel:[0,1,0] op_sel_hi:[1,1,0]
    v_cvt_pk_bf16_f32 v240, v240, v241
    v_cvt_pk_bf16_f32 v241, v242, v243
    v_cvt_pk_bf16_f32 v242, v244, v245
    v_cvt_pk_bf16_f32 v243, v246, v247
    ds_write_b128 v85, v[240:243] offset:256
    v_pk_fma_f32 v[248:249], v[248:249], v[26:27], v[26:27] op_sel:[0,1,0] op_sel_hi:[1,1,0]
    v_pk_fma_f32 v[250:251], v[250:251], v[26:27], v[26:27] op_sel:[0,1,0] op_sel_hi:[1,1,0]
    v_pk_fma_f32 v[252:253], v[252:253], v[26:27], v[26:27] op_sel:[0,1,0] op_sel_hi:[1,1,0]
    v_pk_fma_f32 v[254:255], v[254:255], v[26:27], v[26:27] op_sel:[0,1,0] op_sel_hi:[1,1,0]
    v_cvt_pk_bf16_f32 v248, v248, v249
    v_cvt_pk_bf16_f32 v249, v250, v251
    v_cvt_pk_bf16_f32 v250, v252, v253
    v_cvt_pk_bf16_f32 v251, v254, v255
    ds_write_b128 v85, v[248:251] offset:512
    s_waitcnt vmcnt(0)
    ds_write2_b64 v2, v[156:157], v[158:159] offset0:0 offset1:20
    ds_write2_b64 v2, v[160:161], v[162:163] offset0:40 offset1:60
    ds_write2_b64 v2, v[164:165], v[166:167] offset0:80 offset1:100
    ds_write2_b64 v2, v[168:169], v[170:171] offset0:120 offset1:140
    s_waitcnt lgkmcnt(0)
    s_barrier
    ds_read_b128 v[108:111], v3 offset:0
    ds_read_b128 v[112:115], v4 offset:0
    ds_read_b128 v[116:119], v5 offset:0
    ds_read_b128 v[120:123], v6 offset:0
    ds_read_b128 v[124:127], v3 offset:31232
    ds_read_b128 v[128:131], v4 offset:31232
    ds_read_b128 v[132:135], v3 offset:160
    ds_read_b128 v[136:139], v4 offset:160
    ds_read_b128 v[140:143], v5 offset:160
    ds_read_b128 v[144:147], v6 offset:160
    ds_read_b128 v[148:151], v3 offset:31392
    ds_read_b128 v[152:155], v4 offset:31392
    v_and_b32 v10, 3, v9
    v_bfe_u32 v11, v9, 2, 2
    v_lshl_add_u32 v10, v10, 2, v11
    v_and_b32 v11, 48, v9
    v_add_u32 v10, v10, v11
    v_lshlrev_b32 v10, 4, v10
    s_mul_i32 s26, s24, 6176
    v_add_u32 v11, s26, v10
    v_mov_b64 v[60:61], 0
    v_mov_b64 v[62:63], 0
    v_mov_b64 v[64:65], 0
    v_mov_b64 v[66:67], 0
    v_mov_b64 v[232:233], 0
    v_mov_b64 v[234:235], 0
    v_mov_b64 v[236:237], 0
    v_mov_b64 v[238:239], 0
    s_setprio 2
    s_waitcnt lgkmcnt(6)
    v_smfmac_f32_16x16x64_bf16 v[60:63], v[172:175], v[108:115], v8
    v_smfmac_f32_16x16x64_bf16 v[60:63], v[176:179], v[116:123], v8
    v_smfmac_f32_16x16x64_bf16 v[232:235], v[172:175], v[112:119], v8
    v_smfmac_f32_16x16x64_bf16 v[232:235], v[176:179], v[120:127], v8
    ds_read_b128 v[108:111], v3 offset:1296
    ds_read_b128 v[112:115], v4 offset:1296
    ds_read_b128 v[116:119], v5 offset:1296
    ds_read_b128 v[120:123], v6 offset:1296
    v_mov_b64 v[68:69], 0
    v_mov_b64 v[70:71], 0
    v_mov_b64 v[240:241], 0
    v_mov_b64 v[242:243], 0
    v_smfmac_f32_16x16x32_bf16 v[60:63], v[180:181], v[124:127], v8
    v_smfmac_f32_16x16x32_bf16 v[232:235], v[180:181], v[128:131], v8
    ds_read_b128 v[124:127], v3 offset:32528
    ds_read_b128 v[128:131], v4 offset:32528
    s_lshr_b32 s52, s20, 2
    s_mul_i32 s53, s52, 12288
    s_add_u32 s53, s53, s67
    s_lshl_b32 s52, s52, 6
    s_add_u32 s52, s52, s65
    s_add_u32 m0, s53, 124928
    s_add_u32 s69, s52, 0
    buffer_load_dwordx4 v7, s[40:43], s69 offen lds
    s_waitcnt lgkmcnt(6)
    v_smfmac_f32_16x16x64_bf16 v[64:67], v[182:185], v[132:139], v8
    v_smfmac_f32_16x16x64_bf16 v[64:67], v[186:189], v[140:147], v8
    v_smfmac_f32_16x16x64_bf16 v[236:239], v[182:185], v[136:143], v8
    v_smfmac_f32_16x16x64_bf16 v[236:239], v[186:189], v[144:151], v8
    ds_read_b128 v[132:135], v3 offset:1456
    ds_read_b128 v[136:139], v4 offset:1456
    ds_read_b128 v[140:143], v5 offset:1456
    ds_read_b128 v[144:147], v6 offset:1456
    v_mov_b64 v[72:73], 0
    v_mov_b64 v[74:75], 0
    v_mov_b64 v[244:245], 0
    v_mov_b64 v[246:247], 0
    v_mov_b32 v84, v60
    v_mul_f32 v85, v60, v60
    v_add_f32 v84, v84, v61
    v_fmac_f32 v85, v61, v61
    v_add_f32 v84, v84, v62
    v_fmac_f32 v85, v62, v62
    v_add_f32 v84, v84, v63
    v_fmac_f32 v85, v63, v63
    v_smfmac_f32_16x16x32_bf16 v[64:67], v[190:191], v[148:151], v8
    v_smfmac_f32_16x16x32_bf16 v[236:239], v[190:191], v[152:155], v8
    ds_read_b128 v[148:151], v3 offset:32688
    ds_read_b128 v[152:155], v4 offset:32688
    s_add_u32 m0, s53, 125952
    s_add_u32 s69, s52, 24576
    buffer_load_dwordx4 v7, s[40:43], s69 offen lds
    v_mov_b32 v86, v232
    v_mul_f32 v87, v232, v232
    v_add_f32 v86, v86, v233
    v_fmac_f32 v87, v233, v233
    v_add_f32 v86, v86, v234
    v_fmac_f32 v87, v234, v234
    v_add_f32 v86, v86, v235
    v_fmac_f32 v87, v235, v235
    s_setprio 1
    s_waitcnt lgkmcnt(6)
    v_smfmac_f32_16x16x64_bf16 v[68:71], v[192:195], v[108:115], v8
    v_smfmac_f32_16x16x64_bf16 v[68:71], v[196:199], v[116:123], v8
    v_smfmac_f32_16x16x64_bf16 v[240:243], v[192:195], v[112:119], v8
    v_smfmac_f32_16x16x64_bf16 v[240:243], v[196:199], v[120:127], v8
    ds_read_b128 v[108:111], v3 offset:2592
    ds_read_b128 v[112:115], v4 offset:2592
    ds_read_b128 v[116:119], v5 offset:2592
    ds_read_b128 v[120:123], v6 offset:2592
    v_mov_b64 v[76:77], 0
    v_mov_b64 v[78:79], 0
    v_mov_b64 v[248:249], 0
    v_mov_b64 v[250:251], 0
    v_add_f32 v84, v84, v64
    v_fmac_f32 v85, v64, v64
    v_add_f32 v84, v84, v65
    v_fmac_f32 v85, v65, v65
    v_add_f32 v84, v84, v66
    v_fmac_f32 v85, v66, v66
    v_add_f32 v84, v84, v67
    v_fmac_f32 v85, v67, v67
    v_smfmac_f32_16x16x32_bf16 v[68:71], v[200:201], v[124:127], v8
    v_smfmac_f32_16x16x32_bf16 v[240:243], v[200:201], v[128:131], v8
    ds_read_b128 v[124:127], v3 offset:33824
    ds_read_b128 v[128:131], v4 offset:33824
    s_add_u32 m0, s53, 126976
    s_add_u32 s69, s52, 49152
    buffer_load_dwordx4 v7, s[40:43], s69 offen lds
    v_add_f32 v86, v86, v236
    v_fmac_f32 v87, v236, v236
    v_add_f32 v86, v86, v237
    v_fmac_f32 v87, v237, v237
    v_add_f32 v86, v86, v238
    v_fmac_f32 v87, v238, v238
    v_add_f32 v86, v86, v239
    v_fmac_f32 v87, v239, v239
    s_waitcnt lgkmcnt(6)
    v_smfmac_f32_16x16x64_bf16 v[72:75], v[202:205], v[132:139], v8
    v_smfmac_f32_16x16x64_bf16 v[72:75], v[206:209], v[140:147], v8
    v_smfmac_f32_16x16x64_bf16 v[244:247], v[202:205], v[136:143], v8
    v_smfmac_f32_16x16x64_bf16 v[244:247], v[206:209], v[144:151], v8
    ds_read_b128 v[132:135], v3 offset:2752
    ds_read_b128 v[136:139], v4 offset:2752
    ds_read_b128 v[140:143], v5 offset:2752
    ds_read_b128 v[144:147], v6 offset:2752
    v_mov_b64 v[80:81], 0
    v_mov_b64 v[82:83], 0
    v_mov_b64 v[252:253], 0
    v_mov_b64 v[254:255], 0
    v_add_f32 v84, v84, v68
    v_fmac_f32 v85, v68, v68
    v_add_f32 v84, v84, v69
    v_fmac_f32 v85, v69, v69
    v_add_f32 v84, v84, v70
    v_fmac_f32 v85, v70, v70
    v_add_f32 v84, v84, v71
    v_fmac_f32 v85, v71, v71
    v_smfmac_f32_16x16x32_bf16 v[72:75], v[210:211], v[148:151], v8
    v_smfmac_f32_16x16x32_bf16 v[244:247], v[210:211], v[152:155], v8
    ds_read_b128 v[148:151], v3 offset:33984
    ds_read_b128 v[152:155], v4 offset:33984
    ds_read_b128 v[12:15], v11 offset:0
    ds_read_b128 v[16:19], v11 offset:1024
    ds_read_b128 v[20:23], v11 offset:2048
    ds_read_b128 v[24:27], v11 offset:3072
    v_add_f32 v86, v86, v240
    v_fmac_f32 v87, v240, v240
    v_add_f32 v86, v86, v241
    v_fmac_f32 v87, v241, v241
    v_add_f32 v86, v86, v242
    v_fmac_f32 v87, v242, v242
    v_add_f32 v86, v86, v243
    v_fmac_f32 v87, v243, v243
    s_setprio 0
    s_waitcnt lgkmcnt(10)
    v_smfmac_f32_16x16x64_bf16 v[76:79], v[212:215], v[108:115], v8
    v_smfmac_f32_16x16x64_bf16 v[76:79], v[216:219], v[116:123], v8
    v_smfmac_f32_16x16x64_bf16 v[248:251], v[212:215], v[112:119], v8
    v_smfmac_f32_16x16x64_bf16 v[248:251], v[216:219], v[120:127], v8
    v_add_f32 v84, v84, v72
    v_fmac_f32 v85, v72, v72
    v_add_f32 v84, v84, v73
    v_fmac_f32 v85, v73, v73
    v_add_f32 v84, v84, v74
    v_fmac_f32 v85, v74, v74
    v_add_f32 v84, v84, v75
    v_fmac_f32 v85, v75, v75
    v_smfmac_f32_16x16x32_bf16 v[76:79], v[220:221], v[124:127], v8
    v_smfmac_f32_16x16x32_bf16 v[248:251], v[220:221], v[128:131], v8
    ds_read_b128 v[28:31], v11 offset:4096
    ds_read_b128 v[32:35], v11 offset:5120
    ds_read_b128 v[36:39], v11 offset:12352
    ds_read_b128 v[40:43], v11 offset:13376
    v_add_f32 v86, v86, v244
    v_fmac_f32 v87, v244, v244
    v_add_f32 v86, v86, v245
    v_fmac_f32 v87, v245, v245
    v_add_f32 v86, v86, v246
    v_fmac_f32 v87, v246, v246
    v_add_f32 v86, v86, v247
    v_fmac_f32 v87, v247, v247
    s_waitcnt lgkmcnt(8)
    v_smfmac_f32_16x16x64_bf16 v[80:83], v[222:225], v[132:139], v8
    v_smfmac_f32_16x16x64_bf16 v[80:83], v[226:229], v[140:147], v8
    v_smfmac_f32_16x16x64_bf16 v[252:255], v[222:225], v[136:143], v8
    v_smfmac_f32_16x16x64_bf16 v[252:255], v[226:229], v[144:151], v8
    v_add_f32 v84, v84, v76
    v_fmac_f32 v85, v76, v76
    v_add_f32 v84, v84, v77
    v_fmac_f32 v85, v77, v77
    v_add_f32 v84, v84, v78
    v_fmac_f32 v85, v78, v78
    v_add_f32 v84, v84, v79
    v_fmac_f32 v85, v79, v79
    v_smfmac_f32_16x16x32_bf16 v[80:83], v[230:231], v[148:151], v8
    v_smfmac_f32_16x16x32_bf16 v[252:255], v[230:231], v[152:155], v8
    ds_read_b128 v[44:47], v11 offset:14400
    ds_read_b128 v[48:51], v11 offset:15424
    ds_read_b128 v[52:55], v11 offset:16448
    ds_read_b128 v[56:59], v11 offset:17472
    v_add_f32 v86, v86, v248
    v_fmac_f32 v87, v248, v248
    v_add_f32 v86, v86, v249
    v_fmac_f32 v87, v249, v249
    v_add_f32 v86, v86, v250
    v_fmac_f32 v87, v250, v250
    v_add_f32 v86, v86, v251
    v_fmac_f32 v87, v251, v251
    s_lshl_b32 s26, s20, 10
    v_add_u32 v108, s26, v0
    v_add_f32 v84, v84, v80
    v_fmac_f32 v85, v80, v80
    v_add_f32 v84, v84, v81
    v_fmac_f32 v85, v81, v81
    v_add_f32 v84, v84, v82
    v_fmac_f32 v85, v82, v82
    v_add_f32 v84, v84, v83
    v_fmac_f32 v85, v83, v83
    v_add_f32 v86, v86, v252
    v_fmac_f32 v87, v252, v252
    v_add_f32 v86, v86, v253
    v_fmac_f32 v87, v253, v253
    v_add_f32 v86, v86, v254
    v_fmac_f32 v87, v254, v254
    v_add_f32 v86, v86, v255
    v_fmac_f32 v87, v255, v255
    ds_write_b128 v108, v[84:87]
    s_waitcnt vmcnt(0) lgkmcnt(0)
    s_barrier
    s_setprio 3
    ds_read_b128 v[108:111], v0 offset:0
    ds_read_b128 v[112:115], v0 offset:1024
    ds_read_b128 v[116:119], v0 offset:2048
    ds_read_b128 v[120:123], v0 offset:3072
    ds_read_b128 v[124:127], v0 offset:4096
    ds_read_b128 v[128:131], v0 offset:5120
    ds_read_b128 v[132:135], v0 offset:6144
    ds_read_b128 v[136:139], v0 offset:7168
    s_waitcnt lgkmcnt(0)
    v_pk_add_f32 v[108:109], v[108:109], v[112:113]
    v_pk_add_f32 v[110:111], v[110:111], v[114:115]
    v_pk_add_f32 v[116:117], v[116:117], v[120:121]
    v_pk_add_f32 v[118:119], v[118:119], v[122:123]
    v_pk_add_f32 v[124:125], v[124:125], v[128:129]
    v_pk_add_f32 v[126:127], v[126:127], v[130:131]
    v_pk_add_f32 v[132:133], v[132:133], v[136:137]
    v_pk_add_f32 v[134:135], v[134:135], v[138:139]
    v_pk_add_f32 v[108:109], v[108:109], v[116:117]
    v_pk_add_f32 v[110:111], v[110:111], v[118:119]
    v_pk_add_f32 v[124:125], v[124:125], v[132:133]
    v_pk_add_f32 v[126:127], v[126:127], v[134:135]
    v_pk_add_f32 v[88:89], v[108:109], v[124:125]
    v_pk_add_f32 v[90:91], v[110:111], v[126:127]
    v_mul_f32 v88, s18, v88
    v_mul_f32 v89, s18, v89
    v_mul_f32 v90, s18, v90
    v_mul_f32 v91, s18, v91
    v_fma_f32 v89, -v88, v88, v89
    v_fma_f32 v91, -v90, v90, v91
    v_max_f32 v89, 0, v89
    v_max_f32 v91, 0, v91
    v_add_f32 v89, 0x3727c5ac, v89
    v_add_f32 v91, 0x3727c5ac, v91
    v_rsq_f32 v89, v89
    v_rsq_f32 v91, v91
    v_mul_f32 v89, 0x3eeff558, v89
    v_mul_f32 v91, 0x3eeff558, v91
    v_mul_f32_e64 v88, -v88, v89
    v_mul_f32_e64 v90, -v90, v91
    v_pk_fma_f32 v[60:61], v[60:61], v[88:89], v[88:89] op_sel:[0,1,0] op_sel_hi:[1,1,0]
    v_pk_fma_f32 v[62:63], v[62:63], v[88:89], v[88:89] op_sel:[0,1,0] op_sel_hi:[1,1,0]
    v_pk_fma_f32 v[64:65], v[64:65], v[88:89], v[88:89] op_sel:[0,1,0] op_sel_hi:[1,1,0]
    v_pk_fma_f32 v[66:67], v[66:67], v[88:89], v[88:89] op_sel:[0,1,0] op_sel_hi:[1,1,0]
    v_cvt_pk_bf16_f32 v60, v60, v61
    v_cvt_pk_bf16_f32 v61, v62, v63
    v_cvt_pk_bf16_f32 v62, v64, v65
    v_cvt_pk_bf16_f32 v63, v66, v67
    ds_write_b128 v1, v[60:63] offset:0
    v_pk_fma_f32 v[68:69], v[68:69], v[88:89], v[88:89] op_sel:[0,1,0] op_sel_hi:[1,1,0]
    v_pk_fma_f32 v[70:71], v[70:71], v[88:89], v[88:89] op_sel:[0,1,0] op_sel_hi:[1,1,0]
    v_pk_fma_f32 v[72:73], v[72:73], v[88:89], v[88:89] op_sel:[0,1,0] op_sel_hi:[1,1,0]
    v_pk_fma_f32 v[74:75], v[74:75], v[88:89], v[88:89] op_sel:[0,1,0] op_sel_hi:[1,1,0]
    v_cvt_pk_bf16_f32 v68, v68, v69
    v_cvt_pk_bf16_f32 v69, v70, v71
    v_cvt_pk_bf16_f32 v70, v72, v73
    v_cvt_pk_bf16_f32 v71, v74, v75
    ds_write_b128 v1, v[68:71] offset:256
    v_pk_fma_f32 v[76:77], v[76:77], v[88:89], v[88:89] op_sel:[0,1,0] op_sel_hi:[1,1,0]
    v_pk_fma_f32 v[78:79], v[78:79], v[88:89], v[88:89] op_sel:[0,1,0] op_sel_hi:[1,1,0]
    v_pk_fma_f32 v[80:81], v[80:81], v[88:89], v[88:89] op_sel:[0,1,0] op_sel_hi:[1,1,0]
    v_pk_fma_f32 v[82:83], v[82:83], v[88:89], v[88:89] op_sel:[0,1,0] op_sel_hi:[1,1,0]
    v_cvt_pk_bf16_f32 v76, v76, v77
    v_cvt_pk_bf16_f32 v77, v78, v79
    v_cvt_pk_bf16_f32 v78, v80, v81
    v_cvt_pk_bf16_f32 v79, v82, v83
    ds_write_b128 v1, v[76:79] offset:512
    v_pk_fma_f32 v[232:233], v[232:233], v[90:91], v[90:91] op_sel:[0,1,0] op_sel_hi:[1,1,0]
    v_pk_fma_f32 v[234:235], v[234:235], v[90:91], v[90:91] op_sel:[0,1,0] op_sel_hi:[1,1,0]
    v_pk_fma_f32 v[236:237], v[236:237], v[90:91], v[90:91] op_sel:[0,1,0] op_sel_hi:[1,1,0]
    v_pk_fma_f32 v[238:239], v[238:239], v[90:91], v[90:91] op_sel:[0,1,0] op_sel_hi:[1,1,0]
    v_cvt_pk_bf16_f32 v232, v232, v233
    v_cvt_pk_bf16_f32 v233, v234, v235
    v_cvt_pk_bf16_f32 v234, v236, v237
    v_cvt_pk_bf16_f32 v235, v238, v239
    ds_write_b128 v1, v[232:235] offset:6176
    v_pk_fma_f32 v[240:241], v[240:241], v[90:91], v[90:91] op_sel:[0,1,0] op_sel_hi:[1,1,0]
    v_pk_fma_f32 v[242:243], v[242:243], v[90:91], v[90:91] op_sel:[0,1,0] op_sel_hi:[1,1,0]
    v_pk_fma_f32 v[244:245], v[244:245], v[90:91], v[90:91] op_sel:[0,1,0] op_sel_hi:[1,1,0]
    v_pk_fma_f32 v[246:247], v[246:247], v[90:91], v[90:91] op_sel:[0,1,0] op_sel_hi:[1,1,0]
    v_cvt_pk_bf16_f32 v240, v240, v241
    v_cvt_pk_bf16_f32 v241, v242, v243
    v_cvt_pk_bf16_f32 v242, v244, v245
    v_cvt_pk_bf16_f32 v243, v246, v247
    ds_write_b128 v1, v[240:243] offset:6432
    v_pk_fma_f32 v[248:249], v[248:249], v[90:91], v[90:91] op_sel:[0,1,0] op_sel_hi:[1,1,0]
    v_pk_fma_f32 v[250:251], v[250:251], v[90:91], v[90:91] op_sel:[0,1,0] op_sel_hi:[1,1,0]
    v_pk_fma_f32 v[252:253], v[252:253], v[90:91], v[90:91] op_sel:[0,1,0] op_sel_hi:[1,1,0]
    v_pk_fma_f32 v[254:255], v[254:255], v[90:91], v[90:91] op_sel:[0,1,0] op_sel_hi:[1,1,0]
    v_cvt_pk_bf16_f32 v248, v248, v249
    v_cvt_pk_bf16_f32 v249, v250, v251
    v_cvt_pk_bf16_f32 v250, v252, v253
    v_cvt_pk_bf16_f32 v251, v254, v255
    ds_write_b128 v1, v[248:251] offset:6688
    v_lshrrev_b32 v4, 4, v9
    v_bfe_u32 v5, v9, 2, 2
    v_lshl_add_u32 v1, v4, 3, v5
    v_lshlrev_b32 v1, 6, v1
    v_xor_b32 v5, s25, v4
    v_and_b32 v5, 1, v5
    v_lshl_add_u32 v1, v5, 5, v1
    v_and_b32 v5, 3, v9
    v_lshl_add_u32 v1, v5, 3, v1
    v_add_u32 v1, 112640, v1
    v_and_b32 v5, 15, v9
    v_lshlrev_b32 v2, 4, v5
    v_and_b32 v5, 1, v4
    v_lshl_add_u32 v2, v5, 3, v2
    v_lshrrev_b32 v4, 1, v4
    v_lshl_add_u32 v3, v4, 8, v2
    v_mov_b32 v2, v3
    s_lshl_b32 s26, s24, 11
    s_lshl_b32 s27, s25, 10
    s_add_u32 s26, s26, s27
    s_add_u32 s26, s26, 0
    v_add_u32 v2, s26, v2
    s_lshl_b32 s26, s25, 9
    s_mov_b32 s27, 0
    s_add_u32 s26, s26, s27
    s_add_u32 s26, s26, 12288
    v_add_u32 v3, s26, v3
    s_cmp_eq_u32 s24, 1
    s_cselect_b64 s[62:63], -1, 0
    ds_read_b64_tr_b16 v[196:197], v1 offset:12288
    ds_read_b64_tr_b16 v[198:199], v1 offset:12544
    ds_read_b64_tr_b16 v[200:201], v1 offset:14336
    ds_read_b64_tr_b16 v[202:203], v1 offset:14592
    ds_read_b64_tr_b16 v[204:205], v1 offset:16384
    ds_read_b64_tr_b16 v[206:207], v1 offset:16640
    ds_read_b64_tr_b16 v[208:209], v1 offset:18432
    ds_read_b64_tr_b16 v[210:211], v1 offset:18688
    ds_read_b64_tr_b16 v[212:213], v1 offset:20480
    ds_read_b64_tr_b16 v[214:215], v1 offset:20736
    ds_read_b64_tr_b16 v[216:217], v1 offset:22528
    ds_read_b64_tr_b16 v[218:219], v1 offset:22784
    v_add_u32 v6, 62464, v11
    v_add_u32 v10, 149504, v10
    s_waitcnt lgkmcnt(0)
    s_barrier
    ds_read_b128 v[60:63], v11 offset:31232
    ds_read_b128 v[64:67], v11 offset:32256
    ds_read_b128 v[68:71], v11 offset:33280
    ds_read_b128 v[72:75], v11 offset:34304
    ds_read_b128 v[76:79], v11 offset:35328
    ds_read_b128 v[80:83], v11 offset:36352
    ds_read_b128 v[84:87], v11 offset:43584
    ds_read_b128 v[88:91], v11 offset:44608
    ds_read_b128 v[92:95], v11 offset:45632
    ds_read_b128 v[96:99], v11 offset:46656
    ds_read_b128 v[100:103], v11 offset:47680
    ds_read_b128 v[104:107], v11 offset:48704
    ds_read_b128 v[124:127], v6 offset:0
    ds_read_b128 v[128:131], v6 offset:1024
    ds_read_b128 v[132:135], v6 offset:2048
    ds_read_b128 v[136:139], v6 offset:3072
    ds_read_b128 v[140:143], v6 offset:4096
    ds_read_b128 v[144:147], v6 offset:5120
    ds_read_b128 v[148:151], v6 offset:12352
    ds_read_b128 v[152:155], v6 offset:13376
    ds_read_b128 v[156:159], v6 offset:14400
    ds_read_b128 v[160:163], v6 offset:15424
    ds_read_b128 v[164:167], v6 offset:16448
    ds_read_b128 v[168:171], v6 offset:17472
    s_cmp_eq_u32 s23, 0
    s_cbranch_scc1 L_PN
    ds_read_b128 v[172:175], v10 offset:0
    ds_read_b128 v[176:179], v10 offset:1024
    ds_read_b128 v[180:183], v10 offset:2048
    ds_read_b128 v[184:187], v10 offset:3072
    ds_read_b128 v[188:191], v10 offset:4096
    ds_read_b128 v[192:195], v10 offset:5120
    s_mov_b32 s64, 0
    s_cmp_eq_u32 s24, 1
    s_cbranch_scc1 L_P_pre1
    s_setprio 1
    v_mfma_f32_16x16x32_bf16 v[220:223], v[196:199], v[12:15], 0
    v_mfma_f32_16x16x32_bf16 v[220:223], v[200:203], v[16:19], v[220:223]
    v_mfma_f32_16x16x32_bf16 v[220:223], v[204:207], v[20:23], v[220:223]
    v_mfma_f32_16x16x32_bf16 v[220:223], v[208:211], v[24:27], v[220:223]
    v_mfma_f32_16x16x32_bf16 v[220:223], v[212:215], v[28:31], v[220:223]
    v_mfma_f32_16x16x32_bf16 v[220:223], v[216:219], v[32:35], v[220:223]
    v_mfma_f32_16x16x32_bf16 v[224:227], v[196:199], v[36:39], 0
    v_mfma_f32_16x16x32_bf16 v[224:227], v[200:203], v[40:43], v[224:227]
    v_mfma_f32_16x16x32_bf16 v[224:227], v[204:207], v[44:47], v[224:227]
    v_mfma_f32_16x16x32_bf16 v[224:227], v[208:211], v[48:51], v[224:227]
    s_nop 3
    v_cvt_pk_f16_f32 v248, v220, v221
    v_mfma_f32_16x16x32_bf16 v[224:227], v[212:215], v[52:55], v[224:227]
    v_pk_fma_f16 v249, v248, v248, s60
    v_pk_mul_f16 v249, v248, v249 neg_lo:[1,0] neg_hi:[1,0]
    v_mfma_f32_16x16x32_bf16 v[224:227], v[216:219], v[56:59], v[224:227]
    v_exp_f16_sdwa v248, v249 dst_sel:WORD_0 dst_unused:UNUSED_PAD src0_sel:WORD_0
    s_waitcnt lgkmcnt(12)
    v_mfma_f32_16x16x32_bf16 v[228:231], v[196:199], v[60:63], 0
    v_mfma_f32_16x16x32_bf16 v[228:231], v[200:203], v[64:67], v[228:231]
    v_exp_f16_sdwa v248, v249 dst_sel:WORD_1 dst_unused:UNUSED_PRESERVE src0_sel:WORD_1
    v_mfma_f32_16x16x32_bf16 v[228:231], v[204:207], v[68:71], v[228:231]
    v_pk_fma_f16 v248, v248, s61, s61
    v_cvt_pk_f16_f32 v250, v222, v223
    v_mfma_f32_16x16x32_bf16 v[228:231], v[208:211], v[72:75], v[228:231]
    v_rcp_f16_sdwa v249, v248 dst_sel:WORD_0 dst_unused:UNUSED_PAD src0_sel:WORD_0
    v_mfma_f32_16x16x32_bf16 v[228:231], v[212:215], v[76:79], v[228:231]
    v_rcp_f16_sdwa v248, v248 dst_sel:WORD_0 dst_unused:UNUSED_PAD src0_sel:WORD_1
    v_mfma_f32_16x16x32_bf16 v[228:231], v[216:219], v[80:83], v[228:231]
    v_fma_mix_f32 v220, v220, v249, 0 op_sel_hi:[0,1,0]
    v_fma_mix_f32 v221, v221, v248, 0 op_sel_hi:[0,1,0]
    v_mfma_f32_16x16x32_bf16 v[232:235], v[196:199], v[84:87], 0
    v_cvt_pk_bf16_f32 v108, v220, v221
    v_pk_fma_f16 v251, v250, v250, s60
    v_mfma_f32_16x16x32_bf16 v[232:235], v[200:203], v[88:91], v[232:235]
    v_pk_mul_f16 v251, v250, v251 neg_lo:[1,0] neg_hi:[1,0]
    v_cvt_pk_f16_f32 v252, v224, v225
    v_mfma_f32_16x16x32_bf16 v[232:235], v[204:207], v[92:95], v[232:235]
    v_exp_f16_sdwa v250, v251 dst_sel:WORD_0 dst_unused:UNUSED_PAD src0_sel:WORD_0
    v_mfma_f32_16x16x32_bf16 v[232:235], v[208:211], v[96:99], v[232:235]
    v_exp_f16_sdwa v250, v251 dst_sel:WORD_1 dst_unused:UNUSED_PRESERVE src0_sel:WORD_1
    v_mfma_f32_16x16x32_bf16 v[232:235], v[212:215], v[100:103], v[232:235]
    v_pk_fma_f16 v250, v250, s61, s61
    v_pk_fma_f16 v253, v252, v252, s60
    v_mfma_f32_16x16x32_bf16 v[232:235], v[216:219], v[104:107], v[232:235]
    v_rcp_f16_sdwa v251, v250 dst_sel:WORD_0 dst_unused:UNUSED_PAD src0_sel:WORD_0
    s_waitcnt lgkmcnt(0)
    v_mfma_f32_16x16x32_bf16 v[236:239], v[196:199], v[124:127], 0
    v_rcp_f16_sdwa v250, v250 dst_sel:WORD_0 dst_unused:UNUSED_PAD src0_sel:WORD_1
    v_mfma_f32_16x16x32_bf16 v[236:239], v[200:203], v[128:131], v[236:239]
    v_fma_mix_f32 v222, v222, v251, 0 op_sel_hi:[0,1,0]
    v_fma_mix_f32 v223, v223, v250, 0 op_sel_hi:[0,1,0]
    v_mfma_f32_16x16x32_bf16 v[236:239], v[204:207], v[132:135], v[236:239]
    v_cvt_pk_bf16_f32 v109, v222, v223
    v_pk_mul_f16 v253, v252, v253 neg_lo:[1,0] neg_hi:[1,0]
    v_mfma_f32_16x16x32_bf16 v[236:239], v[208:211], v[136:139], v[236:239]
    v_exp_f16_sdwa v252, v253 dst_sel:WORD_0 dst_unused:UNUSED_PAD src0_sel:WORD_0
    v_mfma_f32_16x16x32_bf16 v[236:239], v[212:215], v[140:143], v[236:239]
    v_exp_f16_sdwa v252, v253 dst_sel:WORD_1 dst_unused:UNUSED_PRESERVE src0_sel:WORD_1
    v_mfma_f32_16x16x32_bf16 v[236:239], v[216:219], v[144:147], v[236:239]
    v_pk_fma_f16 v252, v252, s61, s61
    v_cvt_pk_f16_f32 v254, v226, v227
    s_waitcnt lgkmcnt(0)
    s_barrier
.p2align 3
L_P_loop:
    v_mfma_f32_16x16x32_bf16 v[240:243], v[196:199], v[148:151], 0
    v_rcp_f16_sdwa v253, v252 dst_sel:WORD_0 dst_unused:UNUSED_PAD src0_sel:WORD_0
    v_mfma_f32_16x16x32_bf16 v[244:247], v[196:199], v[172:175], 0
    v_rcp_f16_sdwa v252, v252 dst_sel:WORD_0 dst_unused:UNUSED_PAD src0_sel:WORD_1
    v_mfma_f32_16x16x32_bf16 v[240:243], v[200:203], v[152:155], v[240:243]
    ds_read_b64_tr_b16 v[196:197], v1 offset:24576
    v_fma_mix_f32 v224, v224, v253, 0 op_sel_hi:[0,1,0]
    v_mfma_f32_16x16x32_bf16 v[244:247], v[200:203], v[176:179], v[244:247]
    ds_read_b64_tr_b16 v[198:199], v1 offset:24832
    v_fma_mix_f32 v225, v225, v252, 0 op_sel_hi:[0,1,0]
    v_mfma_f32_16x16x32_bf16 v[240:243], v[204:207], v[156:159], v[240:243]
    ds_read_b64_tr_b16 v[200:201], v1 offset:26624
    v_cvt_pk_bf16_f32 v110, v224, v225
    v_mfma_f32_16x16x32_bf16 v[244:247], v[204:207], v[180:183], v[244:247]
    ds_read_b64_tr_b16 v[202:203], v1 offset:26880
    v_pk_fma_f16 v255, v254, v254, s60
    v_mfma_f32_16x16x32_bf16 v[240:243], v[208:211], v[160:163], v[240:243]
    ds_read_b64_tr_b16 v[204:205], v1 offset:28672
    v_pk_mul_f16 v255, v254, v255 neg_lo:[1,0] neg_hi:[1,0]
    v_mfma_f32_16x16x32_bf16 v[244:247], v[208:211], v[184:187], v[244:247]
    ds_read_b64_tr_b16 v[206:207], v1 offset:28928
    v_cvt_pk_f16_f32 v248, v228, v229
    v_mfma_f32_16x16x32_bf16 v[240:243], v[212:215], v[164:167], v[240:243]
    ds_read_b64_tr_b16 v[208:209], v1 offset:30720
    v_pk_fma_f16 v249, v248, v248, s60
    v_mfma_f32_16x16x32_bf16 v[244:247], v[212:215], v[188:191], v[244:247]
    ds_read_b64_tr_b16 v[210:211], v1 offset:30976
    v_pk_mul_f16 v249, v248, v249 neg_lo:[1,0] neg_hi:[1,0]
    v_mfma_f32_16x16x32_bf16 v[240:243], v[216:219], v[168:171], v[240:243]
    ds_read_b64_tr_b16 v[212:213], v1 offset:32768
    v_cvt_pk_f16_f32 v250, v230, v231
    v_mfma_f32_16x16x32_bf16 v[244:247], v[216:219], v[192:195], v[244:247]
    ds_read_b64_tr_b16 v[214:215], v1 offset:33024
    ds_read_b64_tr_b16 v[216:217], v1 offset:34816
    ds_read_b64_tr_b16 v[218:219], v1 offset:35072
    v_exp_f16_sdwa v254, v255 dst_sel:WORD_0 dst_unused:UNUSED_PAD src0_sel:WORD_0
    v_exp_f16_sdwa v248, v249 dst_sel:WORD_0 dst_unused:UNUSED_PAD src0_sel:WORD_0
    v_exp_f16_sdwa v254, v255 dst_sel:WORD_1 dst_unused:UNUSED_PRESERVE src0_sel:WORD_1
    v_exp_f16_sdwa v248, v249 dst_sel:WORD_1 dst_unused:UNUSED_PRESERVE src0_sel:WORD_1
    v_pk_fma_f16 v254, v254, s61, s61
    v_rcp_f16_sdwa v255, v254 dst_sel:WORD_0 dst_unused:UNUSED_PAD src0_sel:WORD_0
    v_pk_fma_f16 v248, v248, s61, s61
    v_rcp_f16_sdwa v254, v254 dst_sel:WORD_0 dst_unused:UNUSED_PAD src0_sel:WORD_1
    v_fma_mix_f32 v226, v226, v255, 0 op_sel_hi:[0,1,0]
    v_fma_mix_f32 v227, v227, v254, 0 op_sel_hi:[0,1,0]
    v_cvt_pk_bf16_f32 v111, v226, v227
    v_rcp_f16_sdwa v249, v248 dst_sel:WORD_0 dst_unused:UNUSED_PAD src0_sel:WORD_0
    v_pk_fma_f16 v251, v250, v250, s60
    v_rcp_f16_sdwa v248, v248 dst_sel:WORD_0 dst_unused:UNUSED_PAD src0_sel:WORD_1
    v_fma_mix_f32 v228, v228, v249, 0 op_sel_hi:[0,1,0]
    v_fma_mix_f32 v229, v229, v248, 0 op_sel_hi:[0,1,0]
    v_cvt_pk_bf16_f32 v112, v228, v229
    v_pk_mul_f16 v251, v250, v251 neg_lo:[1,0] neg_hi:[1,0]
    v_exp_f16_sdwa v250, v251 dst_sel:WORD_0 dst_unused:UNUSED_PAD src0_sel:WORD_0
    v_cvt_pk_f16_f32 v252, v232, v233
    v_exp_f16_sdwa v250, v251 dst_sel:WORD_1 dst_unused:UNUSED_PRESERVE src0_sel:WORD_1
    v_pk_fma_f16 v253, v252, v252, s60
    v_pk_fma_f16 v250, v250, s61, s61
    v_rcp_f16_sdwa v251, v250 dst_sel:WORD_0 dst_unused:UNUSED_PAD src0_sel:WORD_0
    v_pk_mul_f16 v253, v252, v253 neg_lo:[1,0] neg_hi:[1,0]
    v_rcp_f16_sdwa v250, v250 dst_sel:WORD_0 dst_unused:UNUSED_PAD src0_sel:WORD_1
    v_fma_mix_f32 v230, v230, v251, 0 op_sel_hi:[0,1,0]
    v_fma_mix_f32 v231, v231, v250, 0 op_sel_hi:[0,1,0]
    v_cvt_pk_bf16_f32 v113, v230, v231
    v_exp_f16_sdwa v252, v253 dst_sel:WORD_0 dst_unused:UNUSED_PAD src0_sel:WORD_0
    v_cvt_pk_f16_f32 v254, v234, v235
    v_exp_f16_sdwa v252, v253 dst_sel:WORD_1 dst_unused:UNUSED_PRESERVE src0_sel:WORD_1
    v_pk_fma_f16 v255, v254, v254, s60
    v_pk_fma_f16 v252, v252, s61, s61
    v_rcp_f16_sdwa v253, v252 dst_sel:WORD_0 dst_unused:UNUSED_PAD src0_sel:WORD_0
    v_pk_mul_f16 v255, v254, v255 neg_lo:[1,0] neg_hi:[1,0]
    v_rcp_f16_sdwa v252, v252 dst_sel:WORD_0 dst_unused:UNUSED_PAD src0_sel:WORD_1
    v_fma_mix_f32 v232, v232, v253, 0 op_sel_hi:[0,1,0]
    v_fma_mix_f32 v233, v233, v252, 0 op_sel_hi:[0,1,0]
    v_cvt_pk_bf16_f32 v114, v232, v233
    v_exp_f16_sdwa v254, v255 dst_sel:WORD_0 dst_unused:UNUSED_PAD src0_sel:WORD_0
    v_cvt_pk_f16_f32 v248, v236, v237
    v_exp_f16_sdwa v254, v255 dst_sel:WORD_1 dst_unused:UNUSED_PRESERVE src0_sel:WORD_1
    v_pk_fma_f16 v249, v248, v248, s60
    v_pk_fma_f16 v254, v254, s61, s61
    v_rcp_f16_sdwa v255, v254 dst_sel:WORD_0 dst_unused:UNUSED_PAD src0_sel:WORD_0
    v_pk_mul_f16 v249, v248, v249 neg_lo:[1,0] neg_hi:[1,0]
    v_rcp_f16_sdwa v254, v254 dst_sel:WORD_0 dst_unused:UNUSED_PAD src0_sel:WORD_1
    v_fma_mix_f32 v234, v234, v255, 0 op_sel_hi:[0,1,0]
    v_fma_mix_f32 v235, v235, v254, 0 op_sel_hi:[0,1,0]
    v_cvt_pk_bf16_f32 v115, v234, v235
    v_exp_f16_sdwa v248, v249 dst_sel:WORD_0 dst_unused:UNUSED_PAD src0_sel:WORD_0
    v_cvt_pk_f16_f32 v250, v238, v239
    v_exp_f16_sdwa v248, v249 dst_sel:WORD_1 dst_unused:UNUSED_PRESERVE src0_sel:WORD_1
    v_pk_fma_f16 v251, v250, v250, s60
    v_pk_fma_f16 v248, v248, s61, s61
    v_rcp_f16_sdwa v249, v248 dst_sel:WORD_0 dst_unused:UNUSED_PAD src0_sel:WORD_0
    v_pk_mul_f16 v251, v250, v251 neg_lo:[1,0] neg_hi:[1,0]
    v_rcp_f16_sdwa v248, v248 dst_sel:WORD_0 dst_unused:UNUSED_PAD src0_sel:WORD_1
    v_fma_mix_f32 v236, v236, v249, 0 op_sel_hi:[0,1,0]
    v_fma_mix_f32 v237, v237, v248, 0 op_sel_hi:[0,1,0]
    v_cvt_pk_bf16_f32 v116, v236, v237
    v_exp_f16_sdwa v250, v251 dst_sel:WORD_0 dst_unused:UNUSED_PAD src0_sel:WORD_0
    v_cvt_pk_f16_f32 v252, v240, v241
    v_exp_f16_sdwa v250, v251 dst_sel:WORD_1 dst_unused:UNUSED_PRESERVE src0_sel:WORD_1
    v_pk_fma_f16 v253, v252, v252, s60
    v_pk_fma_f16 v250, v250, s61, s61
    v_rcp_f16_sdwa v251, v250 dst_sel:WORD_0 dst_unused:UNUSED_PAD src0_sel:WORD_0
    v_pk_mul_f16 v253, v252, v253 neg_lo:[1,0] neg_hi:[1,0]
    v_rcp_f16_sdwa v250, v250 dst_sel:WORD_0 dst_unused:UNUSED_PAD src0_sel:WORD_1
    v_fma_mix_f32 v238, v238, v251, 0 op_sel_hi:[0,1,0]
    v_fma_mix_f32 v239, v239, v250, 0 op_sel_hi:[0,1,0]
    v_cvt_pk_bf16_f32 v117, v238, v239
    v_exp_f16_sdwa v252, v253 dst_sel:WORD_0 dst_unused:UNUSED_PAD src0_sel:WORD_0
    v_cvt_pk_f16_f32 v254, v242, v243
    v_exp_f16_sdwa v252, v253 dst_sel:WORD_1 dst_unused:UNUSED_PRESERVE src0_sel:WORD_1
    v_pk_fma_f16 v255, v254, v254, s60
    v_pk_fma_f16 v252, v252, s61, s61
    v_rcp_f16_sdwa v253, v252 dst_sel:WORD_0 dst_unused:UNUSED_PAD src0_sel:WORD_0
    v_pk_mul_f16 v255, v254, v255 neg_lo:[1,0] neg_hi:[1,0]
    v_rcp_f16_sdwa v252, v252 dst_sel:WORD_0 dst_unused:UNUSED_PAD src0_sel:WORD_1
    v_fma_mix_f32 v240, v240, v253, 0 op_sel_hi:[0,1,0]
    v_fma_mix_f32 v241, v241, v252, 0 op_sel_hi:[0,1,0]
    v_cvt_pk_bf16_f32 v118, v240, v241
    v_exp_f16_sdwa v254, v255 dst_sel:WORD_0 dst_unused:UNUSED_PAD src0_sel:WORD_0
    v_cvt_pk_f16_f32 v248, v244, v245
    v_exp_f16_sdwa v254, v255 dst_sel:WORD_1 dst_unused:UNUSED_PRESERVE src0_sel:WORD_1
    v_pk_fma_f16 v249, v248, v248, s60
    v_pk_fma_f16 v254, v254, s61, s61
    v_rcp_f16_sdwa v255, v254 dst_sel:WORD_0 dst_unused:UNUSED_PAD src0_sel:WORD_0
    v_pk_mul_f16 v249, v248, v249 neg_lo:[1,0] neg_hi:[1,0]
    v_rcp_f16_sdwa v254, v254 dst_sel:WORD_0 dst_unused:UNUSED_PAD src0_sel:WORD_1
    v_fma_mix_f32 v242, v242, v255, 0 op_sel_hi:[0,1,0]
    v_fma_mix_f32 v243, v243, v254, 0 op_sel_hi:[0,1,0]
    v_cvt_pk_bf16_f32 v119, v242, v243
    v_exp_f16_sdwa v248, v249 dst_sel:WORD_0 dst_unused:UNUSED_PAD src0_sel:WORD_0
    v_cvt_pk_f16_f32 v250, v246, v247
    v_exp_f16_sdwa v248, v249 dst_sel:WORD_1 dst_unused:UNUSED_PRESERVE src0_sel:WORD_1
    v_pk_fma_f16 v251, v250, v250, s60
    v_pk_fma_f16 v248, v248, s61, s61
    v_rcp_f16_sdwa v249, v248 dst_sel:WORD_0 dst_unused:UNUSED_PAD src0_sel:WORD_0
    v_pk_mul_f16 v251, v250, v251 neg_lo:[1,0] neg_hi:[1,0]
    v_rcp_f16_sdwa v248, v248 dst_sel:WORD_0 dst_unused:UNUSED_PAD src0_sel:WORD_1
    v_fma_mix_f32 v244, v244, v249, 0 op_sel_hi:[0,1,0]
    v_fma_mix_f32 v245, v245, v248, 0 op_sel_hi:[0,1,0]
    v_cvt_pk_bf16_f32 v120, v244, v245
    s_waitcnt lgkmcnt(0)
    v_mfma_f32_16x16x32_bf16 v[220:223], v[196:199], v[12:15], 0
    ds_write2st64_b64 v2, v[108:109], v[110:111] offset0:0 offset1:1
    v_mfma_f32_16x16x32_bf16 v[220:223], v[200:203], v[16:19], v[220:223]
    v_exp_f16_sdwa v250, v251 dst_sel:WORD_0 dst_unused:UNUSED_PAD src0_sel:WORD_0
    v_mfma_f32_16x16x32_bf16 v[220:223], v[204:207], v[20:23], v[220:223]
    v_exp_f16_sdwa v250, v251 dst_sel:WORD_1 dst_unused:UNUSED_PRESERVE src0_sel:WORD_1
    v_mfma_f32_16x16x32_bf16 v[220:223], v[208:211], v[24:27], v[220:223]
    v_pk_fma_f16 v250, v250, s61, s61
    v_mfma_f32_16x16x32_bf16 v[220:223], v[212:215], v[28:31], v[220:223]
    v_rcp_f16_sdwa v251, v250 dst_sel:WORD_0 dst_unused:UNUSED_PAD src0_sel:WORD_0
    v_mfma_f32_16x16x32_bf16 v[220:223], v[216:219], v[32:35], v[220:223]
    v_rcp_f16_sdwa v250, v250 dst_sel:WORD_0 dst_unused:UNUSED_PAD src0_sel:WORD_1
    v_mfma_f32_16x16x32_bf16 v[224:227], v[196:199], v[36:39], 0
    ds_write2st64_b64 v2, v[112:113], v[114:115] offset0:8 offset1:9
    v_mfma_f32_16x16x32_bf16 v[224:227], v[200:203], v[40:43], v[224:227]
    v_fma_mix_f32 v246, v246, v251, 0 op_sel_hi:[0,1,0]
    v_fma_mix_f32 v247, v247, v250, 0 op_sel_hi:[0,1,0]
    v_mfma_f32_16x16x32_bf16 v[224:227], v[204:207], v[44:47], v[224:227]
    v_cvt_pk_bf16_f32 v121, v246, v247
    v_cvt_pk_f16_f32 v248, v220, v221
    v_mfma_f32_16x16x32_bf16 v[224:227], v[208:211], v[48:51], v[224:227]
    v_pk_fma_f16 v249, v248, v248, s60
    v_pk_mul_f16 v249, v248, v249 neg_lo:[1,0] neg_hi:[1,0]
    v_mfma_f32_16x16x32_bf16 v[224:227], v[212:215], v[52:55], v[224:227]
    v_exp_f16_sdwa v248, v249 dst_sel:WORD_0 dst_unused:UNUSED_PAD src0_sel:WORD_0
    v_mfma_f32_16x16x32_bf16 v[224:227], v[216:219], v[56:59], v[224:227]
    v_exp_f16_sdwa v248, v249 dst_sel:WORD_1 dst_unused:UNUSED_PRESERVE src0_sel:WORD_1
    v_mfma_f32_16x16x32_bf16 v[228:231], v[196:199], v[60:63], 0
    ds_write2st64_b64 v2, v[116:117], v[118:119] offset0:16 offset1:17
    v_mfma_f32_16x16x32_bf16 v[228:231], v[200:203], v[64:67], v[228:231]
    v_pk_fma_f16 v248, v248, s61, s61
    v_cvt_pk_f16_f32 v250, v222, v223
    v_mfma_f32_16x16x32_bf16 v[228:231], v[204:207], v[68:71], v[228:231]
    v_rcp_f16_sdwa v249, v248 dst_sel:WORD_0 dst_unused:UNUSED_PAD src0_sel:WORD_0
    v_mfma_f32_16x16x32_bf16 v[228:231], v[208:211], v[72:75], v[228:231]
    v_rcp_f16_sdwa v248, v248 dst_sel:WORD_0 dst_unused:UNUSED_PAD src0_sel:WORD_1
    v_mfma_f32_16x16x32_bf16 v[228:231], v[212:215], v[76:79], v[228:231]
    v_fma_mix_f32 v220, v220, v249, 0 op_sel_hi:[0,1,0]
    v_fma_mix_f32 v221, v221, v248, 0 op_sel_hi:[0,1,0]
    v_mfma_f32_16x16x32_bf16 v[228:231], v[216:219], v[80:83], v[228:231]
    v_cvt_pk_bf16_f32 v108, v220, v221
    v_pk_fma_f16 v251, v250, v250, s60
    v_mfma_f32_16x16x32_bf16 v[232:235], v[196:199], v[84:87], 0
    ds_write_b64 v3, v[120:121] offset:0
    v_mfma_f32_16x16x32_bf16 v[232:235], v[200:203], v[88:91], v[232:235]
    v_pk_mul_f16 v251, v250, v251 neg_lo:[1,0] neg_hi:[1,0]
    v_cvt_pk_f16_f32 v252, v224, v225
    v_mfma_f32_16x16x32_bf16 v[232:235], v[204:207], v[92:95], v[232:235]
    v_exp_f16_sdwa v250, v251 dst_sel:WORD_0 dst_unused:UNUSED_PAD src0_sel:WORD_0
    v_mfma_f32_16x16x32_bf16 v[232:235], v[208:211], v[96:99], v[232:235]
    v_exp_f16_sdwa v250, v251 dst_sel:WORD_1 dst_unused:UNUSED_PRESERVE src0_sel:WORD_1
    v_mfma_f32_16x16x32_bf16 v[232:235], v[212:215], v[100:103], v[232:235]
    v_pk_fma_f16 v250, v250, s61, s61
    v_pk_fma_f16 v253, v252, v252, s60
    v_mfma_f32_16x16x32_bf16 v[232:235], v[216:219], v[104:107], v[232:235]
    v_rcp_f16_sdwa v251, v250 dst_sel:WORD_0 dst_unused:UNUSED_PAD src0_sel:WORD_0
    s_waitcnt lgkmcnt(0)
    s_barrier
    v_mfma_f32_16x16x32_bf16 v[236:239], v[196:199], v[124:127], 0
    v_rcp_f16_sdwa v250, v250 dst_sel:WORD_0 dst_unused:UNUSED_PAD src0_sel:WORD_1
    v_mfma_f32_16x16x32_bf16 v[240:243], v[196:199], v[148:151], 0
    v_fma_mix_f32 v222, v222, v251, 0 op_sel_hi:[0,1,0]
    v_fma_mix_f32 v223, v223, v250, 0 op_sel_hi:[0,1,0]
    v_mfma_f32_16x16x32_bf16 v[236:239], v[200:203], v[128:131], v[236:239]
    ds_read_b64_tr_b16 v[196:197], v1 offset:0
    v_cvt_pk_bf16_f32 v109, v222, v223
    v_mfma_f32_16x16x32_bf16 v[240:243], v[200:203], v[152:155], v[240:243]
    ds_read_b64_tr_b16 v[198:199], v1 offset:256
    v_pk_mul_f16 v253, v252, v253 neg_lo:[1,0] neg_hi:[1,0]
    v_mfma_f32_16x16x32_bf16 v[236:239], v[204:207], v[132:135], v[236:239]
    ds_read_b64_tr_b16 v[200:201], v1 offset:2048
    v_cvt_pk_f16_f32 v254, v226, v227
    v_mfma_f32_16x16x32_bf16 v[240:243], v[204:207], v[156:159], v[240:243]
    ds_read_b64_tr_b16 v[202:203], v1 offset:2304
    v_pk_fma_f16 v255, v254, v254, s60
    v_mfma_f32_16x16x32_bf16 v[236:239], v[208:211], v[136:139], v[236:239]
    ds_read_b64_tr_b16 v[204:205], v1 offset:4096
    v_pk_mul_f16 v255, v254, v255 neg_lo:[1,0] neg_hi:[1,0]
    v_mfma_f32_16x16x32_bf16 v[240:243], v[208:211], v[160:163], v[240:243]
    ds_read_b64_tr_b16 v[206:207], v1 offset:4352
    v_cvt_pk_f16_f32 v248, v228, v229
    v_mfma_f32_16x16x32_bf16 v[236:239], v[212:215], v[140:143], v[236:239]
    ds_read_b64_tr_b16 v[208:209], v1 offset:6144
    v_pk_fma_f16 v249, v248, v248, s60
    v_mfma_f32_16x16x32_bf16 v[240:243], v[212:215], v[164:167], v[240:243]
    ds_read_b64_tr_b16 v[210:211], v1 offset:6400
    v_pk_mul_f16 v249, v248, v249 neg_lo:[1,0] neg_hi:[1,0]
    v_mfma_f32_16x16x32_bf16 v[236:239], v[216:219], v[144:147], v[236:239]
    ds_read_b64_tr_b16 v[212:213], v1 offset:8192
    v_mfma_f32_16x16x32_bf16 v[240:243], v[216:219], v[168:171], v[240:243]
    ds_read_b64_tr_b16 v[214:215], v1 offset:8448
    ds_read_b64_tr_b16 v[216:217], v1 offset:10240
    ds_read_b64_tr_b16 v[218:219], v1 offset:10496
    v_exp_f16_sdwa v252, v253 dst_sel:WORD_0 dst_unused:UNUSED_PAD src0_sel:WORD_0
    v_exp_f16_sdwa v254, v255 dst_sel:WORD_0 dst_unused:UNUSED_PAD src0_sel:WORD_0
    v_exp_f16_sdwa v252, v253 dst_sel:WORD_1 dst_unused:UNUSED_PRESERVE src0_sel:WORD_1
    v_exp_f16_sdwa v254, v255 dst_sel:WORD_1 dst_unused:UNUSED_PRESERVE src0_sel:WORD_1
    v_pk_fma_f16 v252, v252, s61, s61
    v_rcp_f16_sdwa v253, v252 dst_sel:WORD_0 dst_unused:UNUSED_PAD src0_sel:WORD_0
    v_pk_fma_f16 v254, v254, s61, s61
    v_rcp_f16_sdwa v252, v252 dst_sel:WORD_0 dst_unused:UNUSED_PAD src0_sel:WORD_1
    v_fma_mix_f32 v224, v224, v253, 0 op_sel_hi:[0,1,0]
    v_fma_mix_f32 v225, v225, v252, 0 op_sel_hi:[0,1,0]
    v_cvt_pk_bf16_f32 v110, v224, v225
    v_rcp_f16_sdwa v255, v254 dst_sel:WORD_0 dst_unused:UNUSED_PAD src0_sel:WORD_0
    v_exp_f16_sdwa v248, v249 dst_sel:WORD_0 dst_unused:UNUSED_PAD src0_sel:WORD_0
    v_rcp_f16_sdwa v254, v254 dst_sel:WORD_0 dst_unused:UNUSED_PAD src0_sel:WORD_1
    v_fma_mix_f32 v226, v226, v255, 0 op_sel_hi:[0,1,0]
    v_fma_mix_f32 v227, v227, v254, 0 op_sel_hi:[0,1,0]
    v_cvt_pk_bf16_f32 v111, v226, v227
    v_exp_f16_sdwa v248, v249 dst_sel:WORD_1 dst_unused:UNUSED_PRESERVE src0_sel:WORD_1
    v_cvt_pk_f16_f32 v250, v230, v231
    v_pk_fma_f16 v248, v248, s61, s61
    v_rcp_f16_sdwa v249, v248 dst_sel:WORD_0 dst_unused:UNUSED_PAD src0_sel:WORD_0
    v_pk_fma_f16 v251, v250, v250, s60
    v_rcp_f16_sdwa v248, v248 dst_sel:WORD_0 dst_unused:UNUSED_PAD src0_sel:WORD_1
    v_fma_mix_f32 v228, v228, v249, 0 op_sel_hi:[0,1,0]
    v_fma_mix_f32 v229, v229, v248, 0 op_sel_hi:[0,1,0]
    v_cvt_pk_bf16_f32 v112, v228, v229
    v_pk_mul_f16 v251, v250, v251 neg_lo:[1,0] neg_hi:[1,0]
    v_exp_f16_sdwa v250, v251 dst_sel:WORD_0 dst_unused:UNUSED_PAD src0_sel:WORD_0
    v_cvt_pk_f16_f32 v252, v232, v233
    v_exp_f16_sdwa v250, v251 dst_sel:WORD_1 dst_unused:UNUSED_PRESERVE src0_sel:WORD_1
    v_pk_fma_f16 v253, v252, v252, s60
    v_pk_fma_f16 v250, v250, s61, s61
    v_rcp_f16_sdwa v251, v250 dst_sel:WORD_0 dst_unused:UNUSED_PAD src0_sel:WORD_0
    v_pk_mul_f16 v253, v252, v253 neg_lo:[1,0] neg_hi:[1,0]
    v_rcp_f16_sdwa v250, v250 dst_sel:WORD_0 dst_unused:UNUSED_PAD src0_sel:WORD_1
    v_fma_mix_f32 v230, v230, v251, 0 op_sel_hi:[0,1,0]
    v_fma_mix_f32 v231, v231, v250, 0 op_sel_hi:[0,1,0]
    v_cvt_pk_bf16_f32 v113, v230, v231
    v_exp_f16_sdwa v252, v253 dst_sel:WORD_0 dst_unused:UNUSED_PAD src0_sel:WORD_0
    v_cvt_pk_f16_f32 v254, v234, v235
    v_exp_f16_sdwa v252, v253 dst_sel:WORD_1 dst_unused:UNUSED_PRESERVE src0_sel:WORD_1
    v_pk_fma_f16 v255, v254, v254, s60
    v_pk_fma_f16 v252, v252, s61, s61
    v_rcp_f16_sdwa v253, v252 dst_sel:WORD_0 dst_unused:UNUSED_PAD src0_sel:WORD_0
    v_pk_mul_f16 v255, v254, v255 neg_lo:[1,0] neg_hi:[1,0]
    v_rcp_f16_sdwa v252, v252 dst_sel:WORD_0 dst_unused:UNUSED_PAD src0_sel:WORD_1
    v_fma_mix_f32 v232, v232, v253, 0 op_sel_hi:[0,1,0]
    v_fma_mix_f32 v233, v233, v252, 0 op_sel_hi:[0,1,0]
    v_cvt_pk_bf16_f32 v114, v232, v233
    v_exp_f16_sdwa v254, v255 dst_sel:WORD_0 dst_unused:UNUSED_PAD src0_sel:WORD_0
    v_cvt_pk_f16_f32 v248, v236, v237
    v_exp_f16_sdwa v254, v255 dst_sel:WORD_1 dst_unused:UNUSED_PRESERVE src0_sel:WORD_1
    v_pk_fma_f16 v249, v248, v248, s60
    v_pk_fma_f16 v254, v254, s61, s61
    v_rcp_f16_sdwa v255, v254 dst_sel:WORD_0 dst_unused:UNUSED_PAD src0_sel:WORD_0
    v_pk_mul_f16 v249, v248, v249 neg_lo:[1,0] neg_hi:[1,0]
    v_rcp_f16_sdwa v254, v254 dst_sel:WORD_0 dst_unused:UNUSED_PAD src0_sel:WORD_1
    v_fma_mix_f32 v234, v234, v255, 0 op_sel_hi:[0,1,0]
    v_fma_mix_f32 v235, v235, v254, 0 op_sel_hi:[0,1,0]
    v_cvt_pk_bf16_f32 v115, v234, v235
    v_exp_f16_sdwa v248, v249 dst_sel:WORD_0 dst_unused:UNUSED_PAD src0_sel:WORD_0
    v_cvt_pk_f16_f32 v250, v238, v239
    v_exp_f16_sdwa v248, v249 dst_sel:WORD_1 dst_unused:UNUSED_PRESERVE src0_sel:WORD_1
    v_pk_fma_f16 v251, v250, v250, s60
    v_pk_fma_f16 v248, v248, s61, s61
    v_rcp_f16_sdwa v249, v248 dst_sel:WORD_0 dst_unused:UNUSED_PAD src0_sel:WORD_0
    v_pk_mul_f16 v251, v250, v251 neg_lo:[1,0] neg_hi:[1,0]
    v_rcp_f16_sdwa v248, v248 dst_sel:WORD_0 dst_unused:UNUSED_PAD src0_sel:WORD_1
    v_fma_mix_f32 v236, v236, v249, 0 op_sel_hi:[0,1,0]
    v_fma_mix_f32 v237, v237, v248, 0 op_sel_hi:[0,1,0]
    v_cvt_pk_bf16_f32 v116, v236, v237
    v_exp_f16_sdwa v250, v251 dst_sel:WORD_0 dst_unused:UNUSED_PAD src0_sel:WORD_0
    v_cvt_pk_f16_f32 v252, v240, v241
    v_exp_f16_sdwa v250, v251 dst_sel:WORD_1 dst_unused:UNUSED_PRESERVE src0_sel:WORD_1
    v_pk_fma_f16 v253, v252, v252, s60
    v_pk_fma_f16 v250, v250, s61, s61
    v_rcp_f16_sdwa v251, v250 dst_sel:WORD_0 dst_unused:UNUSED_PAD src0_sel:WORD_0
    v_pk_mul_f16 v253, v252, v253 neg_lo:[1,0] neg_hi:[1,0]
    v_rcp_f16_sdwa v250, v250 dst_sel:WORD_0 dst_unused:UNUSED_PAD src0_sel:WORD_1
    v_fma_mix_f32 v238, v238, v251, 0 op_sel_hi:[0,1,0]
    v_fma_mix_f32 v239, v239, v250, 0 op_sel_hi:[0,1,0]
    v_cvt_pk_bf16_f32 v117, v238, v239
    v_exp_f16_sdwa v252, v253 dst_sel:WORD_0 dst_unused:UNUSED_PAD src0_sel:WORD_0
    v_cvt_pk_f16_f32 v254, v242, v243
    v_exp_f16_sdwa v252, v253 dst_sel:WORD_1 dst_unused:UNUSED_PRESERVE src0_sel:WORD_1
    v_pk_fma_f16 v255, v254, v254, s60
    v_pk_fma_f16 v252, v252, s61, s61
    v_rcp_f16_sdwa v253, v252 dst_sel:WORD_0 dst_unused:UNUSED_PAD src0_sel:WORD_0
    v_pk_mul_f16 v255, v254, v255 neg_lo:[1,0] neg_hi:[1,0]
    v_rcp_f16_sdwa v252, v252 dst_sel:WORD_0 dst_unused:UNUSED_PAD src0_sel:WORD_1
    s_waitcnt lgkmcnt(0)
    v_mfma_f32_16x16x32_bf16 v[220:223], v[196:199], v[12:15], 0
    ds_write2st64_b64 v2, v[108:109], v[110:111] offset0:26 offset1:27
    v_mfma_f32_16x16x32_bf16 v[220:223], v[200:203], v[16:19], v[220:223]
    v_exp_f16_sdwa v254, v255 dst_sel:WORD_0 dst_unused:UNUSED_PAD src0_sel:WORD_0
    v_mfma_f32_16x16x32_bf16 v[220:223], v[204:207], v[20:23], v[220:223]
    v_exp_f16_sdwa v254, v255 dst_sel:WORD_1 dst_unused:UNUSED_PRESERVE src0_sel:WORD_1
    v_mfma_f32_16x16x32_bf16 v[220:223], v[208:211], v[24:27], v[220:223]
    v_fma_mix_f32 v240, v240, v253, 0 op_sel_hi:[0,1,0]
    v_fma_mix_f32 v241, v241, v252, 0 op_sel_hi:[0,1,0]
    v_mfma_f32_16x16x32_bf16 v[220:223], v[212:215], v[28:31], v[220:223]
    v_cvt_pk_bf16_f32 v118, v240, v241
    v_pk_fma_f16 v254, v254, s61, s61
    v_mfma_f32_16x16x32_bf16 v[220:223], v[216:219], v[32:35], v[220:223]
    v_rcp_f16_sdwa v255, v254 dst_sel:WORD_0 dst_unused:UNUSED_PAD src0_sel:WORD_0
    v_mfma_f32_16x16x32_bf16 v[224:227], v[196:199], v[36:39], 0
    ds_write2st64_b64 v2, v[112:113], v[114:115] offset0:34 offset1:35
    v_mfma_f32_16x16x32_bf16 v[224:227], v[200:203], v[40:43], v[224:227]
    v_rcp_f16_sdwa v254, v254 dst_sel:WORD_0 dst_unused:UNUSED_PAD src0_sel:WORD_1
    v_mfma_f32_16x16x32_bf16 v[224:227], v[204:207], v[44:47], v[224:227]
    v_fma_mix_f32 v242, v242, v255, 0 op_sel_hi:[0,1,0]
    v_fma_mix_f32 v243, v243, v254, 0 op_sel_hi:[0,1,0]
    v_mfma_f32_16x16x32_bf16 v[224:227], v[208:211], v[48:51], v[224:227]
    v_cvt_pk_bf16_f32 v119, v242, v243
    v_cvt_pk_f16_f32 v248, v220, v221
    v_mfma_f32_16x16x32_bf16 v[224:227], v[212:215], v[52:55], v[224:227]
    v_pk_fma_f16 v249, v248, v248, s60
    v_pk_mul_f16 v249, v248, v249 neg_lo:[1,0] neg_hi:[1,0]
    v_mfma_f32_16x16x32_bf16 v[224:227], v[216:219], v[56:59], v[224:227]
    v_exp_f16_sdwa v248, v249 dst_sel:WORD_0 dst_unused:UNUSED_PAD src0_sel:WORD_0
    v_mfma_f32_16x16x32_bf16 v[228:231], v[196:199], v[60:63], 0
    ds_write2st64_b64 v2, v[116:117], v[118:119] offset0:42 offset1:43
    v_mfma_f32_16x16x32_bf16 v[228:231], v[200:203], v[64:67], v[228:231]
    v_exp_f16_sdwa v248, v249 dst_sel:WORD_1 dst_unused:UNUSED_PRESERVE src0_sel:WORD_1
    v_mfma_f32_16x16x32_bf16 v[228:231], v[204:207], v[68:71], v[228:231]
    v_pk_fma_f16 v248, v248, s61, s61
    v_cvt_pk_f16_f32 v250, v222, v223
    v_mfma_f32_16x16x32_bf16 v[228:231], v[208:211], v[72:75], v[228:231]
    v_rcp_f16_sdwa v249, v248 dst_sel:WORD_0 dst_unused:UNUSED_PAD src0_sel:WORD_0
    v_mfma_f32_16x16x32_bf16 v[228:231], v[212:215], v[76:79], v[228:231]
    v_rcp_f16_sdwa v248, v248 dst_sel:WORD_0 dst_unused:UNUSED_PAD src0_sel:WORD_1
    v_mfma_f32_16x16x32_bf16 v[228:231], v[216:219], v[80:83], v[228:231]
    v_fma_mix_f32 v220, v220, v249, 0 op_sel_hi:[0,1,0]
    v_fma_mix_f32 v221, v221, v248, 0 op_sel_hi:[0,1,0]
    v_mfma_f32_16x16x32_bf16 v[232:235], v[196:199], v[84:87], 0
    v_cvt_pk_bf16_f32 v108, v220, v221
    v_pk_fma_f16 v251, v250, v250, s60
    v_mfma_f32_16x16x32_bf16 v[232:235], v[200:203], v[88:91], v[232:235]
    v_pk_mul_f16 v251, v250, v251 neg_lo:[1,0] neg_hi:[1,0]
    v_cvt_pk_f16_f32 v252, v224, v225
    v_mfma_f32_16x16x32_bf16 v[232:235], v[204:207], v[92:95], v[232:235]
    v_exp_f16_sdwa v250, v251 dst_sel:WORD_0 dst_unused:UNUSED_PAD src0_sel:WORD_0
    v_mfma_f32_16x16x32_bf16 v[232:235], v[208:211], v[96:99], v[232:235]
    v_exp_f16_sdwa v250, v251 dst_sel:WORD_1 dst_unused:UNUSED_PRESERVE src0_sel:WORD_1
    v_mfma_f32_16x16x32_bf16 v[232:235], v[212:215], v[100:103], v[232:235]
    v_pk_fma_f16 v250, v250, s61, s61
    v_pk_fma_f16 v253, v252, v252, s60
    v_mfma_f32_16x16x32_bf16 v[232:235], v[216:219], v[104:107], v[232:235]
    v_rcp_f16_sdwa v251, v250 dst_sel:WORD_0 dst_unused:UNUSED_PAD src0_sel:WORD_0
    v_mfma_f32_16x16x32_bf16 v[236:239], v[196:199], v[124:127], 0
    v_rcp_f16_sdwa v250, v250 dst_sel:WORD_0 dst_unused:UNUSED_PAD src0_sel:WORD_1
    v_mfma_f32_16x16x32_bf16 v[236:239], v[200:203], v[128:131], v[236:239]
    v_fma_mix_f32 v222, v222, v251, 0 op_sel_hi:[0,1,0]
    v_fma_mix_f32 v223, v223, v250, 0 op_sel_hi:[0,1,0]
    v_mfma_f32_16x16x32_bf16 v[236:239], v[204:207], v[132:135], v[236:239]
    v_cvt_pk_bf16_f32 v109, v222, v223
    v_pk_mul_f16 v253, v252, v253 neg_lo:[1,0] neg_hi:[1,0]
    v_mfma_f32_16x16x32_bf16 v[236:239], v[208:211], v[136:139], v[236:239]
    v_exp_f16_sdwa v252, v253 dst_sel:WORD_0 dst_unused:UNUSED_PAD src0_sel:WORD_0
    v_mfma_f32_16x16x32_bf16 v[236:239], v[212:215], v[140:143], v[236:239]
    v_exp_f16_sdwa v252, v253 dst_sel:WORD_1 dst_unused:UNUSED_PRESERVE src0_sel:WORD_1
    v_mfma_f32_16x16x32_bf16 v[236:239], v[216:219], v[144:147], v[236:239]
    v_pk_fma_f16 v252, v252, s61, s61
    v_cvt_pk_f16_f32 v254, v226, v227
    s_add_u32 s64, s64, 1
    s_cmp_eq_u32 s64, 8
    s_waitcnt lgkmcnt(0)
    s_barrier
    s_cbranch_scc1 L_P_last1
    v_mfma_f32_16x16x32_bf16 v[240:243], v[196:199], v[148:151], 0
    v_rcp_f16_sdwa v253, v252 dst_sel:WORD_0 dst_unused:UNUSED_PAD src0_sel:WORD_0
    v_mfma_f32_16x16x32_bf16 v[244:247], v[196:199], v[172:175], 0
    v_rcp_f16_sdwa v252, v252 dst_sel:WORD_0 dst_unused:UNUSED_PAD src0_sel:WORD_1
    v_mfma_f32_16x16x32_bf16 v[240:243], v[200:203], v[152:155], v[240:243]
    ds_read_b64_tr_b16 v[196:197], v1 offset:12288
    v_fma_mix_f32 v224, v224, v253, 0 op_sel_hi:[0,1,0]
    v_mfma_f32_16x16x32_bf16 v[244:247], v[200:203], v[176:179], v[244:247]
    ds_read_b64_tr_b16 v[198:199], v1 offset:12544
    v_fma_mix_f32 v225, v225, v252, 0 op_sel_hi:[0,1,0]
    v_mfma_f32_16x16x32_bf16 v[240:243], v[204:207], v[156:159], v[240:243]
    ds_read_b64_tr_b16 v[200:201], v1 offset:14336
    v_cvt_pk_bf16_f32 v110, v224, v225
    v_mfma_f32_16x16x32_bf16 v[244:247], v[204:207], v[180:183], v[244:247]
    ds_read_b64_tr_b16 v[202:203], v1 offset:14592
    v_pk_fma_f16 v255, v254, v254, s60
    v_mfma_f32_16x16x32_bf16 v[240:243], v[208:211], v[160:163], v[240:243]
    ds_read_b64_tr_b16 v[204:205], v1 offset:16384
    v_pk_mul_f16 v255, v254, v255 neg_lo:[1,0] neg_hi:[1,0]
    v_mfma_f32_16x16x32_bf16 v[244:247], v[208:211], v[184:187], v[244:247]
    ds_read_b64_tr_b16 v[206:207], v1 offset:16640
    v_cvt_pk_f16_f32 v248, v228, v229
    v_mfma_f32_16x16x32_bf16 v[240:243], v[212:215], v[164:167], v[240:243]
    ds_read_b64_tr_b16 v[208:209], v1 offset:18432
    v_pk_fma_f16 v249, v248, v248, s60
    v_mfma_f32_16x16x32_bf16 v[244:247], v[212:215], v[188:191], v[244:247]
    ds_read_b64_tr_b16 v[210:211], v1 offset:18688
    v_pk_mul_f16 v249, v248, v249 neg_lo:[1,0] neg_hi:[1,0]
    v_mfma_f32_16x16x32_bf16 v[240:243], v[216:219], v[168:171], v[240:243]
    ds_read_b64_tr_b16 v[212:213], v1 offset:20480
    v_cvt_pk_f16_f32 v250, v230, v231
    v_mfma_f32_16x16x32_bf16 v[244:247], v[216:219], v[192:195], v[244:247]
    ds_read_b64_tr_b16 v[214:215], v1 offset:20736
    ds_read_b64_tr_b16 v[216:217], v1 offset:22528
    ds_read_b64_tr_b16 v[218:219], v1 offset:22784
    v_exp_f16_sdwa v254, v255 dst_sel:WORD_0 dst_unused:UNUSED_PAD src0_sel:WORD_0
    v_exp_f16_sdwa v248, v249 dst_sel:WORD_0 dst_unused:UNUSED_PAD src0_sel:WORD_0
    v_exp_f16_sdwa v254, v255 dst_sel:WORD_1 dst_unused:UNUSED_PRESERVE src0_sel:WORD_1
    v_exp_f16_sdwa v248, v249 dst_sel:WORD_1 dst_unused:UNUSED_PRESERVE src0_sel:WORD_1
    v_pk_fma_f16 v254, v254, s61, s61
    v_rcp_f16_sdwa v255, v254 dst_sel:WORD_0 dst_unused:UNUSED_PAD src0_sel:WORD_0
    v_pk_fma_f16 v248, v248, s61, s61
    v_rcp_f16_sdwa v254, v254 dst_sel:WORD_0 dst_unused:UNUSED_PAD src0_sel:WORD_1
    v_fma_mix_f32 v226, v226, v255, 0 op_sel_hi:[0,1,0]
    v_fma_mix_f32 v227, v227, v254, 0 op_sel_hi:[0,1,0]
    v_cvt_pk_bf16_f32 v111, v226, v227
    v_rcp_f16_sdwa v249, v248 dst_sel:WORD_0 dst_unused:UNUSED_PAD src0_sel:WORD_0
    v_pk_fma_f16 v251, v250, v250, s60
    v_rcp_f16_sdwa v248, v248 dst_sel:WORD_0 dst_unused:UNUSED_PAD src0_sel:WORD_1
    v_fma_mix_f32 v228, v228, v249, 0 op_sel_hi:[0,1,0]
    v_fma_mix_f32 v229, v229, v248, 0 op_sel_hi:[0,1,0]
    v_cvt_pk_bf16_f32 v112, v228, v229
    v_pk_mul_f16 v251, v250, v251 neg_lo:[1,0] neg_hi:[1,0]
    v_exp_f16_sdwa v250, v251 dst_sel:WORD_0 dst_unused:UNUSED_PAD src0_sel:WORD_0
    v_cvt_pk_f16_f32 v252, v232, v233
    v_exp_f16_sdwa v250, v251 dst_sel:WORD_1 dst_unused:UNUSED_PRESERVE src0_sel:WORD_1
    v_pk_fma_f16 v253, v252, v252, s60
    v_pk_fma_f16 v250, v250, s61, s61
    v_rcp_f16_sdwa v251, v250 dst_sel:WORD_0 dst_unused:UNUSED_PAD src0_sel:WORD_0
    v_pk_mul_f16 v253, v252, v253 neg_lo:[1,0] neg_hi:[1,0]
    v_rcp_f16_sdwa v250, v250 dst_sel:WORD_0 dst_unused:UNUSED_PAD src0_sel:WORD_1
    v_fma_mix_f32 v230, v230, v251, 0 op_sel_hi:[0,1,0]
    v_fma_mix_f32 v231, v231, v250, 0 op_sel_hi:[0,1,0]
    v_cvt_pk_bf16_f32 v113, v230, v231
    v_exp_f16_sdwa v252, v253 dst_sel:WORD_0 dst_unused:UNUSED_PAD src0_sel:WORD_0
    v_cvt_pk_f16_f32 v254, v234, v235
    v_exp_f16_sdwa v252, v253 dst_sel:WORD_1 dst_unused:UNUSED_PRESERVE src0_sel:WORD_1
    v_pk_fma_f16 v255, v254, v254, s60
    v_pk_fma_f16 v252, v252, s61, s61
    v_rcp_f16_sdwa v253, v252 dst_sel:WORD_0 dst_unused:UNUSED_PAD src0_sel:WORD_0
    v_pk_mul_f16 v255, v254, v255 neg_lo:[1,0] neg_hi:[1,0]
    v_rcp_f16_sdwa v252, v252 dst_sel:WORD_0 dst_unused:UNUSED_PAD src0_sel:WORD_1
    v_fma_mix_f32 v232, v232, v253, 0 op_sel_hi:[0,1,0]
    v_fma_mix_f32 v233, v233, v252, 0 op_sel_hi:[0,1,0]
    v_cvt_pk_bf16_f32 v114, v232, v233
    v_exp_f16_sdwa v254, v255 dst_sel:WORD_0 dst_unused:UNUSED_PAD src0_sel:WORD_0
    v_cvt_pk_f16_f32 v248, v236, v237
    v_exp_f16_sdwa v254, v255 dst_sel:WORD_1 dst_unused:UNUSED_PRESERVE src0_sel:WORD_1
    v_pk_fma_f16 v249, v248, v248, s60
    v_pk_fma_f16 v254, v254, s61, s61
    v_rcp_f16_sdwa v255, v254 dst_sel:WORD_0 dst_unused:UNUSED_PAD src0_sel:WORD_0
    v_pk_mul_f16 v249, v248, v249 neg_lo:[1,0] neg_hi:[1,0]
    v_rcp_f16_sdwa v254, v254 dst_sel:WORD_0 dst_unused:UNUSED_PAD src0_sel:WORD_1
    v_fma_mix_f32 v234, v234, v255, 0 op_sel_hi:[0,1,0]
    v_fma_mix_f32 v235, v235, v254, 0 op_sel_hi:[0,1,0]
    v_cvt_pk_bf16_f32 v115, v234, v235
    v_exp_f16_sdwa v248, v249 dst_sel:WORD_0 dst_unused:UNUSED_PAD src0_sel:WORD_0
    v_cvt_pk_f16_f32 v250, v238, v239
    v_exp_f16_sdwa v248, v249 dst_sel:WORD_1 dst_unused:UNUSED_PRESERVE src0_sel:WORD_1
    v_pk_fma_f16 v251, v250, v250, s60
    v_pk_fma_f16 v248, v248, s61, s61
    v_rcp_f16_sdwa v249, v248 dst_sel:WORD_0 dst_unused:UNUSED_PAD src0_sel:WORD_0
    v_pk_mul_f16 v251, v250, v251 neg_lo:[1,0] neg_hi:[1,0]
    v_rcp_f16_sdwa v248, v248 dst_sel:WORD_0 dst_unused:UNUSED_PAD src0_sel:WORD_1
    v_fma_mix_f32 v236, v236, v249, 0 op_sel_hi:[0,1,0]
    v_fma_mix_f32 v237, v237, v248, 0 op_sel_hi:[0,1,0]
    v_cvt_pk_bf16_f32 v116, v236, v237
    v_exp_f16_sdwa v250, v251 dst_sel:WORD_0 dst_unused:UNUSED_PAD src0_sel:WORD_0
    v_cvt_pk_f16_f32 v252, v240, v241
    v_exp_f16_sdwa v250, v251 dst_sel:WORD_1 dst_unused:UNUSED_PRESERVE src0_sel:WORD_1
    v_pk_fma_f16 v253, v252, v252, s60
    v_pk_fma_f16 v250, v250, s61, s61
    v_rcp_f16_sdwa v251, v250 dst_sel:WORD_0 dst_unused:UNUSED_PAD src0_sel:WORD_0
    v_pk_mul_f16 v253, v252, v253 neg_lo:[1,0] neg_hi:[1,0]
    v_rcp_f16_sdwa v250, v250 dst_sel:WORD_0 dst_unused:UNUSED_PAD src0_sel:WORD_1
    v_fma_mix_f32 v238, v238, v251, 0 op_sel_hi:[0,1,0]
    v_fma_mix_f32 v239, v239, v250, 0 op_sel_hi:[0,1,0]
    v_cvt_pk_bf16_f32 v117, v238, v239
    v_exp_f16_sdwa v252, v253 dst_sel:WORD_0 dst_unused:UNUSED_PAD src0_sel:WORD_0
    v_cvt_pk_f16_f32 v254, v242, v243
    v_exp_f16_sdwa v252, v253 dst_sel:WORD_1 dst_unused:UNUSED_PRESERVE src0_sel:WORD_1
    v_pk_fma_f16 v255, v254, v254, s60
    v_pk_fma_f16 v252, v252, s61, s61
    v_rcp_f16_sdwa v253, v252 dst_sel:WORD_0 dst_unused:UNUSED_PAD src0_sel:WORD_0
    v_pk_mul_f16 v255, v254, v255 neg_lo:[1,0] neg_hi:[1,0]
    v_rcp_f16_sdwa v252, v252 dst_sel:WORD_0 dst_unused:UNUSED_PAD src0_sel:WORD_1
    v_fma_mix_f32 v240, v240, v253, 0 op_sel_hi:[0,1,0]
    v_fma_mix_f32 v241, v241, v252, 0 op_sel_hi:[0,1,0]
    v_cvt_pk_bf16_f32 v118, v240, v241
    v_exp_f16_sdwa v254, v255 dst_sel:WORD_0 dst_unused:UNUSED_PAD src0_sel:WORD_0
    v_cvt_pk_f16_f32 v248, v244, v245
    v_exp_f16_sdwa v254, v255 dst_sel:WORD_1 dst_unused:UNUSED_PRESERVE src0_sel:WORD_1
    v_pk_fma_f16 v249, v248, v248, s60
    v_pk_fma_f16 v254, v254, s61, s61
    v_rcp_f16_sdwa v255, v254 dst_sel:WORD_0 dst_unused:UNUSED_PAD src0_sel:WORD_0
    v_pk_mul_f16 v249, v248, v249 neg_lo:[1,0] neg_hi:[1,0]
    v_rcp_f16_sdwa v254, v254 dst_sel:WORD_0 dst_unused:UNUSED_PAD src0_sel:WORD_1
    v_fma_mix_f32 v242, v242, v255, 0 op_sel_hi:[0,1,0]
    v_fma_mix_f32 v243, v243, v254, 0 op_sel_hi:[0,1,0]
    v_cvt_pk_bf16_f32 v119, v242, v243
    v_exp_f16_sdwa v248, v249 dst_sel:WORD_0 dst_unused:UNUSED_PAD src0_sel:WORD_0
    v_cvt_pk_f16_f32 v250, v246, v247
    v_exp_f16_sdwa v248, v249 dst_sel:WORD_1 dst_unused:UNUSED_PRESERVE src0_sel:WORD_1
    v_pk_fma_f16 v251, v250, v250, s60
    v_pk_fma_f16 v248, v248, s61, s61
    v_rcp_f16_sdwa v249, v248 dst_sel:WORD_0 dst_unused:UNUSED_PAD src0_sel:WORD_0
    v_pk_mul_f16 v251, v250, v251 neg_lo:[1,0] neg_hi:[1,0]
    v_rcp_f16_sdwa v248, v248 dst_sel:WORD_0 dst_unused:UNUSED_PAD src0_sel:WORD_1
    v_fma_mix_f32 v244, v244, v249, 0 op_sel_hi:[0,1,0]
    v_fma_mix_f32 v245, v245, v248, 0 op_sel_hi:[0,1,0]
    v_cvt_pk_bf16_f32 v120, v244, v245
    s_waitcnt lgkmcnt(0)
    v_mfma_f32_16x16x32_bf16 v[220:223], v[196:199], v[12:15], 0
    ds_write2st64_b64 v2, v[108:109], v[110:111] offset0:61 offset1:62
    v_mfma_f32_16x16x32_bf16 v[220:223], v[200:203], v[16:19], v[220:223]
    v_exp_f16_sdwa v250, v251 dst_sel:WORD_0 dst_unused:UNUSED_PAD src0_sel:WORD_0
    v_mfma_f32_16x16x32_bf16 v[220:223], v[204:207], v[20:23], v[220:223]
    v_exp_f16_sdwa v250, v251 dst_sel:WORD_1 dst_unused:UNUSED_PRESERVE src0_sel:WORD_1
    v_mfma_f32_16x16x32_bf16 v[220:223], v[208:211], v[24:27], v[220:223]
    v_pk_fma_f16 v250, v250, s61, s61
    v_mfma_f32_16x16x32_bf16 v[220:223], v[212:215], v[28:31], v[220:223]
    v_rcp_f16_sdwa v251, v250 dst_sel:WORD_0 dst_unused:UNUSED_PAD src0_sel:WORD_0
    v_mfma_f32_16x16x32_bf16 v[220:223], v[216:219], v[32:35], v[220:223]
    v_rcp_f16_sdwa v250, v250 dst_sel:WORD_0 dst_unused:UNUSED_PAD src0_sel:WORD_1
    v_mfma_f32_16x16x32_bf16 v[224:227], v[196:199], v[36:39], 0
    ds_write2st64_b64 v2, v[112:113], v[114:115] offset0:69 offset1:70
    v_mfma_f32_16x16x32_bf16 v[224:227], v[200:203], v[40:43], v[224:227]
    v_fma_mix_f32 v246, v246, v251, 0 op_sel_hi:[0,1,0]
    v_fma_mix_f32 v247, v247, v250, 0 op_sel_hi:[0,1,0]
    v_mfma_f32_16x16x32_bf16 v[224:227], v[204:207], v[44:47], v[224:227]
    v_cvt_pk_bf16_f32 v121, v246, v247
    v_cvt_pk_f16_f32 v248, v220, v221
    v_mfma_f32_16x16x32_bf16 v[224:227], v[208:211], v[48:51], v[224:227]
    v_pk_fma_f16 v249, v248, v248, s60
    v_pk_mul_f16 v249, v248, v249 neg_lo:[1,0] neg_hi:[1,0]
    v_mfma_f32_16x16x32_bf16 v[224:227], v[212:215], v[52:55], v[224:227]
    v_exp_f16_sdwa v248, v249 dst_sel:WORD_0 dst_unused:UNUSED_PAD src0_sel:WORD_0
    v_mfma_f32_16x16x32_bf16 v[224:227], v[216:219], v[56:59], v[224:227]
    v_exp_f16_sdwa v248, v249 dst_sel:WORD_1 dst_unused:UNUSED_PRESERVE src0_sel:WORD_1
    v_mfma_f32_16x16x32_bf16 v[228:231], v[196:199], v[60:63], 0
    ds_write2st64_b64 v2, v[116:117], v[118:119] offset0:77 offset1:78
    v_mfma_f32_16x16x32_bf16 v[228:231], v[200:203], v[64:67], v[228:231]
    v_pk_fma_f16 v248, v248, s61, s61
    v_cvt_pk_f16_f32 v250, v222, v223
    v_mfma_f32_16x16x32_bf16 v[228:231], v[204:207], v[68:71], v[228:231]
    v_rcp_f16_sdwa v249, v248 dst_sel:WORD_0 dst_unused:UNUSED_PAD src0_sel:WORD_0
    v_mfma_f32_16x16x32_bf16 v[228:231], v[208:211], v[72:75], v[228:231]
    v_rcp_f16_sdwa v248, v248 dst_sel:WORD_0 dst_unused:UNUSED_PAD src0_sel:WORD_1
    v_mfma_f32_16x16x32_bf16 v[228:231], v[212:215], v[76:79], v[228:231]
    v_fma_mix_f32 v220, v220, v249, 0 op_sel_hi:[0,1,0]
    v_fma_mix_f32 v221, v221, v248, 0 op_sel_hi:[0,1,0]
    v_mfma_f32_16x16x32_bf16 v[228:231], v[216:219], v[80:83], v[228:231]
    v_cvt_pk_bf16_f32 v108, v220, v221
    v_pk_fma_f16 v251, v250, v250, s60
    v_mfma_f32_16x16x32_bf16 v[232:235], v[196:199], v[84:87], 0
    ds_write_b64 v3, v[120:121] offset:31232
    v_mfma_f32_16x16x32_bf16 v[232:235], v[200:203], v[88:91], v[232:235]
    v_pk_mul_f16 v251, v250, v251 neg_lo:[1,0] neg_hi:[1,0]
    v_cvt_pk_f16_f32 v252, v224, v225
    v_mfma_f32_16x16x32_bf16 v[232:235], v[204:207], v[92:95], v[232:235]
    v_exp_f16_sdwa v250, v251 dst_sel:WORD_0 dst_unused:UNUSED_PAD src0_sel:WORD_0
    v_mfma_f32_16x16x32_bf16 v[232:235], v[208:211], v[96:99], v[232:235]
    v_exp_f16_sdwa v250, v251 dst_sel:WORD_1 dst_unused:UNUSED_PRESERVE src0_sel:WORD_1
    v_mfma_f32_16x16x32_bf16 v[232:235], v[212:215], v[100:103], v[232:235]
    v_pk_fma_f16 v250, v250, s61, s61
    v_pk_fma_f16 v253, v252, v252, s60
    v_mfma_f32_16x16x32_bf16 v[232:235], v[216:219], v[104:107], v[232:235]
    v_rcp_f16_sdwa v251, v250 dst_sel:WORD_0 dst_unused:UNUSED_PAD src0_sel:WORD_0
    s_waitcnt lgkmcnt(0)
    s_barrier
L_P_mid:
    v_mfma_f32_16x16x32_bf16 v[236:239], v[196:199], v[124:127], 0
    v_rcp_f16_sdwa v250, v250 dst_sel:WORD_0 dst_unused:UNUSED_PAD src0_sel:WORD_1
    v_mfma_f32_16x16x32_bf16 v[240:243], v[196:199], v[148:151], 0
    v_fma_mix_f32 v222, v222, v251, 0 op_sel_hi:[0,1,0]
    v_fma_mix_f32 v223, v223, v250, 0 op_sel_hi:[0,1,0]
    v_mfma_f32_16x16x32_bf16 v[236:239], v[200:203], v[128:131], v[236:239]
    ds_read_b64_tr_b16 v[196:197], v1 offset:24576
    v_cvt_pk_bf16_f32 v109, v222, v223
    v_mfma_f32_16x16x32_bf16 v[240:243], v[200:203], v[152:155], v[240:243]
    ds_read_b64_tr_b16 v[198:199], v1 offset:24832
    v_pk_mul_f16 v253, v252, v253 neg_lo:[1,0] neg_hi:[1,0]
    v_mfma_f32_16x16x32_bf16 v[236:239], v[204:207], v[132:135], v[236:239]
    ds_read_b64_tr_b16 v[200:201], v1 offset:26624
    v_cvt_pk_f16_f32 v254, v226, v227
    v_mfma_f32_16x16x32_bf16 v[240:243], v[204:207], v[156:159], v[240:243]
    ds_read_b64_tr_b16 v[202:203], v1 offset:26880
    v_pk_fma_f16 v255, v254, v254, s60
    v_mfma_f32_16x16x32_bf16 v[236:239], v[208:211], v[136:139], v[236:239]
    ds_read_b64_tr_b16 v[204:205], v1 offset:28672
    v_pk_mul_f16 v255, v254, v255 neg_lo:[1,0] neg_hi:[1,0]
    v_mfma_f32_16x16x32_bf16 v[240:243], v[208:211], v[160:163], v[240:243]
    ds_read_b64_tr_b16 v[206:207], v1 offset:28928
    v_cvt_pk_f16_f32 v248, v228, v229
    v_mfma_f32_16x16x32_bf16 v[236:239], v[212:215], v[140:143], v[236:239]
    ds_read_b64_tr_b16 v[208:209], v1 offset:30720
    v_pk_fma_f16 v249, v248, v248, s60
    v_mfma_f32_16x16x32_bf16 v[240:243], v[212:215], v[164:167], v[240:243]
    ds_read_b64_tr_b16 v[210:211], v1 offset:30976
    v_pk_mul_f16 v249, v248, v249 neg_lo:[1,0] neg_hi:[1,0]
    v_mfma_f32_16x16x32_bf16 v[236:239], v[216:219], v[144:147], v[236:239]
    ds_read_b64_tr_b16 v[212:213], v1 offset:32768
    v_mfma_f32_16x16x32_bf16 v[240:243], v[216:219], v[168:171], v[240:243]
    ds_read_b64_tr_b16 v[214:215], v1 offset:33024
    ds_read_b64_tr_b16 v[216:217], v1 offset:34816
    ds_read_b64_tr_b16 v[218:219], v1 offset:35072
    v_exp_f16_sdwa v252, v253 dst_sel:WORD_0 dst_unused:UNUSED_PAD src0_sel:WORD_0
    v_exp_f16_sdwa v254, v255 dst_sel:WORD_0 dst_unused:UNUSED_PAD src0_sel:WORD_0
    v_exp_f16_sdwa v252, v253 dst_sel:WORD_1 dst_unused:UNUSED_PRESERVE src0_sel:WORD_1
    v_exp_f16_sdwa v254, v255 dst_sel:WORD_1 dst_unused:UNUSED_PRESERVE src0_sel:WORD_1
    v_pk_fma_f16 v252, v252, s61, s61
    v_rcp_f16_sdwa v253, v252 dst_sel:WORD_0 dst_unused:UNUSED_PAD src0_sel:WORD_0
    v_pk_fma_f16 v254, v254, s61, s61
    v_rcp_f16_sdwa v252, v252 dst_sel:WORD_0 dst_unused:UNUSED_PAD src0_sel:WORD_1
    v_fma_mix_f32 v224, v224, v253, 0 op_sel_hi:[0,1,0]
    v_fma_mix_f32 v225, v225, v252, 0 op_sel_hi:[0,1,0]
    v_cvt_pk_bf16_f32 v110, v224, v225
    v_rcp_f16_sdwa v255, v254 dst_sel:WORD_0 dst_unused:UNUSED_PAD src0_sel:WORD_0
    v_exp_f16_sdwa v248, v249 dst_sel:WORD_0 dst_unused:UNUSED_PAD src0_sel:WORD_0
    v_rcp_f16_sdwa v254, v254 dst_sel:WORD_0 dst_unused:UNUSED_PAD src0_sel:WORD_1
    v_fma_mix_f32 v226, v226, v255, 0 op_sel_hi:[0,1,0]
    v_fma_mix_f32 v227, v227, v254, 0 op_sel_hi:[0,1,0]
    v_cvt_pk_bf16_f32 v111, v226, v227
    v_exp_f16_sdwa v248, v249 dst_sel:WORD_1 dst_unused:UNUSED_PRESERVE src0_sel:WORD_1
    v_cvt_pk_f16_f32 v250, v230, v231
    v_pk_fma_f16 v248, v248, s61, s61
    v_rcp_f16_sdwa v249, v248 dst_sel:WORD_0 dst_unused:UNUSED_PAD src0_sel:WORD_0
    v_pk_fma_f16 v251, v250, v250, s60
    v_rcp_f16_sdwa v248, v248 dst_sel:WORD_0 dst_unused:UNUSED_PAD src0_sel:WORD_1
    v_fma_mix_f32 v228, v228, v249, 0 op_sel_hi:[0,1,0]
    v_fma_mix_f32 v229, v229, v248, 0 op_sel_hi:[0,1,0]
    v_cvt_pk_bf16_f32 v112, v228, v229
    v_pk_mul_f16 v251, v250, v251 neg_lo:[1,0] neg_hi:[1,0]
    v_exp_f16_sdwa v250, v251 dst_sel:WORD_0 dst_unused:UNUSED_PAD src0_sel:WORD_0
    v_cvt_pk_f16_f32 v252, v232, v233
    v_exp_f16_sdwa v250, v251 dst_sel:WORD_1 dst_unused:UNUSED_PRESERVE src0_sel:WORD_1
    v_pk_fma_f16 v253, v252, v252, s60
    v_pk_fma_f16 v250, v250, s61, s61
    v_rcp_f16_sdwa v251, v250 dst_sel:WORD_0 dst_unused:UNUSED_PAD src0_sel:WORD_0
    v_pk_mul_f16 v253, v252, v253 neg_lo:[1,0] neg_hi:[1,0]
    v_rcp_f16_sdwa v250, v250 dst_sel:WORD_0 dst_unused:UNUSED_PAD src0_sel:WORD_1
    v_fma_mix_f32 v230, v230, v251, 0 op_sel_hi:[0,1,0]
    v_fma_mix_f32 v231, v231, v250, 0 op_sel_hi:[0,1,0]
    v_cvt_pk_bf16_f32 v113, v230, v231
    v_exp_f16_sdwa v252, v253 dst_sel:WORD_0 dst_unused:UNUSED_PAD src0_sel:WORD_0
    v_cvt_pk_f16_f32 v254, v234, v235
    v_exp_f16_sdwa v252, v253 dst_sel:WORD_1 dst_unused:UNUSED_PRESERVE src0_sel:WORD_1
    v_pk_fma_f16 v255, v254, v254, s60
    v_pk_fma_f16 v252, v252, s61, s61
    v_rcp_f16_sdwa v253, v252 dst_sel:WORD_0 dst_unused:UNUSED_PAD src0_sel:WORD_0
    v_pk_mul_f16 v255, v254, v255 neg_lo:[1,0] neg_hi:[1,0]
    v_rcp_f16_sdwa v252, v252 dst_sel:WORD_0 dst_unused:UNUSED_PAD src0_sel:WORD_1
    v_fma_mix_f32 v232, v232, v253, 0 op_sel_hi:[0,1,0]
    v_fma_mix_f32 v233, v233, v252, 0 op_sel_hi:[0,1,0]
    v_cvt_pk_bf16_f32 v114, v232, v233
    v_exp_f16_sdwa v254, v255 dst_sel:WORD_0 dst_unused:UNUSED_PAD src0_sel:WORD_0
    v_cvt_pk_f16_f32 v248, v236, v237
    v_exp_f16_sdwa v254, v255 dst_sel:WORD_1 dst_unused:UNUSED_PRESERVE src0_sel:WORD_1
    v_pk_fma_f16 v249, v248, v248, s60
    v_pk_fma_f16 v254, v254, s61, s61
    v_rcp_f16_sdwa v255, v254 dst_sel:WORD_0 dst_unused:UNUSED_PAD src0_sel:WORD_0
    v_pk_mul_f16 v249, v248, v249 neg_lo:[1,0] neg_hi:[1,0]
    v_rcp_f16_sdwa v254, v254 dst_sel:WORD_0 dst_unused:UNUSED_PAD src0_sel:WORD_1
    v_fma_mix_f32 v234, v234, v255, 0 op_sel_hi:[0,1,0]
    v_fma_mix_f32 v235, v235, v254, 0 op_sel_hi:[0,1,0]
    v_cvt_pk_bf16_f32 v115, v234, v235
    v_exp_f16_sdwa v248, v249 dst_sel:WORD_0 dst_unused:UNUSED_PAD src0_sel:WORD_0
    v_cvt_pk_f16_f32 v250, v238, v239
    v_exp_f16_sdwa v248, v249 dst_sel:WORD_1 dst_unused:UNUSED_PRESERVE src0_sel:WORD_1
    v_pk_fma_f16 v251, v250, v250, s60
    v_pk_fma_f16 v248, v248, s61, s61
    v_rcp_f16_sdwa v249, v248 dst_sel:WORD_0 dst_unused:UNUSED_PAD src0_sel:WORD_0
    v_pk_mul_f16 v251, v250, v251 neg_lo:[1,0] neg_hi:[1,0]
    v_rcp_f16_sdwa v248, v248 dst_sel:WORD_0 dst_unused:UNUSED_PAD src0_sel:WORD_1
    v_fma_mix_f32 v236, v236, v249, 0 op_sel_hi:[0,1,0]
    v_fma_mix_f32 v237, v237, v248, 0 op_sel_hi:[0,1,0]
    v_cvt_pk_bf16_f32 v116, v236, v237
    v_exp_f16_sdwa v250, v251 dst_sel:WORD_0 dst_unused:UNUSED_PAD src0_sel:WORD_0
    v_cvt_pk_f16_f32 v252, v240, v241
    v_exp_f16_sdwa v250, v251 dst_sel:WORD_1 dst_unused:UNUSED_PRESERVE src0_sel:WORD_1
    v_pk_fma_f16 v253, v252, v252, s60
    v_pk_fma_f16 v250, v250, s61, s61
    v_rcp_f16_sdwa v251, v250 dst_sel:WORD_0 dst_unused:UNUSED_PAD src0_sel:WORD_0
    v_pk_mul_f16 v253, v252, v253 neg_lo:[1,0] neg_hi:[1,0]
    v_rcp_f16_sdwa v250, v250 dst_sel:WORD_0 dst_unused:UNUSED_PAD src0_sel:WORD_1
    v_fma_mix_f32 v238, v238, v251, 0 op_sel_hi:[0,1,0]
    v_fma_mix_f32 v239, v239, v250, 0 op_sel_hi:[0,1,0]
    v_cvt_pk_bf16_f32 v117, v238, v239
    v_exp_f16_sdwa v252, v253 dst_sel:WORD_0 dst_unused:UNUSED_PAD src0_sel:WORD_0
    v_cvt_pk_f16_f32 v254, v242, v243
    v_exp_f16_sdwa v252, v253 dst_sel:WORD_1 dst_unused:UNUSED_PRESERVE src0_sel:WORD_1
    v_pk_fma_f16 v255, v254, v254, s60
    v_pk_fma_f16 v252, v252, s61, s61
    v_rcp_f16_sdwa v253, v252 dst_sel:WORD_0 dst_unused:UNUSED_PAD src0_sel:WORD_0
    v_pk_mul_f16 v255, v254, v255 neg_lo:[1,0] neg_hi:[1,0]
    v_rcp_f16_sdwa v252, v252 dst_sel:WORD_0 dst_unused:UNUSED_PAD src0_sel:WORD_1
    s_waitcnt lgkmcnt(0)
    v_mfma_f32_16x16x32_bf16 v[220:223], v[196:199], v[12:15], 0
    ds_write2st64_b64 v2, v[108:109], v[110:111] offset0:0 offset1:1
    v_mfma_f32_16x16x32_bf16 v[220:223], v[200:203], v[16:19], v[220:223]
    v_exp_f16_sdwa v254, v255 dst_sel:WORD_0 dst_unused:UNUSED_PAD src0_sel:WORD_0
    v_mfma_f32_16x16x32_bf16 v[220:223], v[204:207], v[20:23], v[220:223]
    v_exp_f16_sdwa v254, v255 dst_sel:WORD_1 dst_unused:UNUSED_PRESERVE src0_sel:WORD_1
    v_mfma_f32_16x16x32_bf16 v[220:223], v[208:211], v[24:27], v[220:223]
    v_fma_mix_f32 v240, v240, v253, 0 op_sel_hi:[0,1,0]
    v_fma_mix_f32 v241, v241, v252, 0 op_sel_hi:[0,1,0]
    v_mfma_f32_16x16x32_bf16 v[220:223], v[212:215], v[28:31], v[220:223]
    v_cvt_pk_bf16_f32 v118, v240, v241
    v_pk_fma_f16 v254, v254, s61, s61
    v_mfma_f32_16x16x32_bf16 v[220:223], v[216:219], v[32:35], v[220:223]
    v_rcp_f16_sdwa v255, v254 dst_sel:WORD_0 dst_unused:UNUSED_PAD src0_sel:WORD_0
    v_mfma_f32_16x16x32_bf16 v[224:227], v[196:199], v[36:39], 0
    ds_write2st64_b64 v2, v[112:113], v[114:115] offset0:8 offset1:9
    v_mfma_f32_16x16x32_bf16 v[224:227], v[200:203], v[40:43], v[224:227]
    v_rcp_f16_sdwa v254, v254 dst_sel:WORD_0 dst_unused:UNUSED_PAD src0_sel:WORD_1
    v_mfma_f32_16x16x32_bf16 v[224:227], v[204:207], v[44:47], v[224:227]
    v_fma_mix_f32 v242, v242, v255, 0 op_sel_hi:[0,1,0]
    v_fma_mix_f32 v243, v243, v254, 0 op_sel_hi:[0,1,0]
    v_mfma_f32_16x16x32_bf16 v[224:227], v[208:211], v[48:51], v[224:227]
    v_cvt_pk_bf16_f32 v119, v242, v243
    v_cvt_pk_f16_f32 v248, v220, v221
    v_mfma_f32_16x16x32_bf16 v[224:227], v[212:215], v[52:55], v[224:227]
    v_pk_fma_f16 v249, v248, v248, s60
    v_pk_mul_f16 v249, v248, v249 neg_lo:[1,0] neg_hi:[1,0]
    v_mfma_f32_16x16x32_bf16 v[224:227], v[216:219], v[56:59], v[224:227]
    v_exp_f16_sdwa v248, v249 dst_sel:WORD_0 dst_unused:UNUSED_PAD src0_sel:WORD_0
    v_mfma_f32_16x16x32_bf16 v[228:231], v[196:199], v[60:63], 0
    ds_write2st64_b64 v2, v[116:117], v[118:119] offset0:16 offset1:17
    v_mfma_f32_16x16x32_bf16 v[228:231], v[200:203], v[64:67], v[228:231]
    v_exp_f16_sdwa v248, v249 dst_sel:WORD_1 dst_unused:UNUSED_PRESERVE src0_sel:WORD_1
    v_mfma_f32_16x16x32_bf16 v[228:231], v[204:207], v[68:71], v[228:231]
    v_pk_fma_f16 v248, v248, s61, s61
    v_cvt_pk_f16_f32 v250, v222, v223
    v_mfma_f32_16x16x32_bf16 v[228:231], v[208:211], v[72:75], v[228:231]
    v_rcp_f16_sdwa v249, v248 dst_sel:WORD_0 dst_unused:UNUSED_PAD src0_sel:WORD_0
    v_mfma_f32_16x16x32_bf16 v[228:231], v[212:215], v[76:79], v[228:231]
    v_rcp_f16_sdwa v248, v248 dst_sel:WORD_0 dst_unused:UNUSED_PAD src0_sel:WORD_1
    v_mfma_f32_16x16x32_bf16 v[228:231], v[216:219], v[80:83], v[228:231]
    v_fma_mix_f32 v220, v220, v249, 0 op_sel_hi:[0,1,0]
    v_fma_mix_f32 v221, v221, v248, 0 op_sel_hi:[0,1,0]
    v_mfma_f32_16x16x32_bf16 v[232:235], v[196:199], v[84:87], 0
    v_cvt_pk_bf16_f32 v108, v220, v221
    v_pk_fma_f16 v251, v250, v250, s60
    v_mfma_f32_16x16x32_bf16 v[232:235], v[200:203], v[88:91], v[232:235]
    v_pk_mul_f16 v251, v250, v251 neg_lo:[1,0] neg_hi:[1,0]
    v_cvt_pk_f16_f32 v252, v224, v225
    v_mfma_f32_16x16x32_bf16 v[232:235], v[204:207], v[92:95], v[232:235]
    v_exp_f16_sdwa v250, v251 dst_sel:WORD_0 dst_unused:UNUSED_PAD src0_sel:WORD_0
    v_mfma_f32_16x16x32_bf16 v[232:235], v[208:211], v[96:99], v[232:235]
    v_exp_f16_sdwa v250, v251 dst_sel:WORD_1 dst_unused:UNUSED_PRESERVE src0_sel:WORD_1
    v_mfma_f32_16x16x32_bf16 v[232:235], v[212:215], v[100:103], v[232:235]
    v_pk_fma_f16 v250, v250, s61, s61
    v_pk_fma_f16 v253, v252, v252, s60
    v_mfma_f32_16x16x32_bf16 v[232:235], v[216:219], v[104:107], v[232:235]
    v_rcp_f16_sdwa v251, v250 dst_sel:WORD_0 dst_unused:UNUSED_PAD src0_sel:WORD_0
    v_mfma_f32_16x16x32_bf16 v[236:239], v[196:199], v[124:127], 0
    v_rcp_f16_sdwa v250, v250 dst_sel:WORD_0 dst_unused:UNUSED_PAD src0_sel:WORD_1
    v_mfma_f32_16x16x32_bf16 v[236:239], v[200:203], v[128:131], v[236:239]
    v_fma_mix_f32 v222, v222, v251, 0 op_sel_hi:[0,1,0]
    v_fma_mix_f32 v223, v223, v250, 0 op_sel_hi:[0,1,0]
    v_mfma_f32_16x16x32_bf16 v[236:239], v[204:207], v[132:135], v[236:239]
    v_cvt_pk_bf16_f32 v109, v222, v223
    v_pk_mul_f16 v253, v252, v253 neg_lo:[1,0] neg_hi:[1,0]
    v_mfma_f32_16x16x32_bf16 v[236:239], v[208:211], v[136:139], v[236:239]
    v_exp_f16_sdwa v252, v253 dst_sel:WORD_0 dst_unused:UNUSED_PAD src0_sel:WORD_0
    v_mfma_f32_16x16x32_bf16 v[236:239], v[212:215], v[140:143], v[236:239]
    v_exp_f16_sdwa v252, v253 dst_sel:WORD_1 dst_unused:UNUSED_PRESERVE src0_sel:WORD_1
    v_mfma_f32_16x16x32_bf16 v[236:239], v[216:219], v[144:147], v[236:239]
    v_pk_fma_f16 v252, v252, s61, s61
    v_cvt_pk_f16_f32 v254, v226, v227
    s_waitcnt lgkmcnt(0)
    s_barrier
    v_mfma_f32_16x16x32_bf16 v[240:243], v[196:199], v[148:151], 0
    v_rcp_f16_sdwa v253, v252 dst_sel:WORD_0 dst_unused:UNUSED_PAD src0_sel:WORD_0
    v_mfma_f32_16x16x32_bf16 v[244:247], v[196:199], v[172:175], 0
    v_rcp_f16_sdwa v252, v252 dst_sel:WORD_0 dst_unused:UNUSED_PAD src0_sel:WORD_1
    v_mfma_f32_16x16x32_bf16 v[240:243], v[200:203], v[152:155], v[240:243]
    ds_read_b64_tr_b16 v[196:197], v1 offset:0
    v_fma_mix_f32 v224, v224, v253, 0 op_sel_hi:[0,1,0]
    v_mfma_f32_16x16x32_bf16 v[244:247], v[200:203], v[176:179], v[244:247]
    ds_read_b64_tr_b16 v[198:199], v1 offset:256
    v_fma_mix_f32 v225, v225, v252, 0 op_sel_hi:[0,1,0]
    v_mfma_f32_16x16x32_bf16 v[240:243], v[204:207], v[156:159], v[240:243]
    ds_read_b64_tr_b16 v[200:201], v1 offset:2048
    v_cvt_pk_bf16_f32 v110, v224, v225
    v_mfma_f32_16x16x32_bf16 v[244:247], v[204:207], v[180:183], v[244:247]
    ds_read_b64_tr_b16 v[202:203], v1 offset:2304
    v_pk_fma_f16 v255, v254, v254, s60
    v_mfma_f32_16x16x32_bf16 v[240:243], v[208:211], v[160:163], v[240:243]
    ds_read_b64_tr_b16 v[204:205], v1 offset:4096
    v_pk_mul_f16 v255, v254, v255 neg_lo:[1,0] neg_hi:[1,0]
    v_mfma_f32_16x16x32_bf16 v[244:247], v[208:211], v[184:187], v[244:247]
    ds_read_b64_tr_b16 v[206:207], v1 offset:4352
    v_cvt_pk_f16_f32 v248, v228, v229
    v_mfma_f32_16x16x32_bf16 v[240:243], v[212:215], v[164:167], v[240:243]
    ds_read_b64_tr_b16 v[208:209], v1 offset:6144
    v_pk_fma_f16 v249, v248, v248, s60
    v_mfma_f32_16x16x32_bf16 v[244:247], v[212:215], v[188:191], v[244:247]
    ds_read_b64_tr_b16 v[210:211], v1 offset:6400
    v_pk_mul_f16 v249, v248, v249 neg_lo:[1,0] neg_hi:[1,0]
    v_mfma_f32_16x16x32_bf16 v[240:243], v[216:219], v[168:171], v[240:243]
    ds_read_b64_tr_b16 v[212:213], v1 offset:8192
    v_cvt_pk_f16_f32 v250, v230, v231
    v_mfma_f32_16x16x32_bf16 v[244:247], v[216:219], v[192:195], v[244:247]
    ds_read_b64_tr_b16 v[214:215], v1 offset:8448
    ds_read_b64_tr_b16 v[216:217], v1 offset:10240
    ds_read_b64_tr_b16 v[218:219], v1 offset:10496
    v_exp_f16_sdwa v254, v255 dst_sel:WORD_0 dst_unused:UNUSED_PAD src0_sel:WORD_0
    v_exp_f16_sdwa v248, v249 dst_sel:WORD_0 dst_unused:UNUSED_PAD src0_sel:WORD_0
    v_exp_f16_sdwa v254, v255 dst_sel:WORD_1 dst_unused:UNUSED_PRESERVE src0_sel:WORD_1
    v_exp_f16_sdwa v248, v249 dst_sel:WORD_1 dst_unused:UNUSED_PRESERVE src0_sel:WORD_1
    v_pk_fma_f16 v254, v254, s61, s61
    v_rcp_f16_sdwa v255, v254 dst_sel:WORD_0 dst_unused:UNUSED_PAD src0_sel:WORD_0
    v_pk_fma_f16 v248, v248, s61, s61
    v_rcp_f16_sdwa v254, v254 dst_sel:WORD_0 dst_unused:UNUSED_PAD src0_sel:WORD_1
    v_fma_mix_f32 v226, v226, v255, 0 op_sel_hi:[0,1,0]
    v_fma_mix_f32 v227, v227, v254, 0 op_sel_hi:[0,1,0]
    v_cvt_pk_bf16_f32 v111, v226, v227
    v_rcp_f16_sdwa v249, v248 dst_sel:WORD_0 dst_unused:UNUSED_PAD src0_sel:WORD_0
    v_pk_fma_f16 v251, v250, v250, s60
    v_rcp_f16_sdwa v248, v248 dst_sel:WORD_0 dst_unused:UNUSED_PAD src0_sel:WORD_1
    v_fma_mix_f32 v228, v228, v249, 0 op_sel_hi:[0,1,0]
    v_fma_mix_f32 v229, v229, v248, 0 op_sel_hi:[0,1,0]
    v_cvt_pk_bf16_f32 v112, v228, v229
    v_pk_mul_f16 v251, v250, v251 neg_lo:[1,0] neg_hi:[1,0]
    v_exp_f16_sdwa v250, v251 dst_sel:WORD_0 dst_unused:UNUSED_PAD src0_sel:WORD_0
    v_cvt_pk_f16_f32 v252, v232, v233
    v_exp_f16_sdwa v250, v251 dst_sel:WORD_1 dst_unused:UNUSED_PRESERVE src0_sel:WORD_1
    v_pk_fma_f16 v253, v252, v252, s60
    v_pk_fma_f16 v250, v250, s61, s61
    v_rcp_f16_sdwa v251, v250 dst_sel:WORD_0 dst_unused:UNUSED_PAD src0_sel:WORD_0
    v_pk_mul_f16 v253, v252, v253 neg_lo:[1,0] neg_hi:[1,0]
    v_rcp_f16_sdwa v250, v250 dst_sel:WORD_0 dst_unused:UNUSED_PAD src0_sel:WORD_1
    v_fma_mix_f32 v230, v230, v251, 0 op_sel_hi:[0,1,0]
    v_fma_mix_f32 v231, v231, v250, 0 op_sel_hi:[0,1,0]
    v_cvt_pk_bf16_f32 v113, v230, v231
    v_exp_f16_sdwa v252, v253 dst_sel:WORD_0 dst_unused:UNUSED_PAD src0_sel:WORD_0
    v_cvt_pk_f16_f32 v254, v234, v235
    v_exp_f16_sdwa v252, v253 dst_sel:WORD_1 dst_unused:UNUSED_PRESERVE src0_sel:WORD_1
    v_pk_fma_f16 v255, v254, v254, s60
    v_pk_fma_f16 v252, v252, s61, s61
    v_rcp_f16_sdwa v253, v252 dst_sel:WORD_0 dst_unused:UNUSED_PAD src0_sel:WORD_0
    v_pk_mul_f16 v255, v254, v255 neg_lo:[1,0] neg_hi:[1,0]
    v_rcp_f16_sdwa v252, v252 dst_sel:WORD_0 dst_unused:UNUSED_PAD src0_sel:WORD_1
    v_fma_mix_f32 v232, v232, v253, 0 op_sel_hi:[0,1,0]
    v_fma_mix_f32 v233, v233, v252, 0 op_sel_hi:[0,1,0]
    v_cvt_pk_bf16_f32 v114, v232, v233
    v_exp_f16_sdwa v254, v255 dst_sel:WORD_0 dst_unused:UNUSED_PAD src0_sel:WORD_0
    v_cvt_pk_f16_f32 v248, v236, v237
    v_exp_f16_sdwa v254, v255 dst_sel:WORD_1 dst_unused:UNUSED_PRESERVE src0_sel:WORD_1
    v_pk_fma_f16 v249, v248, v248, s60
    v_pk_fma_f16 v254, v254, s61, s61
    v_rcp_f16_sdwa v255, v254 dst_sel:WORD_0 dst_unused:UNUSED_PAD src0_sel:WORD_0
    v_pk_mul_f16 v249, v248, v249 neg_lo:[1,0] neg_hi:[1,0]
    v_rcp_f16_sdwa v254, v254 dst_sel:WORD_0 dst_unused:UNUSED_PAD src0_sel:WORD_1
    v_fma_mix_f32 v234, v234, v255, 0 op_sel_hi:[0,1,0]
    v_fma_mix_f32 v235, v235, v254, 0 op_sel_hi:[0,1,0]
    v_cvt_pk_bf16_f32 v115, v234, v235
    v_exp_f16_sdwa v248, v249 dst_sel:WORD_0 dst_unused:UNUSED_PAD src0_sel:WORD_0
    v_cvt_pk_f16_f32 v250, v238, v239
    v_exp_f16_sdwa v248, v249 dst_sel:WORD_1 dst_unused:UNUSED_PRESERVE src0_sel:WORD_1
    v_pk_fma_f16 v251, v250, v250, s60
    v_pk_fma_f16 v248, v248, s61, s61
    v_rcp_f16_sdwa v249, v248 dst_sel:WORD_0 dst_unused:UNUSED_PAD src0_sel:WORD_0
    v_pk_mul_f16 v251, v250, v251 neg_lo:[1,0] neg_hi:[1,0]
    v_rcp_f16_sdwa v248, v248 dst_sel:WORD_0 dst_unused:UNUSED_PAD src0_sel:WORD_1
    v_fma_mix_f32 v236, v236, v249, 0 op_sel_hi:[0,1,0]
    v_fma_mix_f32 v237, v237, v248, 0 op_sel_hi:[0,1,0]
    v_cvt_pk_bf16_f32 v116, v236, v237
    v_exp_f16_sdwa v250, v251 dst_sel:WORD_0 dst_unused:UNUSED_PAD src0_sel:WORD_0
    v_cvt_pk_f16_f32 v252, v240, v241
    v_exp_f16_sdwa v250, v251 dst_sel:WORD_1 dst_unused:UNUSED_PRESERVE src0_sel:WORD_1
    v_pk_fma_f16 v253, v252, v252, s60
    v_pk_fma_f16 v250, v250, s61, s61
    v_rcp_f16_sdwa v251, v250 dst_sel:WORD_0 dst_unused:UNUSED_PAD src0_sel:WORD_0
    v_pk_mul_f16 v253, v252, v253 neg_lo:[1,0] neg_hi:[1,0]
    v_rcp_f16_sdwa v250, v250 dst_sel:WORD_0 dst_unused:UNUSED_PAD src0_sel:WORD_1
    v_fma_mix_f32 v238, v238, v251, 0 op_sel_hi:[0,1,0]
    v_fma_mix_f32 v239, v239, v250, 0 op_sel_hi:[0,1,0]
    v_cvt_pk_bf16_f32 v117, v238, v239
    v_exp_f16_sdwa v252, v253 dst_sel:WORD_0 dst_unused:UNUSED_PAD src0_sel:WORD_0
    v_cvt_pk_f16_f32 v254, v242, v243
    v_exp_f16_sdwa v252, v253 dst_sel:WORD_1 dst_unused:UNUSED_PRESERVE src0_sel:WORD_1
    v_pk_fma_f16 v255, v254, v254, s60
    v_pk_fma_f16 v252, v252, s61, s61
    v_rcp_f16_sdwa v253, v252 dst_sel:WORD_0 dst_unused:UNUSED_PAD src0_sel:WORD_0
    v_pk_mul_f16 v255, v254, v255 neg_lo:[1,0] neg_hi:[1,0]
    v_rcp_f16_sdwa v252, v252 dst_sel:WORD_0 dst_unused:UNUSED_PAD src0_sel:WORD_1
    v_fma_mix_f32 v240, v240, v253, 0 op_sel_hi:[0,1,0]
    v_fma_mix_f32 v241, v241, v252, 0 op_sel_hi:[0,1,0]
    v_cvt_pk_bf16_f32 v118, v240, v241
    v_exp_f16_sdwa v254, v255 dst_sel:WORD_0 dst_unused:UNUSED_PAD src0_sel:WORD_0
    v_cvt_pk_f16_f32 v248, v244, v245
    v_exp_f16_sdwa v254, v255 dst_sel:WORD_1 dst_unused:UNUSED_PRESERVE src0_sel:WORD_1
    v_pk_fma_f16 v249, v248, v248, s60
    v_pk_fma_f16 v254, v254, s61, s61
    v_rcp_f16_sdwa v255, v254 dst_sel:WORD_0 dst_unused:UNUSED_PAD src0_sel:WORD_0
    v_pk_mul_f16 v249, v248, v249 neg_lo:[1,0] neg_hi:[1,0]
    v_rcp_f16_sdwa v254, v254 dst_sel:WORD_0 dst_unused:UNUSED_PAD src0_sel:WORD_1
    v_fma_mix_f32 v242, v242, v255, 0 op_sel_hi:[0,1,0]
    v_fma_mix_f32 v243, v243, v254, 0 op_sel_hi:[0,1,0]
    v_cvt_pk_bf16_f32 v119, v242, v243
    v_exp_f16_sdwa v248, v249 dst_sel:WORD_0 dst_unused:UNUSED_PAD src0_sel:WORD_0
    v_cvt_pk_f16_f32 v250, v246, v247
    v_exp_f16_sdwa v248, v249 dst_sel:WORD_1 dst_unused:UNUSED_PRESERVE src0_sel:WORD_1
    v_pk_fma_f16 v251, v250, v250, s60
    v_pk_fma_f16 v248, v248, s61, s61
    v_rcp_f16_sdwa v249, v248 dst_sel:WORD_0 dst_unused:UNUSED_PAD src0_sel:WORD_0
    v_pk_mul_f16 v251, v250, v251 neg_lo:[1,0] neg_hi:[1,0]
    v_rcp_f16_sdwa v248, v248 dst_sel:WORD_0 dst_unused:UNUSED_PAD src0_sel:WORD_1
    v_fma_mix_f32 v244, v244, v249, 0 op_sel_hi:[0,1,0]
    v_fma_mix_f32 v245, v245, v248, 0 op_sel_hi:[0,1,0]
    v_cvt_pk_bf16_f32 v120, v244, v245
    s_waitcnt lgkmcnt(0)
    v_mfma_f32_16x16x32_bf16 v[220:223], v[196:199], v[12:15], 0
    ds_write2st64_b64 v2, v[108:109], v[110:111] offset0:26 offset1:27
    v_mfma_f32_16x16x32_bf16 v[220:223], v[200:203], v[16:19], v[220:223]
    v_exp_f16_sdwa v250, v251 dst_sel:WORD_0 dst_unused:UNUSED_PAD src0_sel:WORD_0
    v_mfma_f32_16x16x32_bf16 v[220:223], v[204:207], v[20:23], v[220:223]
    v_exp_f16_sdwa v250, v251 dst_sel:WORD_1 dst_unused:UNUSED_PRESERVE src0_sel:WORD_1
    v_mfma_f32_16x16x32_bf16 v[220:223], v[208:211], v[24:27], v[220:223]
    v_pk_fma_f16 v250, v250, s61, s61
    v_mfma_f32_16x16x32_bf16 v[220:223], v[212:215], v[28:31], v[220:223]
    v_rcp_f16_sdwa v251, v250 dst_sel:WORD_0 dst_unused:UNUSED_PAD src0_sel:WORD_0
    v_mfma_f32_16x16x32_bf16 v[220:223], v[216:219], v[32:35], v[220:223]
    v_rcp_f16_sdwa v250, v250 dst_sel:WORD_0 dst_unused:UNUSED_PAD src0_sel:WORD_1
    v_mfma_f32_16x16x32_bf16 v[224:227], v[196:199], v[36:39], 0
    ds_write2st64_b64 v2, v[112:113], v[114:115] offset0:34 offset1:35
    v_mfma_f32_16x16x32_bf16 v[224:227], v[200:203], v[40:43], v[224:227]
    v_fma_mix_f32 v246, v246, v251, 0 op_sel_hi:[0,1,0]
    v_fma_mix_f32 v247, v247, v250, 0 op_sel_hi:[0,1,0]
    v_mfma_f32_16x16x32_bf16 v[224:227], v[204:207], v[44:47], v[224:227]
    v_cvt_pk_bf16_f32 v121, v246, v247
    v_cvt_pk_f16_f32 v248, v220, v221
    v_mfma_f32_16x16x32_bf16 v[224:227], v[208:211], v[48:51], v[224:227]
    v_pk_fma_f16 v249, v248, v248, s60
    v_pk_mul_f16 v249, v248, v249 neg_lo:[1,0] neg_hi:[1,0]
    v_mfma_f32_16x16x32_bf16 v[224:227], v[212:215], v[52:55], v[224:227]
    v_exp_f16_sdwa v248, v249 dst_sel:WORD_0 dst_unused:UNUSED_PAD src0_sel:WORD_0
    v_mfma_f32_16x16x32_bf16 v[224:227], v[216:219], v[56:59], v[224:227]
    v_exp_f16_sdwa v248, v249 dst_sel:WORD_1 dst_unused:UNUSED_PRESERVE src0_sel:WORD_1
    v_mfma_f32_16x16x32_bf16 v[228:231], v[196:199], v[60:63], 0
    ds_write2st64_b64 v2, v[116:117], v[118:119] offset0:42 offset1:43
    v_mfma_f32_16x16x32_bf16 v[228:231], v[200:203], v[64:67], v[228:231]
    v_pk_fma_f16 v248, v248, s61, s61
    v_cvt_pk_f16_f32 v250, v222, v223
    v_mfma_f32_16x16x32_bf16 v[228:231], v[204:207], v[68:71], v[228:231]
    v_rcp_f16_sdwa v249, v248 dst_sel:WORD_0 dst_unused:UNUSED_PAD src0_sel:WORD_0
    v_mfma_f32_16x16x32_bf16 v[228:231], v[208:211], v[72:75], v[228:231]
    v_rcp_f16_sdwa v248, v248 dst_sel:WORD_0 dst_unused:UNUSED_PAD src0_sel:WORD_1
    v_mfma_f32_16x16x32_bf16 v[228:231], v[212:215], v[76:79], v[228:231]
    v_fma_mix_f32 v220, v220, v249, 0 op_sel_hi:[0,1,0]
    v_fma_mix_f32 v221, v221, v248, 0 op_sel_hi:[0,1,0]
    v_mfma_f32_16x16x32_bf16 v[228:231], v[216:219], v[80:83], v[228:231]
    v_cvt_pk_bf16_f32 v108, v220, v221
    v_pk_fma_f16 v251, v250, v250, s60
    v_mfma_f32_16x16x32_bf16 v[232:235], v[196:199], v[84:87], 0
    ds_write_b64 v3, v[120:121] offset:13312
    v_mfma_f32_16x16x32_bf16 v[232:235], v[200:203], v[88:91], v[232:235]
    v_pk_mul_f16 v251, v250, v251 neg_lo:[1,0] neg_hi:[1,0]
    v_cvt_pk_f16_f32 v252, v224, v225
    v_mfma_f32_16x16x32_bf16 v[232:235], v[204:207], v[92:95], v[232:235]
    v_exp_f16_sdwa v250, v251 dst_sel:WORD_0 dst_unused:UNUSED_PAD src0_sel:WORD_0
    v_mfma_f32_16x16x32_bf16 v[232:235], v[208:211], v[96:99], v[232:235]
    v_exp_f16_sdwa v250, v251 dst_sel:WORD_1 dst_unused:UNUSED_PRESERVE src0_sel:WORD_1
    v_mfma_f32_16x16x32_bf16 v[232:235], v[212:215], v[100:103], v[232:235]
    v_pk_fma_f16 v250, v250, s61, s61
    v_pk_fma_f16 v253, v252, v252, s60
    v_mfma_f32_16x16x32_bf16 v[232:235], v[216:219], v[104:107], v[232:235]
    v_rcp_f16_sdwa v251, v250 dst_sel:WORD_0 dst_unused:UNUSED_PAD src0_sel:WORD_0
    s_add_u32 s64, s64, 1
    s_cmp_eq_u32 s64, 8
    s_waitcnt lgkmcnt(0)
    s_barrier
    s_cbranch_scc1 L_P_last0
    v_mfma_f32_16x16x32_bf16 v[236:239], v[196:199], v[124:127], 0
    v_rcp_f16_sdwa v250, v250 dst_sel:WORD_0 dst_unused:UNUSED_PAD src0_sel:WORD_1
    v_mfma_f32_16x16x32_bf16 v[240:243], v[196:199], v[148:151], 0
    v_fma_mix_f32 v222, v222, v251, 0 op_sel_hi:[0,1,0]
    v_fma_mix_f32 v223, v223, v250, 0 op_sel_hi:[0,1,0]
    v_mfma_f32_16x16x32_bf16 v[236:239], v[200:203], v[128:131], v[236:239]
    ds_read_b64_tr_b16 v[196:197], v1 offset:12288
    v_cvt_pk_bf16_f32 v109, v222, v223
    v_mfma_f32_16x16x32_bf16 v[240:243], v[200:203], v[152:155], v[240:243]
    ds_read_b64_tr_b16 v[198:199], v1 offset:12544
    v_pk_mul_f16 v253, v252, v253 neg_lo:[1,0] neg_hi:[1,0]
    v_mfma_f32_16x16x32_bf16 v[236:239], v[204:207], v[132:135], v[236:239]
    ds_read_b64_tr_b16 v[200:201], v1 offset:14336
    v_cvt_pk_f16_f32 v254, v226, v227
    v_mfma_f32_16x16x32_bf16 v[240:243], v[204:207], v[156:159], v[240:243]
    ds_read_b64_tr_b16 v[202:203], v1 offset:14592
    v_pk_fma_f16 v255, v254, v254, s60
    v_mfma_f32_16x16x32_bf16 v[236:239], v[208:211], v[136:139], v[236:239]
    ds_read_b64_tr_b16 v[204:205], v1 offset:16384
    v_pk_mul_f16 v255, v254, v255 neg_lo:[1,0] neg_hi:[1,0]
    v_mfma_f32_16x16x32_bf16 v[240:243], v[208:211], v[160:163], v[240:243]
    ds_read_b64_tr_b16 v[206:207], v1 offset:16640
    v_cvt_pk_f16_f32 v248, v228, v229
    v_mfma_f32_16x16x32_bf16 v[236:239], v[212:215], v[140:143], v[236:239]
    ds_read_b64_tr_b16 v[208:209], v1 offset:18432
    v_pk_fma_f16 v249, v248, v248, s60
    v_mfma_f32_16x16x32_bf16 v[240:243], v[212:215], v[164:167], v[240:243]
    ds_read_b64_tr_b16 v[210:211], v1 offset:18688
    v_pk_mul_f16 v249, v248, v249 neg_lo:[1,0] neg_hi:[1,0]
    v_mfma_f32_16x16x32_bf16 v[236:239], v[216:219], v[144:147], v[236:239]
    ds_read_b64_tr_b16 v[212:213], v1 offset:20480
    v_mfma_f32_16x16x32_bf16 v[240:243], v[216:219], v[168:171], v[240:243]
    ds_read_b64_tr_b16 v[214:215], v1 offset:20736
    ds_read_b64_tr_b16 v[216:217], v1 offset:22528
    ds_read_b64_tr_b16 v[218:219], v1 offset:22784
    v_exp_f16_sdwa v252, v253 dst_sel:WORD_0 dst_unused:UNUSED_PAD src0_sel:WORD_0
    v_exp_f16_sdwa v254, v255 dst_sel:WORD_0 dst_unused:UNUSED_PAD src0_sel:WORD_0
    v_exp_f16_sdwa v252, v253 dst_sel:WORD_1 dst_unused:UNUSED_PRESERVE src0_sel:WORD_1
    v_exp_f16_sdwa v254, v255 dst_sel:WORD_1 dst_unused:UNUSED_PRESERVE src0_sel:WORD_1
    v_pk_fma_f16 v252, v252, s61, s61
    v_rcp_f16_sdwa v253, v252 dst_sel:WORD_0 dst_unused:UNUSED_PAD src0_sel:WORD_0
    v_pk_fma_f16 v254, v254, s61, s61
    v_rcp_f16_sdwa v252, v252 dst_sel:WORD_0 dst_unused:UNUSED_PAD src0_sel:WORD_1
    v_fma_mix_f32 v224, v224, v253, 0 op_sel_hi:[0,1,0]
    v_fma_mix_f32 v225, v225, v252, 0 op_sel_hi:[0,1,0]
    v_cvt_pk_bf16_f32 v110, v224, v225
    v_rcp_f16_sdwa v255, v254 dst_sel:WORD_0 dst_unused:UNUSED_PAD src0_sel:WORD_0
    v_exp_f16_sdwa v248, v249 dst_sel:WORD_0 dst_unused:UNUSED_PAD src0_sel:WORD_0
    v_rcp_f16_sdwa v254, v254 dst_sel:WORD_0 dst_unused:UNUSED_PAD src0_sel:WORD_1
    v_fma_mix_f32 v226, v226, v255, 0 op_sel_hi:[0,1,0]
    v_fma_mix_f32 v227, v227, v254, 0 op_sel_hi:[0,1,0]
    v_cvt_pk_bf16_f32 v111, v226, v227
    v_exp_f16_sdwa v248, v249 dst_sel:WORD_1 dst_unused:UNUSED_PRESERVE src0_sel:WORD_1
    v_cvt_pk_f16_f32 v250, v230, v231
    v_pk_fma_f16 v248, v248, s61, s61
    v_rcp_f16_sdwa v249, v248 dst_sel:WORD_0 dst_unused:UNUSED_PAD src0_sel:WORD_0
    v_pk_fma_f16 v251, v250, v250, s60
    v_rcp_f16_sdwa v248, v248 dst_sel:WORD_0 dst_unused:UNUSED_PAD src0_sel:WORD_1
    v_fma_mix_f32 v228, v228, v249, 0 op_sel_hi:[0,1,0]
    v_fma_mix_f32 v229, v229, v248, 0 op_sel_hi:[0,1,0]
    v_cvt_pk_bf16_f32 v112, v228, v229
    v_pk_mul_f16 v251, v250, v251 neg_lo:[1,0] neg_hi:[1,0]
    v_exp_f16_sdwa v250, v251 dst_sel:WORD_0 dst_unused:UNUSED_PAD src0_sel:WORD_0
    v_cvt_pk_f16_f32 v252, v232, v233
    v_exp_f16_sdwa v250, v251 dst_sel:WORD_1 dst_unused:UNUSED_PRESERVE src0_sel:WORD_1
    v_pk_fma_f16 v253, v252, v252, s60
    v_pk_fma_f16 v250, v250, s61, s61
    v_rcp_f16_sdwa v251, v250 dst_sel:WORD_0 dst_unused:UNUSED_PAD src0_sel:WORD_0
    v_pk_mul_f16 v253, v252, v253 neg_lo:[1,0] neg_hi:[1,0]
    v_rcp_f16_sdwa v250, v250 dst_sel:WORD_0 dst_unused:UNUSED_PAD src0_sel:WORD_1
    v_fma_mix_f32 v230, v230, v251, 0 op_sel_hi:[0,1,0]
    v_fma_mix_f32 v231, v231, v250, 0 op_sel_hi:[0,1,0]
    v_cvt_pk_bf16_f32 v113, v230, v231
    v_exp_f16_sdwa v252, v253 dst_sel:WORD_0 dst_unused:UNUSED_PAD src0_sel:WORD_0
    v_cvt_pk_f16_f32 v254, v234, v235
    v_exp_f16_sdwa v252, v253 dst_sel:WORD_1 dst_unused:UNUSED_PRESERVE src0_sel:WORD_1
    v_pk_fma_f16 v255, v254, v254, s60
    v_pk_fma_f16 v252, v252, s61, s61
    v_rcp_f16_sdwa v253, v252 dst_sel:WORD_0 dst_unused:UNUSED_PAD src0_sel:WORD_0
    v_pk_mul_f16 v255, v254, v255 neg_lo:[1,0] neg_hi:[1,0]
    v_rcp_f16_sdwa v252, v252 dst_sel:WORD_0 dst_unused:UNUSED_PAD src0_sel:WORD_1
    v_fma_mix_f32 v232, v232, v253, 0 op_sel_hi:[0,1,0]
    v_fma_mix_f32 v233, v233, v252, 0 op_sel_hi:[0,1,0]
    v_cvt_pk_bf16_f32 v114, v232, v233
    v_exp_f16_sdwa v254, v255 dst_sel:WORD_0 dst_unused:UNUSED_PAD src0_sel:WORD_0
    v_cvt_pk_f16_f32 v248, v236, v237
    v_exp_f16_sdwa v254, v255 dst_sel:WORD_1 dst_unused:UNUSED_PRESERVE src0_sel:WORD_1
    v_pk_fma_f16 v249, v248, v248, s60
    v_pk_fma_f16 v254, v254, s61, s61
    v_rcp_f16_sdwa v255, v254 dst_sel:WORD_0 dst_unused:UNUSED_PAD src0_sel:WORD_0
    v_pk_mul_f16 v249, v248, v249 neg_lo:[1,0] neg_hi:[1,0]
    v_rcp_f16_sdwa v254, v254 dst_sel:WORD_0 dst_unused:UNUSED_PAD src0_sel:WORD_1
    v_fma_mix_f32 v234, v234, v255, 0 op_sel_hi:[0,1,0]
    v_fma_mix_f32 v235, v235, v254, 0 op_sel_hi:[0,1,0]
    v_cvt_pk_bf16_f32 v115, v234, v235
    v_exp_f16_sdwa v248, v249 dst_sel:WORD_0 dst_unused:UNUSED_PAD src0_sel:WORD_0
    v_cvt_pk_f16_f32 v250, v238, v239
    v_exp_f16_sdwa v248, v249 dst_sel:WORD_1 dst_unused:UNUSED_PRESERVE src0_sel:WORD_1
    v_pk_fma_f16 v251, v250, v250, s60
    v_pk_fma_f16 v248, v248, s61, s61
    v_rcp_f16_sdwa v249, v248 dst_sel:WORD_0 dst_unused:UNUSED_PAD src0_sel:WORD_0
    v_pk_mul_f16 v251, v250, v251 neg_lo:[1,0] neg_hi:[1,0]
    v_rcp_f16_sdwa v248, v248 dst_sel:WORD_0 dst_unused:UNUSED_PAD src0_sel:WORD_1
    v_fma_mix_f32 v236, v236, v249, 0 op_sel_hi:[0,1,0]
    v_fma_mix_f32 v237, v237, v248, 0 op_sel_hi:[0,1,0]
    v_cvt_pk_bf16_f32 v116, v236, v237
    v_exp_f16_sdwa v250, v251 dst_sel:WORD_0 dst_unused:UNUSED_PAD src0_sel:WORD_0
    v_cvt_pk_f16_f32 v252, v240, v241
    v_exp_f16_sdwa v250, v251 dst_sel:WORD_1 dst_unused:UNUSED_PRESERVE src0_sel:WORD_1
    v_pk_fma_f16 v253, v252, v252, s60
    v_pk_fma_f16 v250, v250, s61, s61
    v_rcp_f16_sdwa v251, v250 dst_sel:WORD_0 dst_unused:UNUSED_PAD src0_sel:WORD_0
    v_pk_mul_f16 v253, v252, v253 neg_lo:[1,0] neg_hi:[1,0]
    v_rcp_f16_sdwa v250, v250 dst_sel:WORD_0 dst_unused:UNUSED_PAD src0_sel:WORD_1
    v_fma_mix_f32 v238, v238, v251, 0 op_sel_hi:[0,1,0]
    v_fma_mix_f32 v239, v239, v250, 0 op_sel_hi:[0,1,0]
    v_cvt_pk_bf16_f32 v117, v238, v239
    v_exp_f16_sdwa v252, v253 dst_sel:WORD_0 dst_unused:UNUSED_PAD src0_sel:WORD_0
    v_cvt_pk_f16_f32 v254, v242, v243
    v_exp_f16_sdwa v252, v253 dst_sel:WORD_1 dst_unused:UNUSED_PRESERVE src0_sel:WORD_1
    v_pk_fma_f16 v255, v254, v254, s60
    v_pk_fma_f16 v252, v252, s61, s61
    v_rcp_f16_sdwa v253, v252 dst_sel:WORD_0 dst_unused:UNUSED_PAD src0_sel:WORD_0
    v_pk_mul_f16 v255, v254, v255 neg_lo:[1,0] neg_hi:[1,0]
    v_rcp_f16_sdwa v252, v252 dst_sel:WORD_0 dst_unused:UNUSED_PAD src0_sel:WORD_1
    s_waitcnt lgkmcnt(0)
    v_mfma_f32_16x16x32_bf16 v[220:223], v[196:199], v[12:15], 0
    ds_write2st64_b64 v2, v[108:109], v[110:111] offset0:61 offset1:62
    v_mfma_f32_16x16x32_bf16 v[220:223], v[200:203], v[16:19], v[220:223]
    v_exp_f16_sdwa v254, v255 dst_sel:WORD_0 dst_unused:UNUSED_PAD src0_sel:WORD_0
    v_mfma_f32_16x16x32_bf16 v[220:223], v[204:207], v[20:23], v[220:223]
    v_exp_f16_sdwa v254, v255 dst_sel:WORD_1 dst_unused:UNUSED_PRESERVE src0_sel:WORD_1
    v_mfma_f32_16x16x32_bf16 v[220:223], v[208:211], v[24:27], v[220:223]
    v_fma_mix_f32 v240, v240, v253, 0 op_sel_hi:[0,1,0]
    v_fma_mix_f32 v241, v241, v252, 0 op_sel_hi:[0,1,0]
    v_mfma_f32_16x16x32_bf16 v[220:223], v[212:215], v[28:31], v[220:223]
    v_cvt_pk_bf16_f32 v118, v240, v241
    v_pk_fma_f16 v254, v254, s61, s61
    v_mfma_f32_16x16x32_bf16 v[220:223], v[216:219], v[32:35], v[220:223]
    v_rcp_f16_sdwa v255, v254 dst_sel:WORD_0 dst_unused:UNUSED_PAD src0_sel:WORD_0
    v_mfma_f32_16x16x32_bf16 v[224:227], v[196:199], v[36:39], 0
    ds_write2st64_b64 v2, v[112:113], v[114:115] offset0:69 offset1:70
    v_mfma_f32_16x16x32_bf16 v[224:227], v[200:203], v[40:43], v[224:227]
    v_rcp_f16_sdwa v254, v254 dst_sel:WORD_0 dst_unused:UNUSED_PAD src0_sel:WORD_1
    v_mfma_f32_16x16x32_bf16 v[224:227], v[204:207], v[44:47], v[224:227]
    v_fma_mix_f32 v242, v242, v255, 0 op_sel_hi:[0,1,0]
    v_fma_mix_f32 v243, v243, v254, 0 op_sel_hi:[0,1,0]
    v_mfma_f32_16x16x32_bf16 v[224:227], v[208:211], v[48:51], v[224:227]
    v_cvt_pk_bf16_f32 v119, v242, v243
    v_cvt_pk_f16_f32 v248, v220, v221
    v_mfma_f32_16x16x32_bf16 v[224:227], v[212:215], v[52:55], v[224:227]
    v_pk_fma_f16 v249, v248, v248, s60
    v_pk_mul_f16 v249, v248, v249 neg_lo:[1,0] neg_hi:[1,0]
    v_mfma_f32_16x16x32_bf16 v[224:227], v[216:219], v[56:59], v[224:227]
    v_exp_f16_sdwa v248, v249 dst_sel:WORD_0 dst_unused:UNUSED_PAD src0_sel:WORD_0
    v_mfma_f32_16x16x32_bf16 v[228:231], v[196:199], v[60:63], 0
    ds_write2st64_b64 v2, v[116:117], v[118:119] offset0:77 offset1:78
    v_mfma_f32_16x16x32_bf16 v[228:231], v[200:203], v[64:67], v[228:231]
    v_exp_f16_sdwa v248, v249 dst_sel:WORD_1 dst_unused:UNUSED_PRESERVE src0_sel:WORD_1
    v_mfma_f32_16x16x32_bf16 v[228:231], v[204:207], v[68:71], v[228:231]
    v_pk_fma_f16 v248, v248, s61, s61
    v_cvt_pk_f16_f32 v250, v222, v223
    v_mfma_f32_16x16x32_bf16 v[228:231], v[208:211], v[72:75], v[228:231]
    v_rcp_f16_sdwa v249, v248 dst_sel:WORD_0 dst_unused:UNUSED_PAD src0_sel:WORD_0
    v_mfma_f32_16x16x32_bf16 v[228:231], v[212:215], v[76:79], v[228:231]
    v_rcp_f16_sdwa v248, v248 dst_sel:WORD_0 dst_unused:UNUSED_PAD src0_sel:WORD_1
    v_mfma_f32_16x16x32_bf16 v[228:231], v[216:219], v[80:83], v[228:231]
    v_fma_mix_f32 v220, v220, v249, 0 op_sel_hi:[0,1,0]
    v_fma_mix_f32 v221, v221, v248, 0 op_sel_hi:[0,1,0]
    v_mfma_f32_16x16x32_bf16 v[232:235], v[196:199], v[84:87], 0
    v_cvt_pk_bf16_f32 v108, v220, v221
    v_pk_fma_f16 v251, v250, v250, s60
    v_mfma_f32_16x16x32_bf16 v[232:235], v[200:203], v[88:91], v[232:235]
    v_pk_mul_f16 v251, v250, v251 neg_lo:[1,0] neg_hi:[1,0]
    v_cvt_pk_f16_f32 v252, v224, v225
    v_mfma_f32_16x16x32_bf16 v[232:235], v[204:207], v[92:95], v[232:235]
    v_exp_f16_sdwa v250, v251 dst_sel:WORD_0 dst_unused:UNUSED_PAD src0_sel:WORD_0
    v_mfma_f32_16x16x32_bf16 v[232:235], v[208:211], v[96:99], v[232:235]
    v_exp_f16_sdwa v250, v251 dst_sel:WORD_1 dst_unused:UNUSED_PRESERVE src0_sel:WORD_1
    v_mfma_f32_16x16x32_bf16 v[232:235], v[212:215], v[100:103], v[232:235]
    v_pk_fma_f16 v250, v250, s61, s61
    v_pk_fma_f16 v253, v252, v252, s60
    v_mfma_f32_16x16x32_bf16 v[232:235], v[216:219], v[104:107], v[232:235]
    v_rcp_f16_sdwa v251, v250 dst_sel:WORD_0 dst_unused:UNUSED_PAD src0_sel:WORD_0
    v_mfma_f32_16x16x32_bf16 v[236:239], v[196:199], v[124:127], 0
    v_rcp_f16_sdwa v250, v250 dst_sel:WORD_0 dst_unused:UNUSED_PAD src0_sel:WORD_1
    v_mfma_f32_16x16x32_bf16 v[236:239], v[200:203], v[128:131], v[236:239]
    v_fma_mix_f32 v222, v222, v251, 0 op_sel_hi:[0,1,0]
    v_fma_mix_f32 v223, v223, v250, 0 op_sel_hi:[0,1,0]
    v_mfma_f32_16x16x32_bf16 v[236:239], v[204:207], v[132:135], v[236:239]
    v_cvt_pk_bf16_f32 v109, v222, v223
    v_pk_mul_f16 v253, v252, v253 neg_lo:[1,0] neg_hi:[1,0]
    v_mfma_f32_16x16x32_bf16 v[236:239], v[208:211], v[136:139], v[236:239]
    v_exp_f16_sdwa v252, v253 dst_sel:WORD_0 dst_unused:UNUSED_PAD src0_sel:WORD_0
    v_mfma_f32_16x16x32_bf16 v[236:239], v[212:215], v[140:143], v[236:239]
    v_exp_f16_sdwa v252, v253 dst_sel:WORD_1 dst_unused:UNUSED_PRESERVE src0_sel:WORD_1
    v_mfma_f32_16x16x32_bf16 v[236:239], v[216:219], v[144:147], v[236:239]
    v_pk_fma_f16 v252, v252, s61, s61
    v_cvt_pk_f16_f32 v254, v226, v227
    s_waitcnt lgkmcnt(0)
    s_barrier
    s_branch L_P_loop
L_P_pre1:
    s_setprio 1
    v_mfma_f32_16x16x32_bf16 v[220:223], v[196:199], v[12:15], 0
    v_mfma_f32_16x16x32_bf16 v[220:223], v[200:203], v[16:19], v[220:223]
    v_mfma_f32_16x16x32_bf16 v[220:223], v[204:207], v[20:23], v[220:223]
    v_mfma_f32_16x16x32_bf16 v[220:223], v[208:211], v[24:27], v[220:223]
    v_mfma_f32_16x16x32_bf16 v[220:223], v[212:215], v[28:31], v[220:223]
    v_mfma_f32_16x16x32_bf16 v[220:223], v[216:219], v[32:35], v[220:223]
    v_mfma_f32_16x16x32_bf16 v[224:227], v[196:199], v[36:39], 0
    v_mfma_f32_16x16x32_bf16 v[224:227], v[200:203], v[40:43], v[224:227]
    v_mfma_f32_16x16x32_bf16 v[224:227], v[204:207], v[44:47], v[224:227]
    s_nop 4
    v_cvt_pk_f16_f32 v248, v220, v221
    v_mfma_f32_16x16x32_bf16 v[224:227], v[208:211], v[48:51], v[224:227]
    v_pk_fma_f16 v249, v248, v248, s60
    v_pk_mul_f16 v249, v248, v249 neg_lo:[1,0] neg_hi:[1,0]
    v_mfma_f32_16x16x32_bf16 v[224:227], v[212:215], v[52:55], v[224:227]
    v_exp_f16_sdwa v248, v249 dst_sel:WORD_0 dst_unused:UNUSED_PAD src0_sel:WORD_0
    v_mfma_f32_16x16x32_bf16 v[224:227], v[216:219], v[56:59], v[224:227]
    v_exp_f16_sdwa v248, v249 dst_sel:WORD_1 dst_unused:UNUSED_PRESERVE src0_sel:WORD_1
    s_waitcnt lgkmcnt(12)
    v_mfma_f32_16x16x32_bf16 v[228:231], v[196:199], v[60:63], 0
    v_mfma_f32_16x16x32_bf16 v[228:231], v[200:203], v[64:67], v[228:231]
    v_pk_fma_f16 v248, v248, s61, s61
    v_cvt_pk_f16_f32 v250, v222, v223
    v_mfma_f32_16x16x32_bf16 v[228:231], v[204:207], v[68:71], v[228:231]
    v_rcp_f16_sdwa v249, v248 dst_sel:WORD_0 dst_unused:UNUSED_PAD src0_sel:WORD_0
    v_mfma_f32_16x16x32_bf16 v[228:231], v[208:211], v[72:75], v[228:231]
    v_rcp_f16_sdwa v248, v248 dst_sel:WORD_0 dst_unused:UNUSED_PAD src0_sel:WORD_1
    v_mfma_f32_16x16x32_bf16 v[228:231], v[212:215], v[76:79], v[228:231]
    v_fma_mix_f32 v220, v220, v249, 0 op_sel_hi:[0,1,0]
    v_fma_mix_f32 v221, v221, v248, 0 op_sel_hi:[0,1,0]
    v_mfma_f32_16x16x32_bf16 v[228:231], v[216:219], v[80:83], v[228:231]
    v_cvt_pk_bf16_f32 v108, v220, v221
    v_pk_fma_f16 v251, v250, v250, s60
    v_mfma_f32_16x16x32_bf16 v[232:235], v[196:199], v[84:87], 0
    v_mfma_f32_16x16x32_bf16 v[232:235], v[200:203], v[88:91], v[232:235]
    v_pk_mul_f16 v251, v250, v251 neg_lo:[1,0] neg_hi:[1,0]
    v_cvt_pk_f16_f32 v252, v224, v225
    v_mfma_f32_16x16x32_bf16 v[232:235], v[204:207], v[92:95], v[232:235]
    v_exp_f16_sdwa v250, v251 dst_sel:WORD_0 dst_unused:UNUSED_PAD src0_sel:WORD_0
    v_mfma_f32_16x16x32_bf16 v[232:235], v[208:211], v[96:99], v[232:235]
    v_exp_f16_sdwa v250, v251 dst_sel:WORD_1 dst_unused:UNUSED_PRESERVE src0_sel:WORD_1
    v_mfma_f32_16x16x32_bf16 v[232:235], v[212:215], v[100:103], v[232:235]
    v_pk_fma_f16 v250, v250, s61, s61
    v_pk_fma_f16 v253, v252, v252, s60
    v_mfma_f32_16x16x32_bf16 v[232:235], v[216:219], v[104:107], v[232:235]
    v_rcp_f16_sdwa v251, v250 dst_sel:WORD_0 dst_unused:UNUSED_PAD src0_sel:WORD_0
    s_waitcnt lgkmcnt(0)
    s_waitcnt lgkmcnt(0)
    s_barrier
    s_branch L_P_mid
L_P_last1:
    v_mfma_f32_16x16x32_bf16 v[240:243], v[196:199], v[148:151], 0
    v_rcp_f16_sdwa v253, v252 dst_sel:WORD_0 dst_unused:UNUSED_PAD src0_sel:WORD_0
    v_mfma_f32_16x16x32_bf16 v[244:247], v[196:199], v[172:175], 0
    v_rcp_f16_sdwa v252, v252 dst_sel:WORD_0 dst_unused:UNUSED_PAD src0_sel:WORD_1
    v_mfma_f32_16x16x32_bf16 v[240:243], v[200:203], v[152:155], v[240:243]
    v_fma_mix_f32 v224, v224, v253, 0 op_sel_hi:[0,1,0]
    v_mfma_f32_16x16x32_bf16 v[244:247], v[200:203], v[176:179], v[244:247]
    v_fma_mix_f32 v225, v225, v252, 0 op_sel_hi:[0,1,0]
    v_mfma_f32_16x16x32_bf16 v[240:243], v[204:207], v[156:159], v[240:243]
    v_cvt_pk_bf16_f32 v110, v224, v225
    v_mfma_f32_16x16x32_bf16 v[244:247], v[204:207], v[180:183], v[244:247]
    v_pk_fma_f16 v255, v254, v254, s60
    v_mfma_f32_16x16x32_bf16 v[240:243], v[208:211], v[160:163], v[240:243]
    v_pk_mul_f16 v255, v254, v255 neg_lo:[1,0] neg_hi:[1,0]
    v_mfma_f32_16x16x32_bf16 v[244:247], v[208:211], v[184:187], v[244:247]
    v_cvt_pk_f16_f32 v248, v228, v229
    v_mfma_f32_16x16x32_bf16 v[240:243], v[212:215], v[164:167], v[240:243]
    v_pk_fma_f16 v249, v248, v248, s60
    v_mfma_f32_16x16x32_bf16 v[244:247], v[212:215], v[188:191], v[244:247]
    v_pk_mul_f16 v249, v248, v249 neg_lo:[1,0] neg_hi:[1,0]
    v_mfma_f32_16x16x32_bf16 v[240:243], v[216:219], v[168:171], v[240:243]
    v_cvt_pk_f16_f32 v250, v230, v231
    v_mfma_f32_16x16x32_bf16 v[244:247], v[216:219], v[192:195], v[244:247]
    v_exp_f16_sdwa v254, v255 dst_sel:WORD_0 dst_unused:UNUSED_PAD src0_sel:WORD_0
    v_exp_f16_sdwa v248, v249 dst_sel:WORD_0 dst_unused:UNUSED_PAD src0_sel:WORD_0
    v_exp_f16_sdwa v254, v255 dst_sel:WORD_1 dst_unused:UNUSED_PRESERVE src0_sel:WORD_1
    v_exp_f16_sdwa v248, v249 dst_sel:WORD_1 dst_unused:UNUSED_PRESERVE src0_sel:WORD_1
    v_pk_fma_f16 v254, v254, s61, s61
    v_rcp_f16_sdwa v255, v254 dst_sel:WORD_0 dst_unused:UNUSED_PAD src0_sel:WORD_0
    v_pk_fma_f16 v248, v248, s61, s61
    v_rcp_f16_sdwa v254, v254 dst_sel:WORD_0 dst_unused:UNUSED_PAD src0_sel:WORD_1
    v_fma_mix_f32 v226, v226, v255, 0 op_sel_hi:[0,1,0]
    v_fma_mix_f32 v227, v227, v254, 0 op_sel_hi:[0,1,0]
    v_cvt_pk_bf16_f32 v111, v226, v227
    v_rcp_f16_sdwa v249, v248 dst_sel:WORD_0 dst_unused:UNUSED_PAD src0_sel:WORD_0
    v_pk_fma_f16 v251, v250, v250, s60
    v_rcp_f16_sdwa v248, v248 dst_sel:WORD_0 dst_unused:UNUSED_PAD src0_sel:WORD_1
    v_fma_mix_f32 v228, v228, v249, 0 op_sel_hi:[0,1,0]
    v_fma_mix_f32 v229, v229, v248, 0 op_sel_hi:[0,1,0]
    v_cvt_pk_bf16_f32 v112, v228, v229
    v_pk_mul_f16 v251, v250, v251 neg_lo:[1,0] neg_hi:[1,0]
    v_exp_f16_sdwa v250, v251 dst_sel:WORD_0 dst_unused:UNUSED_PAD src0_sel:WORD_0
    v_cvt_pk_f16_f32 v252, v232, v233
    v_exp_f16_sdwa v250, v251 dst_sel:WORD_1 dst_unused:UNUSED_PRESERVE src0_sel:WORD_1
    v_pk_fma_f16 v253, v252, v252, s60
    v_pk_fma_f16 v250, v250, s61, s61
    v_rcp_f16_sdwa v251, v250 dst_sel:WORD_0 dst_unused:UNUSED_PAD src0_sel:WORD_0
    v_pk_mul_f16 v253, v252, v253 neg_lo:[1,0] neg_hi:[1,0]
    v_rcp_f16_sdwa v250, v250 dst_sel:WORD_0 dst_unused:UNUSED_PAD src0_sel:WORD_1
    v_fma_mix_f32 v230, v230, v251, 0 op_sel_hi:[0,1,0]
    v_fma_mix_f32 v231, v231, v250, 0 op_sel_hi:[0,1,0]
    v_cvt_pk_bf16_f32 v113, v230, v231
    v_exp_f16_sdwa v252, v253 dst_sel:WORD_0 dst_unused:UNUSED_PAD src0_sel:WORD_0
    v_cvt_pk_f16_f32 v254, v234, v235
    v_exp_f16_sdwa v252, v253 dst_sel:WORD_1 dst_unused:UNUSED_PRESERVE src0_sel:WORD_1
    v_pk_fma_f16 v255, v254, v254, s60
    v_pk_fma_f16 v252, v252, s61, s61
    v_rcp_f16_sdwa v253, v252 dst_sel:WORD_0 dst_unused:UNUSED_PAD src0_sel:WORD_0
    v_pk_mul_f16 v255, v254, v255 neg_lo:[1,0] neg_hi:[1,0]
    v_rcp_f16_sdwa v252, v252 dst_sel:WORD_0 dst_unused:UNUSED_PAD src0_sel:WORD_1
    v_fma_mix_f32 v232, v232, v253, 0 op_sel_hi:[0,1,0]
    v_fma_mix_f32 v233, v233, v252, 0 op_sel_hi:[0,1,0]
    v_cvt_pk_bf16_f32 v114, v232, v233
    v_exp_f16_sdwa v254, v255 dst_sel:WORD_0 dst_unused:UNUSED_PAD src0_sel:WORD_0
    v_cvt_pk_f16_f32 v248, v236, v237
    v_exp_f16_sdwa v254, v255 dst_sel:WORD_1 dst_unused:UNUSED_PRESERVE src0_sel:WORD_1
    v_pk_fma_f16 v249, v248, v248, s60
    v_pk_fma_f16 v254, v254, s61, s61
    v_rcp_f16_sdwa v255, v254 dst_sel:WORD_0 dst_unused:UNUSED_PAD src0_sel:WORD_0
    v_pk_mul_f16 v249, v248, v249 neg_lo:[1,0] neg_hi:[1,0]
    v_rcp_f16_sdwa v254, v254 dst_sel:WORD_0 dst_unused:UNUSED_PAD src0_sel:WORD_1
    v_fma_mix_f32 v234, v234, v255, 0 op_sel_hi:[0,1,0]
    v_fma_mix_f32 v235, v235, v254, 0 op_sel_hi:[0,1,0]
    v_cvt_pk_bf16_f32 v115, v234, v235
    v_exp_f16_sdwa v248, v249 dst_sel:WORD_0 dst_unused:UNUSED_PAD src0_sel:WORD_0
    v_cvt_pk_f16_f32 v250, v238, v239
    v_exp_f16_sdwa v248, v249 dst_sel:WORD_1 dst_unused:UNUSED_PRESERVE src0_sel:WORD_1
    v_pk_fma_f16 v251, v250, v250, s60
    v_pk_fma_f16 v248, v248, s61, s61
    v_rcp_f16_sdwa v249, v248 dst_sel:WORD_0 dst_unused:UNUSED_PAD src0_sel:WORD_0
    v_pk_mul_f16 v251, v250, v251 neg_lo:[1,0] neg_hi:[1,0]
    v_rcp_f16_sdwa v248, v248 dst_sel:WORD_0 dst_unused:UNUSED_PAD src0_sel:WORD_1
    v_fma_mix_f32 v236, v236, v249, 0 op_sel_hi:[0,1,0]
    v_fma_mix_f32 v237, v237, v248, 0 op_sel_hi:[0,1,0]
    v_cvt_pk_bf16_f32 v116, v236, v237
    v_exp_f16_sdwa v250, v251 dst_sel:WORD_0 dst_unused:UNUSED_PAD src0_sel:WORD_0
    v_cvt_pk_f16_f32 v252, v240, v241
    v_exp_f16_sdwa v250, v251 dst_sel:WORD_1 dst_unused:UNUSED_PRESERVE src0_sel:WORD_1
    v_pk_fma_f16 v253, v252, v252, s60
    v_pk_fma_f16 v250, v250, s61, s61
    v_rcp_f16_sdwa v251, v250 dst_sel:WORD_0 dst_unused:UNUSED_PAD src0_sel:WORD_0
    v_pk_mul_f16 v253, v252, v253 neg_lo:[1,0] neg_hi:[1,0]
    v_rcp_f16_sdwa v250, v250 dst_sel:WORD_0 dst_unused:UNUSED_PAD src0_sel:WORD_1
    v_fma_mix_f32 v238, v238, v251, 0 op_sel_hi:[0,1,0]
    v_fma_mix_f32 v239, v239, v250, 0 op_sel_hi:[0,1,0]
    v_cvt_pk_bf16_f32 v117, v238, v239
    v_exp_f16_sdwa v252, v253 dst_sel:WORD_0 dst_unused:UNUSED_PAD src0_sel:WORD_0
    v_cvt_pk_f16_f32 v254, v242, v243
    v_exp_f16_sdwa v252, v253 dst_sel:WORD_1 dst_unused:UNUSED_PRESERVE src0_sel:WORD_1
    v_pk_fma_f16 v255, v254, v254, s60
    v_pk_fma_f16 v252, v252, s61, s61
    v_rcp_f16_sdwa v253, v252 dst_sel:WORD_0 dst_unused:UNUSED_PAD src0_sel:WORD_0
    v_pk_mul_f16 v255, v254, v255 neg_lo:[1,0] neg_hi:[1,0]
    v_rcp_f16_sdwa v252, v252 dst_sel:WORD_0 dst_unused:UNUSED_PAD src0_sel:WORD_1
    v_fma_mix_f32 v240, v240, v253, 0 op_sel_hi:[0,1,0]
    v_fma_mix_f32 v241, v241, v252, 0 op_sel_hi:[0,1,0]
    v_cvt_pk_bf16_f32 v118, v240, v241
    v_exp_f16_sdwa v254, v255 dst_sel:WORD_0 dst_unused:UNUSED_PAD src0_sel:WORD_0
    v_cvt_pk_f16_f32 v248, v244, v245
    v_exp_f16_sdwa v254, v255 dst_sel:WORD_1 dst_unused:UNUSED_PRESERVE src0_sel:WORD_1
    v_pk_fma_f16 v249, v248, v248, s60
    v_pk_fma_f16 v254, v254, s61, s61
    v_rcp_f16_sdwa v255, v254 dst_sel:WORD_0 dst_unused:UNUSED_PAD src0_sel:WORD_0
    v_pk_mul_f16 v249, v248, v249 neg_lo:[1,0] neg_hi:[1,0]
    v_rcp_f16_sdwa v254, v254 dst_sel:WORD_0 dst_unused:UNUSED_PAD src0_sel:WORD_1
    v_fma_mix_f32 v242, v242, v255, 0 op_sel_hi:[0,1,0]
    v_fma_mix_f32 v243, v243, v254, 0 op_sel_hi:[0,1,0]
    v_cvt_pk_bf16_f32 v119, v242, v243
    v_exp_f16_sdwa v248, v249 dst_sel:WORD_0 dst_unused:UNUSED_PAD src0_sel:WORD_0
    v_cvt_pk_f16_f32 v250, v246, v247
    v_exp_f16_sdwa v248, v249 dst_sel:WORD_1 dst_unused:UNUSED_PRESERVE src0_sel:WORD_1
    v_pk_fma_f16 v251, v250, v250, s60
    v_pk_fma_f16 v248, v248, s61, s61
    v_rcp_f16_sdwa v249, v248 dst_sel:WORD_0 dst_unused:UNUSED_PAD src0_sel:WORD_0
    v_pk_mul_f16 v251, v250, v251 neg_lo:[1,0] neg_hi:[1,0]
    v_rcp_f16_sdwa v248, v248 dst_sel:WORD_0 dst_unused:UNUSED_PAD src0_sel:WORD_1
    v_fma_mix_f32 v244, v244, v249, 0 op_sel_hi:[0,1,0]
    v_fma_mix_f32 v245, v245, v248, 0 op_sel_hi:[0,1,0]
    v_cvt_pk_bf16_f32 v120, v244, v245
    ds_write2st64_b64 v2, v[108:109], v[110:111] offset0:61 offset1:62
    v_exp_f16_sdwa v250, v251 dst_sel:WORD_0 dst_unused:UNUSED_PAD src0_sel:WORD_0
    s_nop 0
    v_exp_f16_sdwa v250, v251 dst_sel:WORD_1 dst_unused:UNUSED_PRESERVE src0_sel:WORD_1
    s_nop 0
    v_pk_fma_f16 v250, v250, s61, s61
    v_rcp_f16_sdwa v251, v250 dst_sel:WORD_0 dst_unused:UNUSED_PAD src0_sel:WORD_0
    v_rcp_f16_sdwa v250, v250 dst_sel:WORD_0 dst_unused:UNUSED_PAD src0_sel:WORD_1
    ds_write2st64_b64 v2, v[112:113], v[114:115] offset0:69 offset1:70
    v_fma_mix_f32 v246, v246, v251, 0 op_sel_hi:[0,1,0]
    v_fma_mix_f32 v247, v247, v250, 0 op_sel_hi:[0,1,0]
    v_cvt_pk_bf16_f32 v121, v246, v247
    ds_write2st64_b64 v2, v[116:117], v[118:119] offset0:77 offset1:78
    ds_write_b64 v3, v[120:121] offset:31232
    s_waitcnt lgkmcnt(0)
    s_barrier
    s_branch L_P_done
L_P_last0:
    v_mfma_f32_16x16x32_bf16 v[236:239], v[196:199], v[124:127], 0
    v_rcp_f16_sdwa v250, v250 dst_sel:WORD_0 dst_unused:UNUSED_PAD src0_sel:WORD_1
    v_mfma_f32_16x16x32_bf16 v[240:243], v[196:199], v[148:151], 0
    v_fma_mix_f32 v222, v222, v251, 0 op_sel_hi:[0,1,0]
    v_fma_mix_f32 v223, v223, v250, 0 op_sel_hi:[0,1,0]
    v_mfma_f32_16x16x32_bf16 v[236:239], v[200:203], v[128:131], v[236:239]
    v_cvt_pk_bf16_f32 v109, v222, v223
    v_mfma_f32_16x16x32_bf16 v[240:243], v[200:203], v[152:155], v[240:243]
    v_pk_mul_f16 v253, v252, v253 neg_lo:[1,0] neg_hi:[1,0]
    v_mfma_f32_16x16x32_bf16 v[236:239], v[204:207], v[132:135], v[236:239]
    v_cvt_pk_f16_f32 v254, v226, v227
    v_mfma_f32_16x16x32_bf16 v[240:243], v[204:207], v[156:159], v[240:243]
    v_pk_fma_f16 v255, v254, v254, s60
    v_mfma_f32_16x16x32_bf16 v[236:239], v[208:211], v[136:139], v[236:239]
    v_pk_mul_f16 v255, v254, v255 neg_lo:[1,0] neg_hi:[1,0]
    v_mfma_f32_16x16x32_bf16 v[240:243], v[208:211], v[160:163], v[240:243]
    v_cvt_pk_f16_f32 v248, v228, v229
    v_mfma_f32_16x16x32_bf16 v[236:239], v[212:215], v[140:143], v[236:239]
    v_pk_fma_f16 v249, v248, v248, s60
    v_mfma_f32_16x16x32_bf16 v[240:243], v[212:215], v[164:167], v[240:243]
    v_pk_mul_f16 v249, v248, v249 neg_lo:[1,0] neg_hi:[1,0]
    v_mfma_f32_16x16x32_bf16 v[236:239], v[216:219], v[144:147], v[236:239]
    v_mfma_f32_16x16x32_bf16 v[240:243], v[216:219], v[168:171], v[240:243]
    v_exp_f16_sdwa v252, v253 dst_sel:WORD_0 dst_unused:UNUSED_PAD src0_sel:WORD_0
    v_exp_f16_sdwa v254, v255 dst_sel:WORD_0 dst_unused:UNUSED_PAD src0_sel:WORD_0
    v_exp_f16_sdwa v252, v253 dst_sel:WORD_1 dst_unused:UNUSED_PRESERVE src0_sel:WORD_1
    v_exp_f16_sdwa v254, v255 dst_sel:WORD_1 dst_unused:UNUSED_PRESERVE src0_sel:WORD_1
    v_pk_fma_f16 v252, v252, s61, s61
    v_rcp_f16_sdwa v253, v252 dst_sel:WORD_0 dst_unused:UNUSED_PAD src0_sel:WORD_0
    v_pk_fma_f16 v254, v254, s61, s61
    v_rcp_f16_sdwa v252, v252 dst_sel:WORD_0 dst_unused:UNUSED_PAD src0_sel:WORD_1
    v_fma_mix_f32 v224, v224, v253, 0 op_sel_hi:[0,1,0]
    v_fma_mix_f32 v225, v225, v252, 0 op_sel_hi:[0,1,0]
    v_cvt_pk_bf16_f32 v110, v224, v225
    v_rcp_f16_sdwa v255, v254 dst_sel:WORD_0 dst_unused:UNUSED_PAD src0_sel:WORD_0
    v_exp_f16_sdwa v248, v249 dst_sel:WORD_0 dst_unused:UNUSED_PAD src0_sel:WORD_0
    v_rcp_f16_sdwa v254, v254 dst_sel:WORD_0 dst_unused:UNUSED_PAD src0_sel:WORD_1
    v_fma_mix_f32 v226, v226, v255, 0 op_sel_hi:[0,1,0]
    v_fma_mix_f32 v227, v227, v254, 0 op_sel_hi:[0,1,0]
    v_cvt_pk_bf16_f32 v111, v226, v227
    v_exp_f16_sdwa v248, v249 dst_sel:WORD_1 dst_unused:UNUSED_PRESERVE src0_sel:WORD_1
    v_cvt_pk_f16_f32 v250, v230, v231
    v_pk_fma_f16 v248, v248, s61, s61
    v_rcp_f16_sdwa v249, v248 dst_sel:WORD_0 dst_unused:UNUSED_PAD src0_sel:WORD_0
    v_pk_fma_f16 v251, v250, v250, s60
    v_rcp_f16_sdwa v248, v248 dst_sel:WORD_0 dst_unused:UNUSED_PAD src0_sel:WORD_1
    v_fma_mix_f32 v228, v228, v249, 0 op_sel_hi:[0,1,0]
    v_fma_mix_f32 v229, v229, v248, 0 op_sel_hi:[0,1,0]
    v_cvt_pk_bf16_f32 v112, v228, v229
    v_pk_mul_f16 v251, v250, v251 neg_lo:[1,0] neg_hi:[1,0]
    v_exp_f16_sdwa v250, v251 dst_sel:WORD_0 dst_unused:UNUSED_PAD src0_sel:WORD_0
    v_cvt_pk_f16_f32 v252, v232, v233
    v_exp_f16_sdwa v250, v251 dst_sel:WORD_1 dst_unused:UNUSED_PRESERVE src0_sel:WORD_1
    v_pk_fma_f16 v253, v252, v252, s60
    v_pk_fma_f16 v250, v250, s61, s61
    v_rcp_f16_sdwa v251, v250 dst_sel:WORD_0 dst_unused:UNUSED_PAD src0_sel:WORD_0
    v_pk_mul_f16 v253, v252, v253 neg_lo:[1,0] neg_hi:[1,0]
    v_rcp_f16_sdwa v250, v250 dst_sel:WORD_0 dst_unused:UNUSED_PAD src0_sel:WORD_1
    v_fma_mix_f32 v230, v230, v251, 0 op_sel_hi:[0,1,0]
    v_fma_mix_f32 v231, v231, v250, 0 op_sel_hi:[0,1,0]
    v_cvt_pk_bf16_f32 v113, v230, v231
    v_exp_f16_sdwa v252, v253 dst_sel:WORD_0 dst_unused:UNUSED_PAD src0_sel:WORD_0
    v_cvt_pk_f16_f32 v254, v234, v235
    v_exp_f16_sdwa v252, v253 dst_sel:WORD_1 dst_unused:UNUSED_PRESERVE src0_sel:WORD_1
    v_pk_fma_f16 v255, v254, v254, s60
    v_pk_fma_f16 v252, v252, s61, s61
    v_rcp_f16_sdwa v253, v252 dst_sel:WORD_0 dst_unused:UNUSED_PAD src0_sel:WORD_0
    v_pk_mul_f16 v255, v254, v255 neg_lo:[1,0] neg_hi:[1,0]
    v_rcp_f16_sdwa v252, v252 dst_sel:WORD_0 dst_unused:UNUSED_PAD src0_sel:WORD_1
    v_fma_mix_f32 v232, v232, v253, 0 op_sel_hi:[0,1,0]
    v_fma_mix_f32 v233, v233, v252, 0 op_sel_hi:[0,1,0]
    v_cvt_pk_bf16_f32 v114, v232, v233
    v_exp_f16_sdwa v254, v255 dst_sel:WORD_0 dst_unused:UNUSED_PAD src0_sel:WORD_0
    v_cvt_pk_f16_f32 v248, v236, v237
    v_exp_f16_sdwa v254, v255 dst_sel:WORD_1 dst_unused:UNUSED_PRESERVE src0_sel:WORD_1
    v_pk_fma_f16 v249, v248, v248, s60
    v_pk_fma_f16 v254, v254, s61, s61
    v_rcp_f16_sdwa v255, v254 dst_sel:WORD_0 dst_unused:UNUSED_PAD src0_sel:WORD_0
    v_pk_mul_f16 v249, v248, v249 neg_lo:[1,0] neg_hi:[1,0]
    v_rcp_f16_sdwa v254, v254 dst_sel:WORD_0 dst_unused:UNUSED_PAD src0_sel:WORD_1
    v_fma_mix_f32 v234, v234, v255, 0 op_sel_hi:[0,1,0]
    v_fma_mix_f32 v235, v235, v254, 0 op_sel_hi:[0,1,0]
    v_cvt_pk_bf16_f32 v115, v234, v235
    v_exp_f16_sdwa v248, v249 dst_sel:WORD_0 dst_unused:UNUSED_PAD src0_sel:WORD_0
    v_cvt_pk_f16_f32 v250, v238, v239
    v_exp_f16_sdwa v248, v249 dst_sel:WORD_1 dst_unused:UNUSED_PRESERVE src0_sel:WORD_1
    v_pk_fma_f16 v251, v250, v250, s60
    v_pk_fma_f16 v248, v248, s61, s61
    v_rcp_f16_sdwa v249, v248 dst_sel:WORD_0 dst_unused:UNUSED_PAD src0_sel:WORD_0
    v_pk_mul_f16 v251, v250, v251 neg_lo:[1,0] neg_hi:[1,0]
    v_rcp_f16_sdwa v248, v248 dst_sel:WORD_0 dst_unused:UNUSED_PAD src0_sel:WORD_1
    v_fma_mix_f32 v236, v236, v249, 0 op_sel_hi:[0,1,0]
    v_fma_mix_f32 v237, v237, v248, 0 op_sel_hi:[0,1,0]
    v_cvt_pk_bf16_f32 v116, v236, v237
    v_exp_f16_sdwa v250, v251 dst_sel:WORD_0 dst_unused:UNUSED_PAD src0_sel:WORD_0
    v_cvt_pk_f16_f32 v252, v240, v241
    v_exp_f16_sdwa v250, v251 dst_sel:WORD_1 dst_unused:UNUSED_PRESERVE src0_sel:WORD_1
    v_pk_fma_f16 v253, v252, v252, s60
    v_pk_fma_f16 v250, v250, s61, s61
    v_rcp_f16_sdwa v251, v250 dst_sel:WORD_0 dst_unused:UNUSED_PAD src0_sel:WORD_0
    v_pk_mul_f16 v253, v252, v253 neg_lo:[1,0] neg_hi:[1,0]
    v_rcp_f16_sdwa v250, v250 dst_sel:WORD_0 dst_unused:UNUSED_PAD src0_sel:WORD_1
    v_fma_mix_f32 v238, v238, v251, 0 op_sel_hi:[0,1,0]
    v_fma_mix_f32 v239, v239, v250, 0 op_sel_hi:[0,1,0]
    v_cvt_pk_bf16_f32 v117, v238, v239
    v_exp_f16_sdwa v252, v253 dst_sel:WORD_0 dst_unused:UNUSED_PAD src0_sel:WORD_0
    v_cvt_pk_f16_f32 v254, v242, v243
    v_exp_f16_sdwa v252, v253 dst_sel:WORD_1 dst_unused:UNUSED_PRESERVE src0_sel:WORD_1
    v_pk_fma_f16 v255, v254, v254, s60
    v_pk_fma_f16 v252, v252, s61, s61
    v_rcp_f16_sdwa v253, v252 dst_sel:WORD_0 dst_unused:UNUSED_PAD src0_sel:WORD_0
    v_pk_mul_f16 v255, v254, v255 neg_lo:[1,0] neg_hi:[1,0]
    v_rcp_f16_sdwa v252, v252 dst_sel:WORD_0 dst_unused:UNUSED_PAD src0_sel:WORD_1
    ds_write2st64_b64 v2, v[108:109], v[110:111] offset0:61 offset1:62
    v_exp_f16_sdwa v254, v255 dst_sel:WORD_0 dst_unused:UNUSED_PAD src0_sel:WORD_0
    s_nop 0
    v_exp_f16_sdwa v254, v255 dst_sel:WORD_1 dst_unused:UNUSED_PRESERVE src0_sel:WORD_1
    v_fma_mix_f32 v240, v240, v253, 0 op_sel_hi:[0,1,0]
    v_fma_mix_f32 v241, v241, v252, 0 op_sel_hi:[0,1,0]
    v_cvt_pk_bf16_f32 v118, v240, v241
    v_pk_fma_f16 v254, v254, s61, s61
    v_rcp_f16_sdwa v255, v254 dst_sel:WORD_0 dst_unused:UNUSED_PAD src0_sel:WORD_0
    ds_write2st64_b64 v2, v[112:113], v[114:115] offset0:69 offset1:70
    v_rcp_f16_sdwa v254, v254 dst_sel:WORD_0 dst_unused:UNUSED_PAD src0_sel:WORD_1
    v_fma_mix_f32 v242, v242, v255, 0 op_sel_hi:[0,1,0]
    v_fma_mix_f32 v243, v243, v254, 0 op_sel_hi:[0,1,0]
    v_cvt_pk_bf16_f32 v119, v242, v243
    ds_write2st64_b64 v2, v[116:117], v[118:119] offset0:77 offset1:78
    s_waitcnt lgkmcnt(0)
    s_barrier
L_P_done:
    s_endpgm
L_PN:
    s_setprio 1
    v_mfma_f32_16x16x32_bf16 v[220:223], v[196:199], v[12:15], 0
    v_mfma_f32_16x16x32_bf16 v[220:223], v[200:203], v[16:19], v[220:223]
    v_mfma_f32_16x16x32_bf16 v[220:223], v[204:207], v[20:23], v[220:223]
    v_mfma_f32_16x16x32_bf16 v[220:223], v[208:211], v[24:27], v[220:223]
    v_mfma_f32_16x16x32_bf16 v[220:223], v[212:215], v[28:31], v[220:223]
    v_mfma_f32_16x16x32_bf16 v[220:223], v[216:219], v[32:35], v[220:223]
    v_mfma_f32_16x16x32_bf16 v[224:227], v[196:199], v[36:39], 0
    v_mfma_f32_16x16x32_bf16 v[224:227], v[200:203], v[40:43], v[224:227]
    v_mfma_f32_16x16x32_bf16 v[224:227], v[204:207], v[44:47], v[224:227]
    v_mfma_f32_16x16x32_bf16 v[224:227], v[208:211], v[48:51], v[224:227]
    v_mfma_f32_16x16x32_bf16 v[224:227], v[212:215], v[52:55], v[224:227]
    v_mfma_f32_16x16x32_bf16 v[224:227], v[216:219], v[56:59], v[224:227]
    s_nop 1
    v_cvt_pk_f16_f32 v248, v220, v221
    v_pk_fma_f16 v249, v248, v248, s60
    s_waitcnt lgkmcnt(12)
    v_mfma_f32_16x16x32_bf16 v[228:231], v[196:199], v[60:63], 0
    v_pk_mul_f16 v249, v248, v249 neg_lo:[1,0] neg_hi:[1,0]
    v_cvt_pk_f16_f32 v250, v222, v223
    v_mfma_f32_16x16x32_bf16 v[228:231], v[200:203], v[64:67], v[228:231]
    v_exp_f16_sdwa v248, v249 dst_sel:WORD_0 dst_unused:UNUSED_PAD src0_sel:WORD_0
    v_mfma_f32_16x16x32_bf16 v[228:231], v[204:207], v[68:71], v[228:231]
    v_exp_f16_sdwa v248, v249 dst_sel:WORD_1 dst_unused:UNUSED_PRESERVE src0_sel:WORD_1
    v_mfma_f32_16x16x32_bf16 v[228:231], v[208:211], v[72:75], v[228:231]
    v_pk_fma_f16 v248, v248, s61, s61
    v_pk_fma_f16 v251, v250, v250, s60
    v_mfma_f32_16x16x32_bf16 v[228:231], v[212:215], v[76:79], v[228:231]
    v_pk_mul_f16 v251, v250, v251 neg_lo:[1,0] neg_hi:[1,0]
    v_mfma_f32_16x16x32_bf16 v[228:231], v[216:219], v[80:83], v[228:231]
    v_rcp_f16_sdwa v249, v248 dst_sel:WORD_0 dst_unused:UNUSED_PAD src0_sel:WORD_0
    v_mfma_f32_16x16x32_bf16 v[232:235], v[196:199], v[84:87], 0
    v_rcp_f16_sdwa v248, v248 dst_sel:WORD_0 dst_unused:UNUSED_PAD src0_sel:WORD_1
    v_mfma_f32_16x16x32_bf16 v[232:235], v[200:203], v[88:91], v[232:235]
    v_exp_f16_sdwa v250, v251 dst_sel:WORD_0 dst_unused:UNUSED_PAD src0_sel:WORD_0
    v_mfma_f32_16x16x32_bf16 v[232:235], v[204:207], v[92:95], v[232:235]
    v_exp_f16_sdwa v250, v251 dst_sel:WORD_1 dst_unused:UNUSED_PRESERVE src0_sel:WORD_1
    v_mfma_f32_16x16x32_bf16 v[232:235], v[208:211], v[96:99], v[232:235]
    v_fma_mix_f32 v220, v220, v249, 0 op_sel_hi:[0,1,0]
    v_fma_mix_f32 v221, v221, v248, 0 op_sel_hi:[0,1,0]
    v_mfma_f32_16x16x32_bf16 v[232:235], v[212:215], v[100:103], v[232:235]
    v_cvt_pk_bf16_f32 v108, v220, v221
    v_pk_fma_f16 v250, v250, s61, s61
    v_mfma_f32_16x16x32_bf16 v[232:235], v[216:219], v[104:107], v[232:235]
    v_rcp_f16_sdwa v251, v250 dst_sel:WORD_0 dst_unused:UNUSED_PAD src0_sel:WORD_0
    s_waitcnt lgkmcnt(0)
    s_waitcnt lgkmcnt(0)
    s_barrier
    v_mfma_f32_16x16x32_bf16 v[236:239], v[196:199], v[124:127], 0
    v_rcp_f16_sdwa v250, v250 dst_sel:WORD_0 dst_unused:UNUSED_PAD src0_sel:WORD_1
    v_mfma_f32_16x16x32_bf16 v[240:243], v[196:199], v[148:151], 0
    v_fma_mix_f32 v222, v222, v251, 0 op_sel_hi:[0,1,0]
    v_fma_mix_f32 v223, v223, v250, 0 op_sel_hi:[0,1,0]
    v_mfma_f32_16x16x32_bf16 v[236:239], v[200:203], v[128:131], v[236:239]
    ds_read_b64_tr_b16 v[196:197], v1 offset:24576
    v_cvt_pk_bf16_f32 v109, v222, v223
    v_mfma_f32_16x16x32_bf16 v[240:243], v[200:203], v[152:155], v[240:243]
    ds_read_b64_tr_b16 v[198:199], v1 offset:24832
    v_cvt_pk_f16_f32 v252, v224, v225
    v_mfma_f32_16x16x32_bf16 v[236:239], v[204:207], v[132:135], v[236:239]
    ds_read_b64_tr_b16 v[200:201], v1 offset:26624
    v_pk_fma_f16 v253, v252, v252, s60
    v_mfma_f32_16x16x32_bf16 v[240:243], v[204:207], v[156:159], v[240:243]
    ds_read_b64_tr_b16 v[202:203], v1 offset:26880
    v_pk_mul_f16 v253, v252, v253 neg_lo:[1,0] neg_hi:[1,0]
    v_mfma_f32_16x16x32_bf16 v[236:239], v[208:211], v[136:139], v[236:239]
    ds_read_b64_tr_b16 v[204:205], v1 offset:28672
    v_cvt_pk_f16_f32 v254, v226, v227
    v_mfma_f32_16x16x32_bf16 v[240:243], v[208:211], v[160:163], v[240:243]
    ds_read_b64_tr_b16 v[206:207], v1 offset:28928
    v_pk_fma_f16 v255, v254, v254, s60
    v_mfma_f32_16x16x32_bf16 v[236:239], v[212:215], v[140:143], v[236:239]
    ds_read_b64_tr_b16 v[208:209], v1 offset:30720
    v_pk_mul_f16 v255, v254, v255 neg_lo:[1,0] neg_hi:[1,0]
    v_mfma_f32_16x16x32_bf16 v[240:243], v[212:215], v[164:167], v[240:243]
    ds_read_b64_tr_b16 v[210:211], v1 offset:30976
    v_cvt_pk_f16_f32 v248, v228, v229
    v_mfma_f32_16x16x32_bf16 v[236:239], v[216:219], v[144:147], v[236:239]
    ds_read_b64_tr_b16 v[212:213], v1 offset:32768
    v_pk_fma_f16 v249, v248, v248, s60
    v_mfma_f32_16x16x32_bf16 v[240:243], v[216:219], v[168:171], v[240:243]
    ds_read_b64_tr_b16 v[214:215], v1 offset:33024
    ds_read_b64_tr_b16 v[216:217], v1 offset:34816
    ds_read_b64_tr_b16 v[218:219], v1 offset:35072
    v_exp_f16_sdwa v252, v253 dst_sel:WORD_0 dst_unused:UNUSED_PAD src0_sel:WORD_0
    v_exp_f16_sdwa v254, v255 dst_sel:WORD_0 dst_unused:UNUSED_PAD src0_sel:WORD_0
    v_exp_f16_sdwa v252, v253 dst_sel:WORD_1 dst_unused:UNUSED_PRESERVE src0_sel:WORD_1
    v_exp_f16_sdwa v254, v255 dst_sel:WORD_1 dst_unused:UNUSED_PRESERVE src0_sel:WORD_1
    v_pk_fma_f16 v252, v252, s61, s61
    v_rcp_f16_sdwa v253, v252 dst_sel:WORD_0 dst_unused:UNUSED_PAD src0_sel:WORD_0
    v_pk_fma_f16 v254, v254, s61, s61
    v_rcp_f16_sdwa v252, v252 dst_sel:WORD_0 dst_unused:UNUSED_PAD src0_sel:WORD_1
    v_fma_mix_f32 v224, v224, v253, 0 op_sel_hi:[0,1,0]
    v_fma_mix_f32 v225, v225, v252, 0 op_sel_hi:[0,1,0]
    v_cvt_pk_bf16_f32 v110, v224, v225
    v_rcp_f16_sdwa v255, v254 dst_sel:WORD_0 dst_unused:UNUSED_PAD src0_sel:WORD_0
    v_pk_mul_f16 v249, v248, v249 neg_lo:[1,0] neg_hi:[1,0]
    v_rcp_f16_sdwa v254, v254 dst_sel:WORD_0 dst_unused:UNUSED_PAD src0_sel:WORD_1
    v_fma_mix_f32 v226, v226, v255, 0 op_sel_hi:[0,1,0]
    v_fma_mix_f32 v227, v227, v254, 0 op_sel_hi:[0,1,0]
    v_cvt_pk_bf16_f32 v111, v226, v227
    v_exp_f16_sdwa v248, v249 dst_sel:WORD_0 dst_unused:UNUSED_PAD src0_sel:WORD_0
    v_cvt_pk_f16_f32 v250, v230, v231
    v_exp_f16_sdwa v248, v249 dst_sel:WORD_1 dst_unused:UNUSED_PRESERVE src0_sel:WORD_1
    v_pk_fma_f16 v251, v250, v250, s60
    v_pk_fma_f16 v248, v248, s61, s61
    v_rcp_f16_sdwa v249, v248 dst_sel:WORD_0 dst_unused:UNUSED_PAD src0_sel:WORD_0
    v_pk_mul_f16 v251, v250, v251 neg_lo:[1,0] neg_hi:[1,0]
    v_rcp_f16_sdwa v248, v248 dst_sel:WORD_0 dst_unused:UNUSED_PAD src0_sel:WORD_1
    v_fma_mix_f32 v228, v228, v249, 0 op_sel_hi:[0,1,0]
    v_fma_mix_f32 v229, v229, v248, 0 op_sel_hi:[0,1,0]
    v_cvt_pk_bf16_f32 v112, v228, v229
    v_exp_f16_sdwa v250, v251 dst_sel:WORD_0 dst_unused:UNUSED_PAD src0_sel:WORD_0
    v_cvt_pk_f16_f32 v252, v232, v233
    v_exp_f16_sdwa v250, v251 dst_sel:WORD_1 dst_unused:UNUSED_PRESERVE src0_sel:WORD_1
    v_pk_fma_f16 v253, v252, v252, s60
    v_pk_fma_f16 v250, v250, s61, s61
    v_rcp_f16_sdwa v251, v250 dst_sel:WORD_0 dst_unused:UNUSED_PAD src0_sel:WORD_0
    v_pk_mul_f16 v253, v252, v253 neg_lo:[1,0] neg_hi:[1,0]
    v_rcp_f16_sdwa v250, v250 dst_sel:WORD_0 dst_unused:UNUSED_PAD src0_sel:WORD_1
    v_fma_mix_f32 v230, v230, v251, 0 op_sel_hi:[0,1,0]
    v_fma_mix_f32 v231, v231, v250, 0 op_sel_hi:[0,1,0]
    v_cvt_pk_bf16_f32 v113, v230, v231
    v_exp_f16_sdwa v252, v253 dst_sel:WORD_0 dst_unused:UNUSED_PAD src0_sel:WORD_0
    v_cvt_pk_f16_f32 v254, v234, v235
    v_exp_f16_sdwa v252, v253 dst_sel:WORD_1 dst_unused:UNUSED_PRESERVE src0_sel:WORD_1
    v_pk_fma_f16 v255, v254, v254, s60
    v_pk_fma_f16 v252, v252, s61, s61
    v_rcp_f16_sdwa v253, v252 dst_sel:WORD_0 dst_unused:UNUSED_PAD src0_sel:WORD_0
    v_pk_mul_f16 v255, v254, v255 neg_lo:[1,0] neg_hi:[1,0]
    v_rcp_f16_sdwa v252, v252 dst_sel:WORD_0 dst_unused:UNUSED_PAD src0_sel:WORD_1
    v_fma_mix_f32 v232, v232, v253, 0 op_sel_hi:[0,1,0]
    v_fma_mix_f32 v233, v233, v252, 0 op_sel_hi:[0,1,0]
    v_cvt_pk_bf16_f32 v114, v232, v233
    v_exp_f16_sdwa v254, v255 dst_sel:WORD_0 dst_unused:UNUSED_PAD src0_sel:WORD_0
    v_cvt_pk_f16_f32 v248, v236, v237
    v_exp_f16_sdwa v254, v255 dst_sel:WORD_1 dst_unused:UNUSED_PRESERVE src0_sel:WORD_1
    v_pk_fma_f16 v249, v248, v248, s60
    v_pk_fma_f16 v254, v254, s61, s61
    v_rcp_f16_sdwa v255, v254 dst_sel:WORD_0 dst_unused:UNUSED_PAD src0_sel:WORD_0
    v_pk_mul_f16 v249, v248, v249 neg_lo:[1,0] neg_hi:[1,0]
    v_rcp_f16_sdwa v254, v254 dst_sel:WORD_0 dst_unused:UNUSED_PAD src0_sel:WORD_1
    v_fma_mix_f32 v234, v234, v255, 0 op_sel_hi:[0,1,0]
    v_fma_mix_f32 v235, v235, v254, 0 op_sel_hi:[0,1,0]
    v_cvt_pk_bf16_f32 v115, v234, v235
    v_exp_f16_sdwa v248, v249 dst_sel:WORD_0 dst_unused:UNUSED_PAD src0_sel:WORD_0
    v_cvt_pk_f16_f32 v250, v238, v239
    v_exp_f16_sdwa v248, v249 dst_sel:WORD_1 dst_unused:UNUSED_PRESERVE src0_sel:WORD_1
    v_pk_fma_f16 v251, v250, v250, s60
    v_pk_fma_f16 v248, v248, s61, s61
    v_rcp_f16_sdwa v249, v248 dst_sel:WORD_0 dst_unused:UNUSED_PAD src0_sel:WORD_0
    v_pk_mul_f16 v251, v250, v251 neg_lo:[1,0] neg_hi:[1,0]
    v_rcp_f16_sdwa v248, v248 dst_sel:WORD_0 dst_unused:UNUSED_PAD src0_sel:WORD_1
    v_fma_mix_f32 v236, v236, v249, 0 op_sel_hi:[0,1,0]
    v_fma_mix_f32 v237, v237, v248, 0 op_sel_hi:[0,1,0]
    v_cvt_pk_bf16_f32 v116, v236, v237
    v_exp_f16_sdwa v250, v251 dst_sel:WORD_0 dst_unused:UNUSED_PAD src0_sel:WORD_0
    v_cvt_pk_f16_f32 v252, v240, v241
    v_exp_f16_sdwa v250, v251 dst_sel:WORD_1 dst_unused:UNUSED_PRESERVE src0_sel:WORD_1
    v_pk_fma_f16 v253, v252, v252, s60
    v_pk_fma_f16 v250, v250, s61, s61
    v_rcp_f16_sdwa v251, v250 dst_sel:WORD_0 dst_unused:UNUSED_PAD src0_sel:WORD_0
    v_pk_mul_f16 v253, v252, v253 neg_lo:[1,0] neg_hi:[1,0]
    v_rcp_f16_sdwa v250, v250 dst_sel:WORD_0 dst_unused:UNUSED_PAD src0_sel:WORD_1
    v_fma_mix_f32 v238, v238, v251, 0 op_sel_hi:[0,1,0]
    v_fma_mix_f32 v239, v239, v250, 0 op_sel_hi:[0,1,0]
    v_cvt_pk_bf16_f32 v117, v238, v239
    v_exp_f16_sdwa v252, v253 dst_sel:WORD_0 dst_unused:UNUSED_PAD src0_sel:WORD_0
    v_cvt_pk_f16_f32 v254, v242, v243
    v_exp_f16_sdwa v252, v253 dst_sel:WORD_1 dst_unused:UNUSED_PRESERVE src0_sel:WORD_1
    v_pk_fma_f16 v255, v254, v254, s60
    v_pk_fma_f16 v252, v252, s61, s61
    s_waitcnt lgkmcnt(0)
    v_mfma_f32_16x16x32_bf16 v[220:223], v[196:199], v[12:15], 0
    ds_write2st64_b64 v2, v[108:109], v[110:111] offset0:0 offset1:1
    v_pk_mul_f16 v255, v254, v255 neg_lo:[1,0] neg_hi:[1,0]
    v_mfma_f32_16x16x32_bf16 v[220:223], v[200:203], v[16:19], v[220:223]
    v_rcp_f16_sdwa v253, v252 dst_sel:WORD_0 dst_unused:UNUSED_PAD src0_sel:WORD_0
    v_mfma_f32_16x16x32_bf16 v[220:223], v[204:207], v[20:23], v[220:223]
    v_rcp_f16_sdwa v252, v252 dst_sel:WORD_0 dst_unused:UNUSED_PAD src0_sel:WORD_1
    v_mfma_f32_16x16x32_bf16 v[220:223], v[208:211], v[24:27], v[220:223]
    v_exp_f16_sdwa v254, v255 dst_sel:WORD_0 dst_unused:UNUSED_PAD src0_sel:WORD_0
    v_mfma_f32_16x16x32_bf16 v[220:223], v[212:215], v[28:31], v[220:223]
    v_exp_f16_sdwa v254, v255 dst_sel:WORD_1 dst_unused:UNUSED_PRESERVE src0_sel:WORD_1
    v_mfma_f32_16x16x32_bf16 v[220:223], v[216:219], v[32:35], v[220:223]
    v_fma_mix_f32 v240, v240, v253, 0 op_sel_hi:[0,1,0]
    v_fma_mix_f32 v241, v241, v252, 0 op_sel_hi:[0,1,0]
    v_mfma_f32_16x16x32_bf16 v[224:227], v[196:199], v[36:39], 0
    v_cvt_pk_bf16_f32 v118, v240, v241
    v_pk_fma_f16 v254, v254, s61, s61
    v_mfma_f32_16x16x32_bf16 v[224:227], v[200:203], v[40:43], v[224:227]
    v_rcp_f16_sdwa v255, v254 dst_sel:WORD_0 dst_unused:UNUSED_PAD src0_sel:WORD_0
    v_mfma_f32_16x16x32_bf16 v[224:227], v[204:207], v[44:47], v[224:227]
    ds_write2st64_b64 v2, v[112:113], v[114:115] offset0:8 offset1:9
    v_fma_mix_f32 v242, v242, v255, 0 op_sel_hi:[0,1,0]
    v_mfma_f32_16x16x32_bf16 v[224:227], v[208:211], v[48:51], v[224:227]
    v_rcp_f16_sdwa v254, v254 dst_sel:WORD_0 dst_unused:UNUSED_PAD src0_sel:WORD_1
    v_mfma_f32_16x16x32_bf16 v[224:227], v[212:215], v[52:55], v[224:227]
    v_fma_mix_f32 v243, v243, v254, 0 op_sel_hi:[0,1,0]
    v_cvt_pk_bf16_f32 v119, v242, v243
    v_mfma_f32_16x16x32_bf16 v[224:227], v[216:219], v[56:59], v[224:227]
    v_cvt_pk_f16_f32 v248, v220, v221
    v_pk_fma_f16 v249, v248, v248, s60
    v_mfma_f32_16x16x32_bf16 v[228:231], v[196:199], v[60:63], 0
    v_pk_mul_f16 v249, v248, v249 neg_lo:[1,0] neg_hi:[1,0]
    v_cvt_pk_f16_f32 v250, v222, v223
    v_mfma_f32_16x16x32_bf16 v[228:231], v[200:203], v[64:67], v[228:231]
    v_exp_f16_sdwa v248, v249 dst_sel:WORD_0 dst_unused:UNUSED_PAD src0_sel:WORD_0
    v_mfma_f32_16x16x32_bf16 v[228:231], v[204:207], v[68:71], v[228:231]
    v_exp_f16_sdwa v248, v249 dst_sel:WORD_1 dst_unused:UNUSED_PRESERVE src0_sel:WORD_1
    v_mfma_f32_16x16x32_bf16 v[228:231], v[208:211], v[72:75], v[228:231]
    v_pk_fma_f16 v248, v248, s61, s61
    v_pk_fma_f16 v251, v250, v250, s60
    v_mfma_f32_16x16x32_bf16 v[228:231], v[212:215], v[76:79], v[228:231]
    ds_write2st64_b64 v2, v[116:117], v[118:119] offset0:16 offset1:17
    v_pk_mul_f16 v251, v250, v251 neg_lo:[1,0] neg_hi:[1,0]
    v_mfma_f32_16x16x32_bf16 v[228:231], v[216:219], v[80:83], v[228:231]
    v_rcp_f16_sdwa v249, v248 dst_sel:WORD_0 dst_unused:UNUSED_PAD src0_sel:WORD_0
    v_mfma_f32_16x16x32_bf16 v[232:235], v[196:199], v[84:87], 0
    v_rcp_f16_sdwa v248, v248 dst_sel:WORD_0 dst_unused:UNUSED_PAD src0_sel:WORD_1
    v_mfma_f32_16x16x32_bf16 v[232:235], v[200:203], v[88:91], v[232:235]
    v_exp_f16_sdwa v250, v251 dst_sel:WORD_0 dst_unused:UNUSED_PAD src0_sel:WORD_0
    v_mfma_f32_16x16x32_bf16 v[232:235], v[204:207], v[92:95], v[232:235]
    v_exp_f16_sdwa v250, v251 dst_sel:WORD_1 dst_unused:UNUSED_PRESERVE src0_sel:WORD_1
    v_mfma_f32_16x16x32_bf16 v[232:235], v[208:211], v[96:99], v[232:235]
    v_fma_mix_f32 v220, v220, v249, 0 op_sel_hi:[0,1,0]
    v_fma_mix_f32 v221, v221, v248, 0 op_sel_hi:[0,1,0]
    v_mfma_f32_16x16x32_bf16 v[232:235], v[212:215], v[100:103], v[232:235]
    v_cvt_pk_bf16_f32 v108, v220, v221
    v_pk_fma_f16 v250, v250, s61, s61
    v_mfma_f32_16x16x32_bf16 v[232:235], v[216:219], v[104:107], v[232:235]
    v_rcp_f16_sdwa v251, v250 dst_sel:WORD_0 dst_unused:UNUSED_PAD src0_sel:WORD_0
    s_waitcnt lgkmcnt(0)
    s_barrier
    v_mfma_f32_16x16x32_bf16 v[236:239], v[196:199], v[124:127], 0
    v_rcp_f16_sdwa v250, v250 dst_sel:WORD_0 dst_unused:UNUSED_PAD src0_sel:WORD_1
    v_mfma_f32_16x16x32_bf16 v[240:243], v[196:199], v[148:151], 0
    v_fma_mix_f32 v222, v222, v251, 0 op_sel_hi:[0,1,0]
    v_fma_mix_f32 v223, v223, v250, 0 op_sel_hi:[0,1,0]
    v_mfma_f32_16x16x32_bf16 v[236:239], v[200:203], v[128:131], v[236:239]
    ds_read_b64_tr_b16 v[196:197], v1 offset:0
    v_cvt_pk_bf16_f32 v109, v222, v223
    v_mfma_f32_16x16x32_bf16 v[240:243], v[200:203], v[152:155], v[240:243]
    ds_read_b64_tr_b16 v[198:199], v1 offset:256
    v_cvt_pk_f16_f32 v252, v224, v225
    v_mfma_f32_16x16x32_bf16 v[236:239], v[204:207], v[132:135], v[236:239]
    ds_read_b64_tr_b16 v[200:201], v1 offset:2048
    v_pk_fma_f16 v253, v252, v252, s60
    v_mfma_f32_16x16x32_bf16 v[240:243], v[204:207], v[156:159], v[240:243]
    ds_read_b64_tr_b16 v[202:203], v1 offset:2304
    v_pk_mul_f16 v253, v252, v253 neg_lo:[1,0] neg_hi:[1,0]
    v_mfma_f32_16x16x32_bf16 v[236:239], v[208:211], v[136:139], v[236:239]
    ds_read_b64_tr_b16 v[204:205], v1 offset:4096
    v_cvt_pk_f16_f32 v254, v226, v227
    v_mfma_f32_16x16x32_bf16 v[240:243], v[208:211], v[160:163], v[240:243]
    ds_read_b64_tr_b16 v[206:207], v1 offset:4352
    v_pk_fma_f16 v255, v254, v254, s60
    v_mfma_f32_16x16x32_bf16 v[236:239], v[212:215], v[140:143], v[236:239]
    ds_read_b64_tr_b16 v[208:209], v1 offset:6144
    v_pk_mul_f16 v255, v254, v255 neg_lo:[1,0] neg_hi:[1,0]
    v_mfma_f32_16x16x32_bf16 v[240:243], v[212:215], v[164:167], v[240:243]
    ds_read_b64_tr_b16 v[210:211], v1 offset:6400
    v_cvt_pk_f16_f32 v248, v228, v229
    v_mfma_f32_16x16x32_bf16 v[236:239], v[216:219], v[144:147], v[236:239]
    ds_read_b64_tr_b16 v[212:213], v1 offset:8192
    v_pk_fma_f16 v249, v248, v248, s60
    v_mfma_f32_16x16x32_bf16 v[240:243], v[216:219], v[168:171], v[240:243]
    ds_read_b64_tr_b16 v[214:215], v1 offset:8448
    ds_read_b64_tr_b16 v[216:217], v1 offset:10240
    ds_read_b64_tr_b16 v[218:219], v1 offset:10496
    v_exp_f16_sdwa v252, v253 dst_sel:WORD_0 dst_unused:UNUSED_PAD src0_sel:WORD_0
    v_exp_f16_sdwa v254, v255 dst_sel:WORD_0 dst_unused:UNUSED_PAD src0_sel:WORD_0
    v_exp_f16_sdwa v252, v253 dst_sel:WORD_1 dst_unused:UNUSED_PRESERVE src0_sel:WORD_1
    v_exp_f16_sdwa v254, v255 dst_sel:WORD_1 dst_unused:UNUSED_PRESERVE src0_sel:WORD_1
    v_pk_fma_f16 v252, v252, s61, s61
    v_rcp_f16_sdwa v253, v252 dst_sel:WORD_0 dst_unused:UNUSED_PAD src0_sel:WORD_0
    v_pk_fma_f16 v254, v254, s61, s61
    v_rcp_f16_sdwa v252, v252 dst_sel:WORD_0 dst_unused:UNUSED_PAD src0_sel:WORD_1
    v_fma_mix_f32 v224, v224, v253, 0 op_sel_hi:[0,1,0]
    v_fma_mix_f32 v225, v225, v252, 0 op_sel_hi:[0,1,0]
    v_cvt_pk_bf16_f32 v110, v224, v225
    v_rcp_f16_sdwa v255, v254 dst_sel:WORD_0 dst_unused:UNUSED_PAD src0_sel:WORD_0
    v_pk_mul_f16 v249, v248, v249 neg_lo:[1,0] neg_hi:[1,0]
    v_rcp_f16_sdwa v254, v254 dst_sel:WORD_0 dst_unused:UNUSED_PAD src0_sel:WORD_1
    v_fma_mix_f32 v226, v226, v255, 0 op_sel_hi:[0,1,0]
    v_fma_mix_f32 v227, v227, v254, 0 op_sel_hi:[0,1,0]
    v_cvt_pk_bf16_f32 v111, v226, v227
    v_exp_f16_sdwa v248, v249 dst_sel:WORD_0 dst_unused:UNUSED_PAD src0_sel:WORD_0
    v_cvt_pk_f16_f32 v250, v230, v231
    v_exp_f16_sdwa v248, v249 dst_sel:WORD_1 dst_unused:UNUSED_PRESERVE src0_sel:WORD_1
    v_pk_fma_f16 v251, v250, v250, s60
    v_pk_fma_f16 v248, v248, s61, s61
    v_rcp_f16_sdwa v249, v248 dst_sel:WORD_0 dst_unused:UNUSED_PAD src0_sel:WORD_0
    v_pk_mul_f16 v251, v250, v251 neg_lo:[1,0] neg_hi:[1,0]
    v_rcp_f16_sdwa v248, v248 dst_sel:WORD_0 dst_unused:UNUSED_PAD src0_sel:WORD_1
    v_fma_mix_f32 v228, v228, v249, 0 op_sel_hi:[0,1,0]
    v_fma_mix_f32 v229, v229, v248, 0 op_sel_hi:[0,1,0]
    v_cvt_pk_bf16_f32 v112, v228, v229
    v_exp_f16_sdwa v250, v251 dst_sel:WORD_0 dst_unused:UNUSED_PAD src0_sel:WORD_0
    v_cvt_pk_f16_f32 v252, v232, v233
    v_exp_f16_sdwa v250, v251 dst_sel:WORD_1 dst_unused:UNUSED_PRESERVE src0_sel:WORD_1
    v_pk_fma_f16 v253, v252, v252, s60
    v_pk_fma_f16 v250, v250, s61, s61
    v_rcp_f16_sdwa v251, v250 dst_sel:WORD_0 dst_unused:UNUSED_PAD src0_sel:WORD_0
    v_pk_mul_f16 v253, v252, v253 neg_lo:[1,0] neg_hi:[1,0]
    v_rcp_f16_sdwa v250, v250 dst_sel:WORD_0 dst_unused:UNUSED_PAD src0_sel:WORD_1
    v_fma_mix_f32 v230, v230, v251, 0 op_sel_hi:[0,1,0]
    v_fma_mix_f32 v231, v231, v250, 0 op_sel_hi:[0,1,0]
    v_cvt_pk_bf16_f32 v113, v230, v231
    v_exp_f16_sdwa v252, v253 dst_sel:WORD_0 dst_unused:UNUSED_PAD src0_sel:WORD_0
    v_cvt_pk_f16_f32 v254, v234, v235
    v_exp_f16_sdwa v252, v253 dst_sel:WORD_1 dst_unused:UNUSED_PRESERVE src0_sel:WORD_1
    v_pk_fma_f16 v255, v254, v254, s60
    v_pk_fma_f16 v252, v252, s61, s61
    v_rcp_f16_sdwa v253, v252 dst_sel:WORD_0 dst_unused:UNUSED_PAD src0_sel:WORD_0
    v_pk_mul_f16 v255, v254, v255 neg_lo:[1,0] neg_hi:[1,0]
    v_rcp_f16_sdwa v252, v252 dst_sel:WORD_0 dst_unused:UNUSED_PAD src0_sel:WORD_1
    v_fma_mix_f32 v232, v232, v253, 0 op_sel_hi:[0,1,0]
    v_fma_mix_f32 v233, v233, v252, 0 op_sel_hi:[0,1,0]
    v_cvt_pk_bf16_f32 v114, v232, v233
    v_exp_f16_sdwa v254, v255 dst_sel:WORD_0 dst_unused:UNUSED_PAD src0_sel:WORD_0
    v_cvt_pk_f16_f32 v248, v236, v237
    v_exp_f16_sdwa v254, v255 dst_sel:WORD_1 dst_unused:UNUSED_PRESERVE src0_sel:WORD_1
    v_pk_fma_f16 v249, v248, v248, s60
    v_pk_fma_f16 v254, v254, s61, s61
    v_rcp_f16_sdwa v255, v254 dst_sel:WORD_0 dst_unused:UNUSED_PAD src0_sel:WORD_0
    v_pk_mul_f16 v249, v248, v249 neg_lo:[1,0] neg_hi:[1,0]
    v_rcp_f16_sdwa v254, v254 dst_sel:WORD_0 dst_unused:UNUSED_PAD src0_sel:WORD_1
    v_fma_mix_f32 v234, v234, v255, 0 op_sel_hi:[0,1,0]
    v_fma_mix_f32 v235, v235, v254, 0 op_sel_hi:[0,1,0]
    v_cvt_pk_bf16_f32 v115, v234, v235
    v_exp_f16_sdwa v248, v249 dst_sel:WORD_0 dst_unused:UNUSED_PAD src0_sel:WORD_0
    v_cvt_pk_f16_f32 v250, v238, v239
    v_exp_f16_sdwa v248, v249 dst_sel:WORD_1 dst_unused:UNUSED_PRESERVE src0_sel:WORD_1
    v_pk_fma_f16 v251, v250, v250, s60
    v_pk_fma_f16 v248, v248, s61, s61
    v_rcp_f16_sdwa v249, v248 dst_sel:WORD_0 dst_unused:UNUSED_PAD src0_sel:WORD_0
    v_pk_mul_f16 v251, v250, v251 neg_lo:[1,0] neg_hi:[1,0]
    v_rcp_f16_sdwa v248, v248 dst_sel:WORD_0 dst_unused:UNUSED_PAD src0_sel:WORD_1
    v_fma_mix_f32 v236, v236, v249, 0 op_sel_hi:[0,1,0]
    v_fma_mix_f32 v237, v237, v248, 0 op_sel_hi:[0,1,0]
    v_cvt_pk_bf16_f32 v116, v236, v237
    v_exp_f16_sdwa v250, v251 dst_sel:WORD_0 dst_unused:UNUSED_PAD src0_sel:WORD_0
    v_cvt_pk_f16_f32 v252, v240, v241
    v_exp_f16_sdwa v250, v251 dst_sel:WORD_1 dst_unused:UNUSED_PRESERVE src0_sel:WORD_1
    v_pk_fma_f16 v253, v252, v252, s60
    v_pk_fma_f16 v250, v250, s61, s61
    v_rcp_f16_sdwa v251, v250 dst_sel:WORD_0 dst_unused:UNUSED_PAD src0_sel:WORD_0
    v_pk_mul_f16 v253, v252, v253 neg_lo:[1,0] neg_hi:[1,0]
    v_rcp_f16_sdwa v250, v250 dst_sel:WORD_0 dst_unused:UNUSED_PAD src0_sel:WORD_1
    v_fma_mix_f32 v238, v238, v251, 0 op_sel_hi:[0,1,0]
    v_fma_mix_f32 v239, v239, v250, 0 op_sel_hi:[0,1,0]
    v_cvt_pk_bf16_f32 v117, v238, v239
    v_exp_f16_sdwa v252, v253 dst_sel:WORD_0 dst_unused:UNUSED_PAD src0_sel:WORD_0
    v_cvt_pk_f16_f32 v254, v242, v243
    v_exp_f16_sdwa v252, v253 dst_sel:WORD_1 dst_unused:UNUSED_PRESERVE src0_sel:WORD_1
    v_pk_fma_f16 v255, v254, v254, s60
    v_pk_fma_f16 v252, v252, s61, s61
    s_waitcnt lgkmcnt(0)
    v_mfma_f32_16x16x32_bf16 v[220:223], v[196:199], v[12:15], 0
    ds_write2st64_b64 v2, v[108:109], v[110:111] offset0:26 offset1:27
    v_pk_mul_f16 v255, v254, v255 neg_lo:[1,0] neg_hi:[1,0]
    v_mfma_f32_16x16x32_bf16 v[220:223], v[200:203], v[16:19], v[220:223]
    v_rcp_f16_sdwa v253, v252 dst_sel:WORD_0 dst_unused:UNUSED_PAD src0_sel:WORD_0
    v_mfma_f32_16x16x32_bf16 v[220:223], v[204:207], v[20:23], v[220:223]
    v_rcp_f16_sdwa v252, v252 dst_sel:WORD_0 dst_unused:UNUSED_PAD src0_sel:WORD_1
    v_mfma_f32_16x16x32_bf16 v[220:223], v[208:211], v[24:27], v[220:223]
    v_exp_f16_sdwa v254, v255 dst_sel:WORD_0 dst_unused:UNUSED_PAD src0_sel:WORD_0
    v_mfma_f32_16x16x32_bf16 v[220:223], v[212:215], v[28:31], v[220:223]
    v_exp_f16_sdwa v254, v255 dst_sel:WORD_1 dst_unused:UNUSED_PRESERVE src0_sel:WORD_1
    v_mfma_f32_16x16x32_bf16 v[220:223], v[216:219], v[32:35], v[220:223]
    v_fma_mix_f32 v240, v240, v253, 0 op_sel_hi:[0,1,0]
    v_fma_mix_f32 v241, v241, v252, 0 op_sel_hi:[0,1,0]
    v_mfma_f32_16x16x32_bf16 v[224:227], v[196:199], v[36:39], 0
    v_cvt_pk_bf16_f32 v118, v240, v241
    v_pk_fma_f16 v254, v254, s61, s61
    v_mfma_f32_16x16x32_bf16 v[224:227], v[200:203], v[40:43], v[224:227]
    v_rcp_f16_sdwa v255, v254 dst_sel:WORD_0 dst_unused:UNUSED_PAD src0_sel:WORD_0
    v_mfma_f32_16x16x32_bf16 v[224:227], v[204:207], v[44:47], v[224:227]
    ds_write2st64_b64 v2, v[112:113], v[114:115] offset0:34 offset1:35
    v_fma_mix_f32 v242, v242, v255, 0 op_sel_hi:[0,1,0]
    v_mfma_f32_16x16x32_bf16 v[224:227], v[208:211], v[48:51], v[224:227]
    v_rcp_f16_sdwa v254, v254 dst_sel:WORD_0 dst_unused:UNUSED_PAD src0_sel:WORD_1
    v_mfma_f32_16x16x32_bf16 v[224:227], v[212:215], v[52:55], v[224:227]
    v_fma_mix_f32 v243, v243, v254, 0 op_sel_hi:[0,1,0]
    v_cvt_pk_bf16_f32 v119, v242, v243
    v_mfma_f32_16x16x32_bf16 v[224:227], v[216:219], v[56:59], v[224:227]
    v_cvt_pk_f16_f32 v248, v220, v221
    v_pk_fma_f16 v249, v248, v248, s60
    v_mfma_f32_16x16x32_bf16 v[228:231], v[196:199], v[60:63], 0
    v_pk_mul_f16 v249, v248, v249 neg_lo:[1,0] neg_hi:[1,0]
    v_cvt_pk_f16_f32 v250, v222, v223
    v_mfma_f32_16x16x32_bf16 v[228:231], v[200:203], v[64:67], v[228:231]
    v_exp_f16_sdwa v248, v249 dst_sel:WORD_0 dst_unused:UNUSED_PAD src0_sel:WORD_0
    v_mfma_f32_16x16x32_bf16 v[228:231], v[204:207], v[68:71], v[228:231]
    v_exp_f16_sdwa v248, v249 dst_sel:WORD_1 dst_unused:UNUSED_PRESERVE src0_sel:WORD_1
    v_mfma_f32_16x16x32_bf16 v[228:231], v[208:211], v[72:75], v[228:231]
    v_pk_fma_f16 v248, v248, s61, s61
    v_pk_fma_f16 v251, v250, v250, s60
    v_mfma_f32_16x16x32_bf16 v[228:231], v[212:215], v[76:79], v[228:231]
    ds_write2st64_b64 v2, v[116:117], v[118:119] offset0:42 offset1:43
    v_pk_mul_f16 v251, v250, v251 neg_lo:[1,0] neg_hi:[1,0]
    v_mfma_f32_16x16x32_bf16 v[228:231], v[216:219], v[80:83], v[228:231]
    v_rcp_f16_sdwa v249, v248 dst_sel:WORD_0 dst_unused:UNUSED_PAD src0_sel:WORD_0
    v_mfma_f32_16x16x32_bf16 v[232:235], v[196:199], v[84:87], 0
    v_rcp_f16_sdwa v248, v248 dst_sel:WORD_0 dst_unused:UNUSED_PAD src0_sel:WORD_1
    v_mfma_f32_16x16x32_bf16 v[232:235], v[200:203], v[88:91], v[232:235]
    v_exp_f16_sdwa v250, v251 dst_sel:WORD_0 dst_unused:UNUSED_PAD src0_sel:WORD_0
    v_mfma_f32_16x16x32_bf16 v[232:235], v[204:207], v[92:95], v[232:235]
    v_exp_f16_sdwa v250, v251 dst_sel:WORD_1 dst_unused:UNUSED_PRESERVE src0_sel:WORD_1
    v_mfma_f32_16x16x32_bf16 v[232:235], v[208:211], v[96:99], v[232:235]
    v_fma_mix_f32 v220, v220, v249, 0 op_sel_hi:[0,1,0]
    v_fma_mix_f32 v221, v221, v248, 0 op_sel_hi:[0,1,0]
    v_mfma_f32_16x16x32_bf16 v[232:235], v[212:215], v[100:103], v[232:235]
    v_cvt_pk_bf16_f32 v108, v220, v221
    v_pk_fma_f16 v250, v250, s61, s61
    v_mfma_f32_16x16x32_bf16 v[232:235], v[216:219], v[104:107], v[232:235]
    v_rcp_f16_sdwa v251, v250 dst_sel:WORD_0 dst_unused:UNUSED_PAD src0_sel:WORD_0
    s_waitcnt lgkmcnt(0)
    s_barrier
    v_mfma_f32_16x16x32_bf16 v[236:239], v[196:199], v[124:127], 0
    v_rcp_f16_sdwa v250, v250 dst_sel:WORD_0 dst_unused:UNUSED_PAD src0_sel:WORD_1
    v_mfma_f32_16x16x32_bf16 v[240:243], v[196:199], v[148:151], 0
    v_fma_mix_f32 v222, v222, v251, 0 op_sel_hi:[0,1,0]
    v_fma_mix_f32 v223, v223, v250, 0 op_sel_hi:[0,1,0]
    v_mfma_f32_16x16x32_bf16 v[236:239], v[200:203], v[128:131], v[236:239]
    ds_read_b64_tr_b16 v[196:197], v1 offset:12288
    v_cvt_pk_bf16_f32 v109, v222, v223
    v_mfma_f32_16x16x32_bf16 v[240:243], v[200:203], v[152:155], v[240:243]
    ds_read_b64_tr_b16 v[198:199], v1 offset:12544
    v_cvt_pk_f16_f32 v252, v224, v225
    v_mfma_f32_16x16x32_bf16 v[236:239], v[204:207], v[132:135], v[236:239]
    ds_read_b64_tr_b16 v[200:201], v1 offset:14336
    v_pk_fma_f16 v253, v252, v252, s60
    v_mfma_f32_16x16x32_bf16 v[240:243], v[204:207], v[156:159], v[240:243]
    ds_read_b64_tr_b16 v[202:203], v1 offset:14592
    v_pk_mul_f16 v253, v252, v253 neg_lo:[1,0] neg_hi:[1,0]
    v_mfma_f32_16x16x32_bf16 v[236:239], v[208:211], v[136:139], v[236:239]
    ds_read_b64_tr_b16 v[204:205], v1 offset:16384
    v_cvt_pk_f16_f32 v254, v226, v227
    v_mfma_f32_16x16x32_bf16 v[240:243], v[208:211], v[160:163], v[240:243]
    ds_read_b64_tr_b16 v[206:207], v1 offset:16640
    v_pk_fma_f16 v255, v254, v254, s60
    v_mfma_f32_16x16x32_bf16 v[236:239], v[212:215], v[140:143], v[236:239]
    ds_read_b64_tr_b16 v[208:209], v1 offset:18432
    v_pk_mul_f16 v255, v254, v255 neg_lo:[1,0] neg_hi:[1,0]
    v_mfma_f32_16x16x32_bf16 v[240:243], v[212:215], v[164:167], v[240:243]
    ds_read_b64_tr_b16 v[210:211], v1 offset:18688
    v_cvt_pk_f16_f32 v248, v228, v229
    v_mfma_f32_16x16x32_bf16 v[236:239], v[216:219], v[144:147], v[236:239]
    ds_read_b64_tr_b16 v[212:213], v1 offset:20480
    v_pk_fma_f16 v249, v248, v248, s60
    v_mfma_f32_16x16x32_bf16 v[240:243], v[216:219], v[168:171], v[240:243]
    ds_read_b64_tr_b16 v[214:215], v1 offset:20736
    ds_read_b64_tr_b16 v[216:217], v1 offset:22528
    ds_read_b64_tr_b16 v[218:219], v1 offset:22784
    v_exp_f16_sdwa v252, v253 dst_sel:WORD_0 dst_unused:UNUSED_PAD src0_sel:WORD_0
    v_exp_f16_sdwa v254, v255 dst_sel:WORD_0 dst_unused:UNUSED_PAD src0_sel:WORD_0
    v_exp_f16_sdwa v252, v253 dst_sel:WORD_1 dst_unused:UNUSED_PRESERVE src0_sel:WORD_1
    v_exp_f16_sdwa v254, v255 dst_sel:WORD_1 dst_unused:UNUSED_PRESERVE src0_sel:WORD_1
    v_pk_fma_f16 v252, v252, s61, s61
    v_rcp_f16_sdwa v253, v252 dst_sel:WORD_0 dst_unused:UNUSED_PAD src0_sel:WORD_0
    v_pk_fma_f16 v254, v254, s61, s61
    v_rcp_f16_sdwa v252, v252 dst_sel:WORD_0 dst_unused:UNUSED_PAD src0_sel:WORD_1
    v_fma_mix_f32 v224, v224, v253, 0 op_sel_hi:[0,1,0]
    v_fma_mix_f32 v225, v225, v252, 0 op_sel_hi:[0,1,0]
    v_cvt_pk_bf16_f32 v110, v224, v225
    v_rcp_f16_sdwa v255, v254 dst_sel:WORD_0 dst_unused:UNUSED_PAD src0_sel:WORD_0
    v_pk_mul_f16 v249, v248, v249 neg_lo:[1,0] neg_hi:[1,0]
    v_rcp_f16_sdwa v254, v254 dst_sel:WORD_0 dst_unused:UNUSED_PAD src0_sel:WORD_1
    v_fma_mix_f32 v226, v226, v255, 0 op_sel_hi:[0,1,0]
    v_fma_mix_f32 v227, v227, v254, 0 op_sel_hi:[0,1,0]
    v_cvt_pk_bf16_f32 v111, v226, v227
    v_exp_f16_sdwa v248, v249 dst_sel:WORD_0 dst_unused:UNUSED_PAD src0_sel:WORD_0
    v_cvt_pk_f16_f32 v250, v230, v231
    v_exp_f16_sdwa v248, v249 dst_sel:WORD_1 dst_unused:UNUSED_PRESERVE src0_sel:WORD_1
    v_pk_fma_f16 v251, v250, v250, s60
    v_pk_fma_f16 v248, v248, s61, s61
    v_rcp_f16_sdwa v249, v248 dst_sel:WORD_0 dst_unused:UNUSED_PAD src0_sel:WORD_0
    v_pk_mul_f16 v251, v250, v251 neg_lo:[1,0] neg_hi:[1,0]
    v_rcp_f16_sdwa v248, v248 dst_sel:WORD_0 dst_unused:UNUSED_PAD src0_sel:WORD_1
    v_fma_mix_f32 v228, v228, v249, 0 op_sel_hi:[0,1,0]
    v_fma_mix_f32 v229, v229, v248, 0 op_sel_hi:[0,1,0]
    v_cvt_pk_bf16_f32 v112, v228, v229
    v_exp_f16_sdwa v250, v251 dst_sel:WORD_0 dst_unused:UNUSED_PAD src0_sel:WORD_0
    v_cvt_pk_f16_f32 v252, v232, v233
    v_exp_f16_sdwa v250, v251 dst_sel:WORD_1 dst_unused:UNUSED_PRESERVE src0_sel:WORD_1
    v_pk_fma_f16 v253, v252, v252, s60
    v_pk_fma_f16 v250, v250, s61, s61
    v_rcp_f16_sdwa v251, v250 dst_sel:WORD_0 dst_unused:UNUSED_PAD src0_sel:WORD_0
    v_pk_mul_f16 v253, v252, v253 neg_lo:[1,0] neg_hi:[1,0]
    v_rcp_f16_sdwa v250, v250 dst_sel:WORD_0 dst_unused:UNUSED_PAD src0_sel:WORD_1
    v_fma_mix_f32 v230, v230, v251, 0 op_sel_hi:[0,1,0]
    v_fma_mix_f32 v231, v231, v250, 0 op_sel_hi:[0,1,0]
    v_cvt_pk_bf16_f32 v113, v230, v231
    v_exp_f16_sdwa v252, v253 dst_sel:WORD_0 dst_unused:UNUSED_PAD src0_sel:WORD_0
    v_cvt_pk_f16_f32 v254, v234, v235
    v_exp_f16_sdwa v252, v253 dst_sel:WORD_1 dst_unused:UNUSED_PRESERVE src0_sel:WORD_1
    v_pk_fma_f16 v255, v254, v254, s60
    v_pk_fma_f16 v252, v252, s61, s61
    v_rcp_f16_sdwa v253, v252 dst_sel:WORD_0 dst_unused:UNUSED_PAD src0_sel:WORD_0
    v_pk_mul_f16 v255, v254, v255 neg_lo:[1,0] neg_hi:[1,0]
    v_rcp_f16_sdwa v252, v252 dst_sel:WORD_0 dst_unused:UNUSED_PAD src0_sel:WORD_1
    v_fma_mix_f32 v232, v232, v253, 0 op_sel_hi:[0,1,0]
    v_fma_mix_f32 v233, v233, v252, 0 op_sel_hi:[0,1,0]
    v_cvt_pk_bf16_f32 v114, v232, v233
    v_exp_f16_sdwa v254, v255 dst_sel:WORD_0 dst_unused:UNUSED_PAD src0_sel:WORD_0
    v_cvt_pk_f16_f32 v248, v236, v237
    v_exp_f16_sdwa v254, v255 dst_sel:WORD_1 dst_unused:UNUSED_PRESERVE src0_sel:WORD_1
    v_pk_fma_f16 v249, v248, v248, s60
    v_pk_fma_f16 v254, v254, s61, s61
    v_rcp_f16_sdwa v255, v254 dst_sel:WORD_0 dst_unused:UNUSED_PAD src0_sel:WORD_0
    v_pk_mul_f16 v249, v248, v249 neg_lo:[1,0] neg_hi:[1,0]
    v_rcp_f16_sdwa v254, v254 dst_sel:WORD_0 dst_unused:UNUSED_PAD src0_sel:WORD_1
    v_fma_mix_f32 v234, v234, v255, 0 op_sel_hi:[0,1,0]
    v_fma_mix_f32 v235, v235, v254, 0 op_sel_hi:[0,1,0]
    v_cvt_pk_bf16_f32 v115, v234, v235
    v_exp_f16_sdwa v248, v249 dst_sel:WORD_0 dst_unused:UNUSED_PAD src0_sel:WORD_0
    v_cvt_pk_f16_f32 v250, v238, v239
    v_exp_f16_sdwa v248, v249 dst_sel:WORD_1 dst_unused:UNUSED_PRESERVE src0_sel:WORD_1
    v_pk_fma_f16 v251, v250, v250, s60
    v_pk_fma_f16 v248, v248, s61, s61
    v_rcp_f16_sdwa v249, v248 dst_sel:WORD_0 dst_unused:UNUSED_PAD src0_sel:WORD_0
    v_pk_mul_f16 v251, v250, v251 neg_lo:[1,0] neg_hi:[1,0]
    v_rcp_f16_sdwa v248, v248 dst_sel:WORD_0 dst_unused:UNUSED_PAD src0_sel:WORD_1
    v_fma_mix_f32 v236, v236, v249, 0 op_sel_hi:[0,1,0]
    v_fma_mix_f32 v237, v237, v248, 0 op_sel_hi:[0,1,0]
    v_cvt_pk_bf16_f32 v116, v236, v237
    v_exp_f16_sdwa v250, v251 dst_sel:WORD_0 dst_unused:UNUSED_PAD src0_sel:WORD_0
    v_cvt_pk_f16_f32 v252, v240, v241
    v_exp_f16_sdwa v250, v251 dst_sel:WORD_1 dst_unused:UNUSED_PRESERVE src0_sel:WORD_1
    v_pk_fma_f16 v253, v252, v252, s60
    v_pk_fma_f16 v250, v250, s61, s61
    v_rcp_f16_sdwa v251, v250 dst_sel:WORD_0 dst_unused:UNUSED_PAD src0_sel:WORD_0
    v_pk_mul_f16 v253, v252, v253 neg_lo:[1,0] neg_hi:[1,0]
    v_rcp_f16_sdwa v250, v250 dst_sel:WORD_0 dst_unused:UNUSED_PAD src0_sel:WORD_1
    v_fma_mix_f32 v238, v238, v251, 0 op_sel_hi:[0,1,0]
    v_fma_mix_f32 v239, v239, v250, 0 op_sel_hi:[0,1,0]
    v_cvt_pk_bf16_f32 v117, v238, v239
    v_exp_f16_sdwa v252, v253 dst_sel:WORD_0 dst_unused:UNUSED_PAD src0_sel:WORD_0
    v_cvt_pk_f16_f32 v254, v242, v243
    v_exp_f16_sdwa v252, v253 dst_sel:WORD_1 dst_unused:UNUSED_PRESERVE src0_sel:WORD_1
    v_pk_fma_f16 v255, v254, v254, s60
    v_pk_fma_f16 v252, v252, s61, s61
    s_waitcnt lgkmcnt(0)
    v_mfma_f32_16x16x32_bf16 v[220:223], v[196:199], v[12:15], 0
    ds_write2st64_b64 v2, v[108:109], v[110:111] offset0:61 offset1:62
    v_pk_mul_f16 v255, v254, v255 neg_lo:[1,0] neg_hi:[1,0]
    v_mfma_f32_16x16x32_bf16 v[220:223], v[200:203], v[16:19], v[220:223]
    v_rcp_f16_sdwa v253, v252 dst_sel:WORD_0 dst_unused:UNUSED_PAD src0_sel:WORD_0
    v_mfma_f32_16x16x32_bf16 v[220:223], v[204:207], v[20:23], v[220:223]
    v_rcp_f16_sdwa v252, v252 dst_sel:WORD_0 dst_unused:UNUSED_PAD src0_sel:WORD_1
    v_mfma_f32_16x16x32_bf16 v[220:223], v[208:211], v[24:27], v[220:223]
    v_exp_f16_sdwa v254, v255 dst_sel:WORD_0 dst_unused:UNUSED_PAD src0_sel:WORD_0
    v_mfma_f32_16x16x32_bf16 v[220:223], v[212:215], v[28:31], v[220:223]
    v_exp_f16_sdwa v254, v255 dst_sel:WORD_1 dst_unused:UNUSED_PRESERVE src0_sel:WORD_1
    v_mfma_f32_16x16x32_bf16 v[220:223], v[216:219], v[32:35], v[220:223]
    v_fma_mix_f32 v240, v240, v253, 0 op_sel_hi:[0,1,0]
    v_fma_mix_f32 v241, v241, v252, 0 op_sel_hi:[0,1,0]
    v_mfma_f32_16x16x32_bf16 v[224:227], v[196:199], v[36:39], 0
    v_cvt_pk_bf16_f32 v118, v240, v241
    v_pk_fma_f16 v254, v254, s61, s61
    v_mfma_f32_16x16x32_bf16 v[224:227], v[200:203], v[40:43], v[224:227]
    v_rcp_f16_sdwa v255, v254 dst_sel:WORD_0 dst_unused:UNUSED_PAD src0_sel:WORD_0
    v_mfma_f32_16x16x32_bf16 v[224:227], v[204:207], v[44:47], v[224:227]
    ds_write2st64_b64 v2, v[112:113], v[114:115] offset0:69 offset1:70
    v_fma_mix_f32 v242, v242, v255, 0 op_sel_hi:[0,1,0]
    v_mfma_f32_16x16x32_bf16 v[224:227], v[208:211], v[48:51], v[224:227]
    v_rcp_f16_sdwa v254, v254 dst_sel:WORD_0 dst_unused:UNUSED_PAD src0_sel:WORD_1
    v_mfma_f32_16x16x32_bf16 v[224:227], v[212:215], v[52:55], v[224:227]
    v_fma_mix_f32 v243, v243, v254, 0 op_sel_hi:[0,1,0]
    v_cvt_pk_bf16_f32 v119, v242, v243
    v_mfma_f32_16x16x32_bf16 v[224:227], v[216:219], v[56:59], v[224:227]
    v_cvt_pk_f16_f32 v248, v220, v221
    v_pk_fma_f16 v249, v248, v248, s60
    v_mfma_f32_16x16x32_bf16 v[228:231], v[196:199], v[60:63], 0
    v_pk_mul_f16 v249, v248, v249 neg_lo:[1,0] neg_hi:[1,0]
    v_cvt_pk_f16_f32 v250, v222, v223
    v_mfma_f32_16x16x32_bf16 v[228:231], v[200:203], v[64:67], v[228:231]
    v_exp_f16_sdwa v248, v249 dst_sel:WORD_0 dst_unused:UNUSED_PAD src0_sel:WORD_0
    v_mfma_f32_16x16x32_bf16 v[228:231], v[204:207], v[68:71], v[228:231]
    v_exp_f16_sdwa v248, v249 dst_sel:WORD_1 dst_unused:UNUSED_PRESERVE src0_sel:WORD_1
    v_mfma_f32_16x16x32_bf16 v[228:231], v[208:211], v[72:75], v[228:231]
    v_pk_fma_f16 v248, v248, s61, s61
    v_pk_fma_f16 v251, v250, v250, s60
    v_mfma_f32_16x16x32_bf16 v[228:231], v[212:215], v[76:79], v[228:231]
    ds_write2st64_b64 v2, v[116:117], v[118:119] offset0:77 offset1:78
    v_pk_mul_f16 v251, v250, v251 neg_lo:[1,0] neg_hi:[1,0]
    v_mfma_f32_16x16x32_bf16 v[228:231], v[216:219], v[80:83], v[228:231]
    v_rcp_f16_sdwa v249, v248 dst_sel:WORD_0 dst_unused:UNUSED_PAD src0_sel:WORD_0
    v_mfma_f32_16x16x32_bf16 v[232:235], v[196:199], v[84:87], 0
    v_rcp_f16_sdwa v248, v248 dst_sel:WORD_0 dst_unused:UNUSED_PAD src0_sel:WORD_1
    v_mfma_f32_16x16x32_bf16 v[232:235], v[200:203], v[88:91], v[232:235]
    v_exp_f16_sdwa v250, v251 dst_sel:WORD_0 dst_unused:UNUSED_PAD src0_sel:WORD_0
    v_mfma_f32_16x16x32_bf16 v[232:235], v[204:207], v[92:95], v[232:235]
    v_exp_f16_sdwa v250, v251 dst_sel:WORD_1 dst_unused:UNUSED_PRESERVE src0_sel:WORD_1
    v_mfma_f32_16x16x32_bf16 v[232:235], v[208:211], v[96:99], v[232:235]
    v_fma_mix_f32 v220, v220, v249, 0 op_sel_hi:[0,1,0]
    v_fma_mix_f32 v221, v221, v248, 0 op_sel_hi:[0,1,0]
    v_mfma_f32_16x16x32_bf16 v[232:235], v[212:215], v[100:103], v[232:235]
    v_cvt_pk_bf16_f32 v108, v220, v221
    v_pk_fma_f16 v250, v250, s61, s61
    v_mfma_f32_16x16x32_bf16 v[232:235], v[216:219], v[104:107], v[232:235]
    v_rcp_f16_sdwa v251, v250 dst_sel:WORD_0 dst_unused:UNUSED_PAD src0_sel:WORD_0
    s_waitcnt lgkmcnt(0)
    s_barrier
    s_mov_b32 s64, 1
.p2align 3
L_PN_loop:
    v_mfma_f32_16x16x32_bf16 v[236:239], v[196:199], v[124:127], 0
    v_rcp_f16_sdwa v250, v250 dst_sel:WORD_0 dst_unused:UNUSED_PAD src0_sel:WORD_1
    v_mfma_f32_16x16x32_bf16 v[240:243], v[196:199], v[148:151], 0
    v_fma_mix_f32 v222, v222, v251, 0 op_sel_hi:[0,1,0]
    v_fma_mix_f32 v223, v223, v250, 0 op_sel_hi:[0,1,0]
    v_mfma_f32_16x16x32_bf16 v[236:239], v[200:203], v[128:131], v[236:239]
    ds_read_b64_tr_b16 v[196:197], v1 offset:24576
    v_cvt_pk_bf16_f32 v109, v222, v223
    v_mfma_f32_16x16x32_bf16 v[240:243], v[200:203], v[152:155], v[240:243]
    ds_read_b64_tr_b16 v[198:199], v1 offset:24832
    v_cvt_pk_f16_f32 v252, v224, v225
    v_mfma_f32_16x16x32_bf16 v[236:239], v[204:207], v[132:135], v[236:239]
    ds_read_b64_tr_b16 v[200:201], v1 offset:26624
    v_pk_fma_f16 v253, v252, v252, s60
    v_mfma_f32_16x16x32_bf16 v[240:243], v[204:207], v[156:159], v[240:243]
    ds_read_b64_tr_b16 v[202:203], v1 offset:26880
    v_pk_mul_f16 v253, v252, v253 neg_lo:[1,0] neg_hi:[1,0]
    v_mfma_f32_16x16x32_bf16 v[236:239], v[208:211], v[136:139], v[236:239]
    ds_read_b64_tr_b16 v[204:205], v1 offset:28672
    v_cvt_pk_f16_f32 v254, v226, v227
    v_mfma_f32_16x16x32_bf16 v[240:243], v[208:211], v[160:163], v[240:243]
    ds_read_b64_tr_b16 v[206:207], v1 offset:28928
    v_pk_fma_f16 v255, v254, v254, s60
    v_mfma_f32_16x16x32_bf16 v[236:239], v[212:215], v[140:143], v[236:239]
    ds_read_b64_tr_b16 v[208:209], v1 offset:30720
    v_pk_mul_f16 v255, v254, v255 neg_lo:[1,0] neg_hi:[1,0]
    v_mfma_f32_16x16x32_bf16 v[240:243], v[212:215], v[164:167], v[240:243]
    ds_read_b64_tr_b16 v[210:211], v1 offset:30976
    v_cvt_pk_f16_f32 v248, v228, v229
    v_mfma_f32_16x16x32_bf16 v[236:239], v[216:219], v[144:147], v[236:239]
    ds_read_b64_tr_b16 v[212:213], v1 offset:32768
    v_pk_fma_f16 v249, v248, v248, s60
    v_mfma_f32_16x16x32_bf16 v[240:243], v[216:219], v[168:171], v[240:243]
    ds_read_b64_tr_b16 v[214:215], v1 offset:33024
    ds_read_b64_tr_b16 v[216:217], v1 offset:34816
    ds_read_b64_tr_b16 v[218:219], v1 offset:35072
    v_exp_f16_sdwa v252, v253 dst_sel:WORD_0 dst_unused:UNUSED_PAD src0_sel:WORD_0
    v_exp_f16_sdwa v254, v255 dst_sel:WORD_0 dst_unused:UNUSED_PAD src0_sel:WORD_0
    v_exp_f16_sdwa v252, v253 dst_sel:WORD_1 dst_unused:UNUSED_PRESERVE src0_sel:WORD_1
    v_exp_f16_sdwa v254, v255 dst_sel:WORD_1 dst_unused:UNUSED_PRESERVE src0_sel:WORD_1
    v_pk_fma_f16 v252, v252, s61, s61
    v_rcp_f16_sdwa v253, v252 dst_sel:WORD_0 dst_unused:UNUSED_PAD src0_sel:WORD_0
    v_pk_fma_f16 v254, v254, s61, s61
    v_rcp_f16_sdwa v252, v252 dst_sel:WORD_0 dst_unused:UNUSED_PAD src0_sel:WORD_1
    v_fma_mix_f32 v224, v224, v253, 0 op_sel_hi:[0,1,0]
    v_fma_mix_f32 v225, v225, v252, 0 op_sel_hi:[0,1,0]
    v_cvt_pk_bf16_f32 v110, v224, v225
    v_rcp_f16_sdwa v255, v254 dst_sel:WORD_0 dst_unused:UNUSED_PAD src0_sel:WORD_0
    v_pk_mul_f16 v249, v248, v249 neg_lo:[1,0] neg_hi:[1,0]
    v_rcp_f16_sdwa v254, v254 dst_sel:WORD_0 dst_unused:UNUSED_PAD src0_sel:WORD_1
    v_fma_mix_f32 v226, v226, v255, 0 op_sel_hi:[0,1,0]
    v_fma_mix_f32 v227, v227, v254, 0 op_sel_hi:[0,1,0]
    v_cvt_pk_bf16_f32 v111, v226, v227
    v_exp_f16_sdwa v248, v249 dst_sel:WORD_0 dst_unused:UNUSED_PAD src0_sel:WORD_0
    v_cvt_pk_f16_f32 v250, v230, v231
    v_exp_f16_sdwa v248, v249 dst_sel:WORD_1 dst_unused:UNUSED_PRESERVE src0_sel:WORD_1
    v_pk_fma_f16 v251, v250, v250, s60
    v_pk_fma_f16 v248, v248, s61, s61
    v_rcp_f16_sdwa v249, v248 dst_sel:WORD_0 dst_unused:UNUSED_PAD src0_sel:WORD_0
    v_pk_mul_f16 v251, v250, v251 neg_lo:[1,0] neg_hi:[1,0]
    v_rcp_f16_sdwa v248, v248 dst_sel:WORD_0 dst_unused:UNUSED_PAD src0_sel:WORD_1
    v_fma_mix_f32 v228, v228, v249, 0 op_sel_hi:[0,1,0]
    v_fma_mix_f32 v229, v229, v248, 0 op_sel_hi:[0,1,0]
    v_cvt_pk_bf16_f32 v112, v228, v229
    v_exp_f16_sdwa v250, v251 dst_sel:WORD_0 dst_unused:UNUSED_PAD src0_sel:WORD_0
    v_cvt_pk_f16_f32 v252, v232, v233
    v_exp_f16_sdwa v250, v251 dst_sel:WORD_1 dst_unused:UNUSED_PRESERVE src0_sel:WORD_1
    v_pk_fma_f16 v253, v252, v252, s60
    v_pk_fma_f16 v250, v250, s61, s61
    v_rcp_f16_sdwa v251, v250 dst_sel:WORD_0 dst_unused:UNUSED_PAD src0_sel:WORD_0
    v_pk_mul_f16 v253, v252, v253 neg_lo:[1,0] neg_hi:[1,0]
    v_rcp_f16_sdwa v250, v250 dst_sel:WORD_0 dst_unused:UNUSED_PAD src0_sel:WORD_1
    v_fma_mix_f32 v230, v230, v251, 0 op_sel_hi:[0,1,0]
    v_fma_mix_f32 v231, v231, v250, 0 op_sel_hi:[0,1,0]
    v_cvt_pk_bf16_f32 v113, v230, v231
    v_exp_f16_sdwa v252, v253 dst_sel:WORD_0 dst_unused:UNUSED_PAD src0_sel:WORD_0
    v_cvt_pk_f16_f32 v254, v234, v235
    v_exp_f16_sdwa v252, v253 dst_sel:WORD_1 dst_unused:UNUSED_PRESERVE src0_sel:WORD_1
    v_pk_fma_f16 v255, v254, v254, s60
    v_pk_fma_f16 v252, v252, s61, s61
    v_rcp_f16_sdwa v253, v252 dst_sel:WORD_0 dst_unused:UNUSED_PAD src0_sel:WORD_0
    v_pk_mul_f16 v255, v254, v255 neg_lo:[1,0] neg_hi:[1,0]
    v_rcp_f16_sdwa v252, v252 dst_sel:WORD_0 dst_unused:UNUSED_PAD src0_sel:WORD_1
    v_fma_mix_f32 v232, v232, v253, 0 op_sel_hi:[0,1,0]
    v_fma_mix_f32 v233, v233, v252, 0 op_sel_hi:[0,1,0]
    v_cvt_pk_bf16_f32 v114, v232, v233
    v_exp_f16_sdwa v254, v255 dst_sel:WORD_0 dst_unused:UNUSED_PAD src0_sel:WORD_0
    v_cvt_pk_f16_f32 v248, v236, v237
    v_exp_f16_sdwa v254, v255 dst_sel:WORD_1 dst_unused:UNUSED_PRESERVE src0_sel:WORD_1
    v_pk_fma_f16 v249, v248, v248, s60
    v_pk_fma_f16 v254, v254, s61, s61
    v_rcp_f16_sdwa v255, v254 dst_sel:WORD_0 dst_unused:UNUSED_PAD src0_sel:WORD_0
    v_pk_mul_f16 v249, v248, v249 neg_lo:[1,0] neg_hi:[1,0]
    v_rcp_f16_sdwa v254, v254 dst_sel:WORD_0 dst_unused:UNUSED_PAD src0_sel:WORD_1
    v_fma_mix_f32 v234, v234, v255, 0 op_sel_hi:[0,1,0]
    v_fma_mix_f32 v235, v235, v254, 0 op_sel_hi:[0,1,0]
    v_cvt_pk_bf16_f32 v115, v234, v235
    v_exp_f16_sdwa v248, v249 dst_sel:WORD_0 dst_unused:UNUSED_PAD src0_sel:WORD_0
    v_cvt_pk_f16_f32 v250, v238, v239
    v_exp_f16_sdwa v248, v249 dst_sel:WORD_1 dst_unused:UNUSED_PRESERVE src0_sel:WORD_1
    v_pk_fma_f16 v251, v250, v250, s60
    v_pk_fma_f16 v248, v248, s61, s61
    v_rcp_f16_sdwa v249, v248 dst_sel:WORD_0 dst_unused:UNUSED_PAD src0_sel:WORD_0
    v_pk_mul_f16 v251, v250, v251 neg_lo:[1,0] neg_hi:[1,0]
    v_rcp_f16_sdwa v248, v248 dst_sel:WORD_0 dst_unused:UNUSED_PAD src0_sel:WORD_1
    v_fma_mix_f32 v236, v236, v249, 0 op_sel_hi:[0,1,0]
    v_fma_mix_f32 v237, v237, v248, 0 op_sel_hi:[0,1,0]
    v_cvt_pk_bf16_f32 v116, v236, v237
    v_exp_f16_sdwa v250, v251 dst_sel:WORD_0 dst_unused:UNUSED_PAD src0_sel:WORD_0
    v_cvt_pk_f16_f32 v252, v240, v241
    v_exp_f16_sdwa v250, v251 dst_sel:WORD_1 dst_unused:UNUSED_PRESERVE src0_sel:WORD_1
    v_pk_fma_f16 v253, v252, v252, s60
    v_pk_fma_f16 v250, v250, s61, s61
    v_rcp_f16_sdwa v251, v250 dst_sel:WORD_0 dst_unused:UNUSED_PAD src0_sel:WORD_0
    v_pk_mul_f16 v253, v252, v253 neg_lo:[1,0] neg_hi:[1,0]
    v_rcp_f16_sdwa v250, v250 dst_sel:WORD_0 dst_unused:UNUSED_PAD src0_sel:WORD_1
    v_fma_mix_f32 v238, v238, v251, 0 op_sel_hi:[0,1,0]
    v_fma_mix_f32 v239, v239, v250, 0 op_sel_hi:[0,1,0]
    v_cvt_pk_bf16_f32 v117, v238, v239
    v_exp_f16_sdwa v252, v253 dst_sel:WORD_0 dst_unused:UNUSED_PAD src0_sel:WORD_0
    v_cvt_pk_f16_f32 v254, v242, v243
    v_exp_f16_sdwa v252, v253 dst_sel:WORD_1 dst_unused:UNUSED_PRESERVE src0_sel:WORD_1
    v_pk_fma_f16 v255, v254, v254, s60
    v_pk_fma_f16 v252, v252, s61, s61
    s_waitcnt lgkmcnt(0)
    v_mfma_f32_16x16x32_bf16 v[220:223], v[196:199], v[12:15], 0
    ds_write2st64_b64 v2, v[108:109], v[110:111] offset0:0 offset1:1
    v_pk_mul_f16 v255, v254, v255 neg_lo:[1,0] neg_hi:[1,0]
    v_mfma_f32_16x16x32_bf16 v[220:223], v[200:203], v[16:19], v[220:223]
    v_rcp_f16_sdwa v253, v252 dst_sel:WORD_0 dst_unused:UNUSED_PAD src0_sel:WORD_0
    v_mfma_f32_16x16x32_bf16 v[220:223], v[204:207], v[20:23], v[220:223]
    v_rcp_f16_sdwa v252, v252 dst_sel:WORD_0 dst_unused:UNUSED_PAD src0_sel:WORD_1
    v_mfma_f32_16x16x32_bf16 v[220:223], v[208:211], v[24:27], v[220:223]
    v_exp_f16_sdwa v254, v255 dst_sel:WORD_0 dst_unused:UNUSED_PAD src0_sel:WORD_0
    v_mfma_f32_16x16x32_bf16 v[220:223], v[212:215], v[28:31], v[220:223]
    v_exp_f16_sdwa v254, v255 dst_sel:WORD_1 dst_unused:UNUSED_PRESERVE src0_sel:WORD_1
    v_mfma_f32_16x16x32_bf16 v[220:223], v[216:219], v[32:35], v[220:223]
    v_fma_mix_f32 v240, v240, v253, 0 op_sel_hi:[0,1,0]
    v_fma_mix_f32 v241, v241, v252, 0 op_sel_hi:[0,1,0]
    v_mfma_f32_16x16x32_bf16 v[224:227], v[196:199], v[36:39], 0
    v_cvt_pk_bf16_f32 v118, v240, v241
    v_pk_fma_f16 v254, v254, s61, s61
    v_mfma_f32_16x16x32_bf16 v[224:227], v[200:203], v[40:43], v[224:227]
    v_rcp_f16_sdwa v255, v254 dst_sel:WORD_0 dst_unused:UNUSED_PAD src0_sel:WORD_0
    v_mfma_f32_16x16x32_bf16 v[224:227], v[204:207], v[44:47], v[224:227]
    ds_write2st64_b64 v2, v[112:113], v[114:115] offset0:8 offset1:9
    v_fma_mix_f32 v242, v242, v255, 0 op_sel_hi:[0,1,0]
    v_mfma_f32_16x16x32_bf16 v[224:227], v[208:211], v[48:51], v[224:227]
    v_rcp_f16_sdwa v254, v254 dst_sel:WORD_0 dst_unused:UNUSED_PAD src0_sel:WORD_1
    v_mfma_f32_16x16x32_bf16 v[224:227], v[212:215], v[52:55], v[224:227]
    v_fma_mix_f32 v243, v243, v254, 0 op_sel_hi:[0,1,0]
    v_cvt_pk_bf16_f32 v119, v242, v243
    v_mfma_f32_16x16x32_bf16 v[224:227], v[216:219], v[56:59], v[224:227]
    v_cvt_pk_f16_f32 v248, v220, v221
    v_pk_fma_f16 v249, v248, v248, s60
    v_mfma_f32_16x16x32_bf16 v[228:231], v[196:199], v[60:63], 0
    v_pk_mul_f16 v249, v248, v249 neg_lo:[1,0] neg_hi:[1,0]
    v_cvt_pk_f16_f32 v250, v222, v223
    v_mfma_f32_16x16x32_bf16 v[228:231], v[200:203], v[64:67], v[228:231]
    v_exp_f16_sdwa v248, v249 dst_sel:WORD_0 dst_unused:UNUSED_PAD src0_sel:WORD_0
    v_mfma_f32_16x16x32_bf16 v[228:231], v[204:207], v[68:71], v[228:231]
    v_exp_f16_sdwa v248, v249 dst_sel:WORD_1 dst_unused:UNUSED_PRESERVE src0_sel:WORD_1
    v_mfma_f32_16x16x32_bf16 v[228:231], v[208:211], v[72:75], v[228:231]
    v_pk_fma_f16 v248, v248, s61, s61
    v_pk_fma_f16 v251, v250, v250, s60
    v_mfma_f32_16x16x32_bf16 v[228:231], v[212:215], v[76:79], v[228:231]
    ds_write2st64_b64 v2, v[116:117], v[118:119] offset0:16 offset1:17
    v_pk_mul_f16 v251, v250, v251 neg_lo:[1,0] neg_hi:[1,0]
    v_mfma_f32_16x16x32_bf16 v[228:231], v[216:219], v[80:83], v[228:231]
    v_rcp_f16_sdwa v249, v248 dst_sel:WORD_0 dst_unused:UNUSED_PAD src0_sel:WORD_0
    v_mfma_f32_16x16x32_bf16 v[232:235], v[196:199], v[84:87], 0
    v_rcp_f16_sdwa v248, v248 dst_sel:WORD_0 dst_unused:UNUSED_PAD src0_sel:WORD_1
    v_mfma_f32_16x16x32_bf16 v[232:235], v[200:203], v[88:91], v[232:235]
    v_exp_f16_sdwa v250, v251 dst_sel:WORD_0 dst_unused:UNUSED_PAD src0_sel:WORD_0
    v_mfma_f32_16x16x32_bf16 v[232:235], v[204:207], v[92:95], v[232:235]
    v_exp_f16_sdwa v250, v251 dst_sel:WORD_1 dst_unused:UNUSED_PRESERVE src0_sel:WORD_1
    v_mfma_f32_16x16x32_bf16 v[232:235], v[208:211], v[96:99], v[232:235]
    v_fma_mix_f32 v220, v220, v249, 0 op_sel_hi:[0,1,0]
    v_fma_mix_f32 v221, v221, v248, 0 op_sel_hi:[0,1,0]
    v_mfma_f32_16x16x32_bf16 v[232:235], v[212:215], v[100:103], v[232:235]
    v_cvt_pk_bf16_f32 v108, v220, v221
    v_pk_fma_f16 v250, v250, s61, s61
    v_mfma_f32_16x16x32_bf16 v[232:235], v[216:219], v[104:107], v[232:235]
    v_rcp_f16_sdwa v251, v250 dst_sel:WORD_0 dst_unused:UNUSED_PAD src0_sel:WORD_0
    s_waitcnt lgkmcnt(0)
    s_barrier
    v_mfma_f32_16x16x32_bf16 v[236:239], v[196:199], v[124:127], 0
    v_rcp_f16_sdwa v250, v250 dst_sel:WORD_0 dst_unused:UNUSED_PAD src0_sel:WORD_1
    v_mfma_f32_16x16x32_bf16 v[240:243], v[196:199], v[148:151], 0
    v_fma_mix_f32 v222, v222, v251, 0 op_sel_hi:[0,1,0]
    v_fma_mix_f32 v223, v223, v250, 0 op_sel_hi:[0,1,0]
    v_mfma_f32_16x16x32_bf16 v[236:239], v[200:203], v[128:131], v[236:239]
    ds_read_b64_tr_b16 v[196:197], v1 offset:0
    v_cvt_pk_bf16_f32 v109, v222, v223
    v_mfma_f32_16x16x32_bf16 v[240:243], v[200:203], v[152:155], v[240:243]
    ds_read_b64_tr_b16 v[198:199], v1 offset:256
    v_cvt_pk_f16_f32 v252, v224, v225
    v_mfma_f32_16x16x32_bf16 v[236:239], v[204:207], v[132:135], v[236:239]
    ds_read_b64_tr_b16 v[200:201], v1 offset:2048
    v_pk_fma_f16 v253, v252, v252, s60
    v_mfma_f32_16x16x32_bf16 v[240:243], v[204:207], v[156:159], v[240:243]
    ds_read_b64_tr_b16 v[202:203], v1 offset:2304
    v_pk_mul_f16 v253, v252, v253 neg_lo:[1,0] neg_hi:[1,0]
    v_mfma_f32_16x16x32_bf16 v[236:239], v[208:211], v[136:139], v[236:239]
    ds_read_b64_tr_b16 v[204:205], v1 offset:4096
    v_cvt_pk_f16_f32 v254, v226, v227
    v_mfma_f32_16x16x32_bf16 v[240:243], v[208:211], v[160:163], v[240:243]
    ds_read_b64_tr_b16 v[206:207], v1 offset:4352
    v_pk_fma_f16 v255, v254, v254, s60
    v_mfma_f32_16x16x32_bf16 v[236:239], v[212:215], v[140:143], v[236:239]
    ds_read_b64_tr_b16 v[208:209], v1 offset:6144
    v_pk_mul_f16 v255, v254, v255 neg_lo:[1,0] neg_hi:[1,0]
    v_mfma_f32_16x16x32_bf16 v[240:243], v[212:215], v[164:167], v[240:243]
    ds_read_b64_tr_b16 v[210:211], v1 offset:6400
    v_cvt_pk_f16_f32 v248, v228, v229
    v_mfma_f32_16x16x32_bf16 v[236:239], v[216:219], v[144:147], v[236:239]
    ds_read_b64_tr_b16 v[212:213], v1 offset:8192
    v_pk_fma_f16 v249, v248, v248, s60
    v_mfma_f32_16x16x32_bf16 v[240:243], v[216:219], v[168:171], v[240:243]
    ds_read_b64_tr_b16 v[214:215], v1 offset:8448
    ds_read_b64_tr_b16 v[216:217], v1 offset:10240
    ds_read_b64_tr_b16 v[218:219], v1 offset:10496
    v_exp_f16_sdwa v252, v253 dst_sel:WORD_0 dst_unused:UNUSED_PAD src0_sel:WORD_0
    v_exp_f16_sdwa v254, v255 dst_sel:WORD_0 dst_unused:UNUSED_PAD src0_sel:WORD_0
    v_exp_f16_sdwa v252, v253 dst_sel:WORD_1 dst_unused:UNUSED_PRESERVE src0_sel:WORD_1
    v_exp_f16_sdwa v254, v255 dst_sel:WORD_1 dst_unused:UNUSED_PRESERVE src0_sel:WORD_1
    v_pk_fma_f16 v252, v252, s61, s61
    v_rcp_f16_sdwa v253, v252 dst_sel:WORD_0 dst_unused:UNUSED_PAD src0_sel:WORD_0
    v_pk_fma_f16 v254, v254, s61, s61
    v_rcp_f16_sdwa v252, v252 dst_sel:WORD_0 dst_unused:UNUSED_PAD src0_sel:WORD_1
    v_fma_mix_f32 v224, v224, v253, 0 op_sel_hi:[0,1,0]
    v_fma_mix_f32 v225, v225, v252, 0 op_sel_hi:[0,1,0]
    v_cvt_pk_bf16_f32 v110, v224, v225
    v_rcp_f16_sdwa v255, v254 dst_sel:WORD_0 dst_unused:UNUSED_PAD src0_sel:WORD_0
    v_pk_mul_f16 v249, v248, v249 neg_lo:[1,0] neg_hi:[1,0]
    v_rcp_f16_sdwa v254, v254 dst_sel:WORD_0 dst_unused:UNUSED_PAD src0_sel:WORD_1
    v_fma_mix_f32 v226, v226, v255, 0 op_sel_hi:[0,1,0]
    v_fma_mix_f32 v227, v227, v254, 0 op_sel_hi:[0,1,0]
    v_cvt_pk_bf16_f32 v111, v226, v227
    v_exp_f16_sdwa v248, v249 dst_sel:WORD_0 dst_unused:UNUSED_PAD src0_sel:WORD_0
    v_cvt_pk_f16_f32 v250, v230, v231
    v_exp_f16_sdwa v248, v249 dst_sel:WORD_1 dst_unused:UNUSED_PRESERVE src0_sel:WORD_1
    v_pk_fma_f16 v251, v250, v250, s60
    v_pk_fma_f16 v248, v248, s61, s61
    v_rcp_f16_sdwa v249, v248 dst_sel:WORD_0 dst_unused:UNUSED_PAD src0_sel:WORD_0
    v_pk_mul_f16 v251, v250, v251 neg_lo:[1,0] neg_hi:[1,0]
    v_rcp_f16_sdwa v248, v248 dst_sel:WORD_0 dst_unused:UNUSED_PAD src0_sel:WORD_1
    v_fma_mix_f32 v228, v228, v249, 0 op_sel_hi:[0,1,0]
    v_fma_mix_f32 v229, v229, v248, 0 op_sel_hi:[0,1,0]
    v_cvt_pk_bf16_f32 v112, v228, v229
    v_exp_f16_sdwa v250, v251 dst_sel:WORD_0 dst_unused:UNUSED_PAD src0_sel:WORD_0
    v_cvt_pk_f16_f32 v252, v232, v233
    v_exp_f16_sdwa v250, v251 dst_sel:WORD_1 dst_unused:UNUSED_PRESERVE src0_sel:WORD_1
    v_pk_fma_f16 v253, v252, v252, s60
    v_pk_fma_f16 v250, v250, s61, s61
    v_rcp_f16_sdwa v251, v250 dst_sel:WORD_0 dst_unused:UNUSED_PAD src0_sel:WORD_0
    v_pk_mul_f16 v253, v252, v253 neg_lo:[1,0] neg_hi:[1,0]
    v_rcp_f16_sdwa v250, v250 dst_sel:WORD_0 dst_unused:UNUSED_PAD src0_sel:WORD_1
    v_fma_mix_f32 v230, v230, v251, 0 op_sel_hi:[0,1,0]
    v_fma_mix_f32 v231, v231, v250, 0 op_sel_hi:[0,1,0]
    v_cvt_pk_bf16_f32 v113, v230, v231
    v_exp_f16_sdwa v252, v253 dst_sel:WORD_0 dst_unused:UNUSED_PAD src0_sel:WORD_0
    v_cvt_pk_f16_f32 v254, v234, v235
    v_exp_f16_sdwa v252, v253 dst_sel:WORD_1 dst_unused:UNUSED_PRESERVE src0_sel:WORD_1
    v_pk_fma_f16 v255, v254, v254, s60
    v_pk_fma_f16 v252, v252, s61, s61
    v_rcp_f16_sdwa v253, v252 dst_sel:WORD_0 dst_unused:UNUSED_PAD src0_sel:WORD_0
    v_pk_mul_f16 v255, v254, v255 neg_lo:[1,0] neg_hi:[1,0]
    v_rcp_f16_sdwa v252, v252 dst_sel:WORD_0 dst_unused:UNUSED_PAD src0_sel:WORD_1
    v_fma_mix_f32 v232, v232, v253, 0 op_sel_hi:[0,1,0]
    v_fma_mix_f32 v233, v233, v252, 0 op_sel_hi:[0,1,0]
    v_cvt_pk_bf16_f32 v114, v232, v233
    v_exp_f16_sdwa v254, v255 dst_sel:WORD_0 dst_unused:UNUSED_PAD src0_sel:WORD_0
    v_cvt_pk_f16_f32 v248, v236, v237
    v_exp_f16_sdwa v254, v255 dst_sel:WORD_1 dst_unused:UNUSED_PRESERVE src0_sel:WORD_1
    v_pk_fma_f16 v249, v248, v248, s60
    v_pk_fma_f16 v254, v254, s61, s61
    v_rcp_f16_sdwa v255, v254 dst_sel:WORD_0 dst_unused:UNUSED_PAD src0_sel:WORD_0
    v_pk_mul_f16 v249, v248, v249 neg_lo:[1,0] neg_hi:[1,0]
    v_rcp_f16_sdwa v254, v254 dst_sel:WORD_0 dst_unused:UNUSED_PAD src0_sel:WORD_1
    v_fma_mix_f32 v234, v234, v255, 0 op_sel_hi:[0,1,0]
    v_fma_mix_f32 v235, v235, v254, 0 op_sel_hi:[0,1,0]
    v_cvt_pk_bf16_f32 v115, v234, v235
    v_exp_f16_sdwa v248, v249 dst_sel:WORD_0 dst_unused:UNUSED_PAD src0_sel:WORD_0
    v_cvt_pk_f16_f32 v250, v238, v239
    v_exp_f16_sdwa v248, v249 dst_sel:WORD_1 dst_unused:UNUSED_PRESERVE src0_sel:WORD_1
    v_pk_fma_f16 v251, v250, v250, s60
    v_pk_fma_f16 v248, v248, s61, s61
    v_rcp_f16_sdwa v249, v248 dst_sel:WORD_0 dst_unused:UNUSED_PAD src0_sel:WORD_0
    v_pk_mul_f16 v251, v250, v251 neg_lo:[1,0] neg_hi:[1,0]
    v_rcp_f16_sdwa v248, v248 dst_sel:WORD_0 dst_unused:UNUSED_PAD src0_sel:WORD_1
    v_fma_mix_f32 v236, v236, v249, 0 op_sel_hi:[0,1,0]
    v_fma_mix_f32 v237, v237, v248, 0 op_sel_hi:[0,1,0]
    v_cvt_pk_bf16_f32 v116, v236, v237
    v_exp_f16_sdwa v250, v251 dst_sel:WORD_0 dst_unused:UNUSED_PAD src0_sel:WORD_0
    v_cvt_pk_f16_f32 v252, v240, v241
    v_exp_f16_sdwa v250, v251 dst_sel:WORD_1 dst_unused:UNUSED_PRESERVE src0_sel:WORD_1
    v_pk_fma_f16 v253, v252, v252, s60
    v_pk_fma_f16 v250, v250, s61, s61
    v_rcp_f16_sdwa v251, v250 dst_sel:WORD_0 dst_unused:UNUSED_PAD src0_sel:WORD_0
    v_pk_mul_f16 v253, v252, v253 neg_lo:[1,0] neg_hi:[1,0]
    v_rcp_f16_sdwa v250, v250 dst_sel:WORD_0 dst_unused:UNUSED_PAD src0_sel:WORD_1
    v_fma_mix_f32 v238, v238, v251, 0 op_sel_hi:[0,1,0]
    v_fma_mix_f32 v239, v239, v250, 0 op_sel_hi:[0,1,0]
    v_cvt_pk_bf16_f32 v117, v238, v239
    v_exp_f16_sdwa v252, v253 dst_sel:WORD_0 dst_unused:UNUSED_PAD src0_sel:WORD_0
    v_cvt_pk_f16_f32 v254, v242, v243
    v_exp_f16_sdwa v252, v253 dst_sel:WORD_1 dst_unused:UNUSED_PRESERVE src0_sel:WORD_1
    v_pk_fma_f16 v255, v254, v254, s60
    v_pk_fma_f16 v252, v252, s61, s61
    s_waitcnt lgkmcnt(0)
    v_mfma_f32_16x16x32_bf16 v[220:223], v[196:199], v[12:15], 0
    ds_write2st64_b64 v2, v[108:109], v[110:111] offset0:26 offset1:27
    v_pk_mul_f16 v255, v254, v255 neg_lo:[1,0] neg_hi:[1,0]
    v_mfma_f32_16x16x32_bf16 v[220:223], v[200:203], v[16:19], v[220:223]
    v_rcp_f16_sdwa v253, v252 dst_sel:WORD_0 dst_unused:UNUSED_PAD src0_sel:WORD_0
    v_mfma_f32_16x16x32_bf16 v[220:223], v[204:207], v[20:23], v[220:223]
    v_rcp_f16_sdwa v252, v252 dst_sel:WORD_0 dst_unused:UNUSED_PAD src0_sel:WORD_1
    v_mfma_f32_16x16x32_bf16 v[220:223], v[208:211], v[24:27], v[220:223]
    v_exp_f16_sdwa v254, v255 dst_sel:WORD_0 dst_unused:UNUSED_PAD src0_sel:WORD_0
    v_mfma_f32_16x16x32_bf16 v[220:223], v[212:215], v[28:31], v[220:223]
    v_exp_f16_sdwa v254, v255 dst_sel:WORD_1 dst_unused:UNUSED_PRESERVE src0_sel:WORD_1
    v_mfma_f32_16x16x32_bf16 v[220:223], v[216:219], v[32:35], v[220:223]
    v_fma_mix_f32 v240, v240, v253, 0 op_sel_hi:[0,1,0]
    v_fma_mix_f32 v241, v241, v252, 0 op_sel_hi:[0,1,0]
    v_mfma_f32_16x16x32_bf16 v[224:227], v[196:199], v[36:39], 0
    v_cvt_pk_bf16_f32 v118, v240, v241
    v_pk_fma_f16 v254, v254, s61, s61
    v_mfma_f32_16x16x32_bf16 v[224:227], v[200:203], v[40:43], v[224:227]
    v_rcp_f16_sdwa v255, v254 dst_sel:WORD_0 dst_unused:UNUSED_PAD src0_sel:WORD_0
    v_mfma_f32_16x16x32_bf16 v[224:227], v[204:207], v[44:47], v[224:227]
    ds_write2st64_b64 v2, v[112:113], v[114:115] offset0:34 offset1:35
    v_fma_mix_f32 v242, v242, v255, 0 op_sel_hi:[0,1,0]
    v_mfma_f32_16x16x32_bf16 v[224:227], v[208:211], v[48:51], v[224:227]
    v_rcp_f16_sdwa v254, v254 dst_sel:WORD_0 dst_unused:UNUSED_PAD src0_sel:WORD_1
    v_mfma_f32_16x16x32_bf16 v[224:227], v[212:215], v[52:55], v[224:227]
    v_fma_mix_f32 v243, v243, v254, 0 op_sel_hi:[0,1,0]
    v_cvt_pk_bf16_f32 v119, v242, v243
    v_mfma_f32_16x16x32_bf16 v[224:227], v[216:219], v[56:59], v[224:227]
    v_cvt_pk_f16_f32 v248, v220, v221
    v_pk_fma_f16 v249, v248, v248, s60
    v_mfma_f32_16x16x32_bf16 v[228:231], v[196:199], v[60:63], 0
    v_pk_mul_f16 v249, v248, v249 neg_lo:[1,0] neg_hi:[1,0]
    v_cvt_pk_f16_f32 v250, v222, v223
    v_mfma_f32_16x16x32_bf16 v[228:231], v[200:203], v[64:67], v[228:231]
    v_exp_f16_sdwa v248, v249 dst_sel:WORD_0 dst_unused:UNUSED_PAD src0_sel:WORD_0
    v_mfma_f32_16x16x32_bf16 v[228:231], v[204:207], v[68:71], v[228:231]
    v_exp_f16_sdwa v248, v249 dst_sel:WORD_1 dst_unused:UNUSED_PRESERVE src0_sel:WORD_1
    v_mfma_f32_16x16x32_bf16 v[228:231], v[208:211], v[72:75], v[228:231]
    v_pk_fma_f16 v248, v248, s61, s61
    v_pk_fma_f16 v251, v250, v250, s60
    v_mfma_f32_16x16x32_bf16 v[228:231], v[212:215], v[76:79], v[228:231]
    ds_write2st64_b64 v2, v[116:117], v[118:119] offset0:42 offset1:43
    v_pk_mul_f16 v251, v250, v251 neg_lo:[1,0] neg_hi:[1,0]
    v_mfma_f32_16x16x32_bf16 v[228:231], v[216:219], v[80:83], v[228:231]
    v_rcp_f16_sdwa v249, v248 dst_sel:WORD_0 dst_unused:UNUSED_PAD src0_sel:WORD_0
    v_mfma_f32_16x16x32_bf16 v[232:235], v[196:199], v[84:87], 0
    v_rcp_f16_sdwa v248, v248 dst_sel:WORD_0 dst_unused:UNUSED_PAD src0_sel:WORD_1
    v_mfma_f32_16x16x32_bf16 v[232:235], v[200:203], v[88:91], v[232:235]
    v_exp_f16_sdwa v250, v251 dst_sel:WORD_0 dst_unused:UNUSED_PAD src0_sel:WORD_0
    v_mfma_f32_16x16x32_bf16 v[232:235], v[204:207], v[92:95], v[232:235]
    v_exp_f16_sdwa v250, v251 dst_sel:WORD_1 dst_unused:UNUSED_PRESERVE src0_sel:WORD_1
    v_mfma_f32_16x16x32_bf16 v[232:235], v[208:211], v[96:99], v[232:235]
    v_fma_mix_f32 v220, v220, v249, 0 op_sel_hi:[0,1,0]
    v_fma_mix_f32 v221, v221, v248, 0 op_sel_hi:[0,1,0]
    v_mfma_f32_16x16x32_bf16 v[232:235], v[212:215], v[100:103], v[232:235]
    v_cvt_pk_bf16_f32 v108, v220, v221
    v_pk_fma_f16 v250, v250, s61, s61
    v_mfma_f32_16x16x32_bf16 v[232:235], v[216:219], v[104:107], v[232:235]
    v_rcp_f16_sdwa v251, v250 dst_sel:WORD_0 dst_unused:UNUSED_PAD src0_sel:WORD_0
    s_waitcnt lgkmcnt(0)
    s_barrier
    v_mfma_f32_16x16x32_bf16 v[236:239], v[196:199], v[124:127], 0
    v_rcp_f16_sdwa v250, v250 dst_sel:WORD_0 dst_unused:UNUSED_PAD src0_sel:WORD_1
    v_mfma_f32_16x16x32_bf16 v[240:243], v[196:199], v[148:151], 0
    v_fma_mix_f32 v222, v222, v251, 0 op_sel_hi:[0,1,0]
    v_fma_mix_f32 v223, v223, v250, 0 op_sel_hi:[0,1,0]
    v_mfma_f32_16x16x32_bf16 v[236:239], v[200:203], v[128:131], v[236:239]
    ds_read_b64_tr_b16 v[196:197], v1 offset:12288
    v_cvt_pk_bf16_f32 v109, v222, v223
    v_mfma_f32_16x16x32_bf16 v[240:243], v[200:203], v[152:155], v[240:243]
    ds_read_b64_tr_b16 v[198:199], v1 offset:12544
    v_cvt_pk_f16_f32 v252, v224, v225
    v_mfma_f32_16x16x32_bf16 v[236:239], v[204:207], v[132:135], v[236:239]
    ds_read_b64_tr_b16 v[200:201], v1 offset:14336
    v_pk_fma_f16 v253, v252, v252, s60
    v_mfma_f32_16x16x32_bf16 v[240:243], v[204:207], v[156:159], v[240:243]
    ds_read_b64_tr_b16 v[202:203], v1 offset:14592
    v_pk_mul_f16 v253, v252, v253 neg_lo:[1,0] neg_hi:[1,0]
    v_mfma_f32_16x16x32_bf16 v[236:239], v[208:211], v[136:139], v[236:239]
    ds_read_b64_tr_b16 v[204:205], v1 offset:16384
    v_cvt_pk_f16_f32 v254, v226, v227
    v_mfma_f32_16x16x32_bf16 v[240:243], v[208:211], v[160:163], v[240:243]
    ds_read_b64_tr_b16 v[206:207], v1 offset:16640
    v_pk_fma_f16 v255, v254, v254, s60
    v_mfma_f32_16x16x32_bf16 v[236:239], v[212:215], v[140:143], v[236:239]
    ds_read_b64_tr_b16 v[208:209], v1 offset:18432
    v_pk_mul_f16 v255, v254, v255 neg_lo:[1,0] neg_hi:[1,0]
    v_mfma_f32_16x16x32_bf16 v[240:243], v[212:215], v[164:167], v[240:243]
    ds_read_b64_tr_b16 v[210:211], v1 offset:18688
    v_cvt_pk_f16_f32 v248, v228, v229
    v_mfma_f32_16x16x32_bf16 v[236:239], v[216:219], v[144:147], v[236:239]
    ds_read_b64_tr_b16 v[212:213], v1 offset:20480
    v_pk_fma_f16 v249, v248, v248, s60
    v_mfma_f32_16x16x32_bf16 v[240:243], v[216:219], v[168:171], v[240:243]
    ds_read_b64_tr_b16 v[214:215], v1 offset:20736
    ds_read_b64_tr_b16 v[216:217], v1 offset:22528
    ds_read_b64_tr_b16 v[218:219], v1 offset:22784
    v_exp_f16_sdwa v252, v253 dst_sel:WORD_0 dst_unused:UNUSED_PAD src0_sel:WORD_0
    v_exp_f16_sdwa v254, v255 dst_sel:WORD_0 dst_unused:UNUSED_PAD src0_sel:WORD_0
    v_exp_f16_sdwa v252, v253 dst_sel:WORD_1 dst_unused:UNUSED_PRESERVE src0_sel:WORD_1
    v_exp_f16_sdwa v254, v255 dst_sel:WORD_1 dst_unused:UNUSED_PRESERVE src0_sel:WORD_1
    v_pk_fma_f16 v252, v252, s61, s61
    v_rcp_f16_sdwa v253, v252 dst_sel:WORD_0 dst_unused:UNUSED_PAD src0_sel:WORD_0
    v_pk_fma_f16 v254, v254, s61, s61
    v_rcp_f16_sdwa v252, v252 dst_sel:WORD_0 dst_unused:UNUSED_PAD src0_sel:WORD_1
    v_fma_mix_f32 v224, v224, v253, 0 op_sel_hi:[0,1,0]
    v_fma_mix_f32 v225, v225, v252, 0 op_sel_hi:[0,1,0]
    v_cvt_pk_bf16_f32 v110, v224, v225
    v_rcp_f16_sdwa v255, v254 dst_sel:WORD_0 dst_unused:UNUSED_PAD src0_sel:WORD_0
    v_pk_mul_f16 v249, v248, v249 neg_lo:[1,0] neg_hi:[1,0]
    v_rcp_f16_sdwa v254, v254 dst_sel:WORD_0 dst_unused:UNUSED_PAD src0_sel:WORD_1
    v_fma_mix_f32 v226, v226, v255, 0 op_sel_hi:[0,1,0]
    v_fma_mix_f32 v227, v227, v254, 0 op_sel_hi:[0,1,0]
    v_cvt_pk_bf16_f32 v111, v226, v227
    v_exp_f16_sdwa v248, v249 dst_sel:WORD_0 dst_unused:UNUSED_PAD src0_sel:WORD_0
    v_cvt_pk_f16_f32 v250, v230, v231
    v_exp_f16_sdwa v248, v249 dst_sel:WORD_1 dst_unused:UNUSED_PRESERVE src0_sel:WORD_1
    v_pk_fma_f16 v251, v250, v250, s60
    v_pk_fma_f16 v248, v248, s61, s61
    v_rcp_f16_sdwa v249, v248 dst_sel:WORD_0 dst_unused:UNUSED_PAD src0_sel:WORD_0
    v_pk_mul_f16 v251, v250, v251 neg_lo:[1,0] neg_hi:[1,0]
    v_rcp_f16_sdwa v248, v248 dst_sel:WORD_0 dst_unused:UNUSED_PAD src0_sel:WORD_1
    v_fma_mix_f32 v228, v228, v249, 0 op_sel_hi:[0,1,0]
    v_fma_mix_f32 v229, v229, v248, 0 op_sel_hi:[0,1,0]
    v_cvt_pk_bf16_f32 v112, v228, v229
    v_exp_f16_sdwa v250, v251 dst_sel:WORD_0 dst_unused:UNUSED_PAD src0_sel:WORD_0
    v_cvt_pk_f16_f32 v252, v232, v233
    v_exp_f16_sdwa v250, v251 dst_sel:WORD_1 dst_unused:UNUSED_PRESERVE src0_sel:WORD_1
    v_pk_fma_f16 v253, v252, v252, s60
    v_pk_fma_f16 v250, v250, s61, s61
    v_rcp_f16_sdwa v251, v250 dst_sel:WORD_0 dst_unused:UNUSED_PAD src0_sel:WORD_0
    v_pk_mul_f16 v253, v252, v253 neg_lo:[1,0] neg_hi:[1,0]
    v_rcp_f16_sdwa v250, v250 dst_sel:WORD_0 dst_unused:UNUSED_PAD src0_sel:WORD_1
    v_fma_mix_f32 v230, v230, v251, 0 op_sel_hi:[0,1,0]
    v_fma_mix_f32 v231, v231, v250, 0 op_sel_hi:[0,1,0]
    v_cvt_pk_bf16_f32 v113, v230, v231
    v_exp_f16_sdwa v252, v253 dst_sel:WORD_0 dst_unused:UNUSED_PAD src0_sel:WORD_0
    v_cvt_pk_f16_f32 v254, v234, v235
    v_exp_f16_sdwa v252, v253 dst_sel:WORD_1 dst_unused:UNUSED_PRESERVE src0_sel:WORD_1
    v_pk_fma_f16 v255, v254, v254, s60
    v_pk_fma_f16 v252, v252, s61, s61
    v_rcp_f16_sdwa v253, v252 dst_sel:WORD_0 dst_unused:UNUSED_PAD src0_sel:WORD_0
    v_pk_mul_f16 v255, v254, v255 neg_lo:[1,0] neg_hi:[1,0]
    v_rcp_f16_sdwa v252, v252 dst_sel:WORD_0 dst_unused:UNUSED_PAD src0_sel:WORD_1
    v_fma_mix_f32 v232, v232, v253, 0 op_sel_hi:[0,1,0]
    v_fma_mix_f32 v233, v233, v252, 0 op_sel_hi:[0,1,0]
    v_cvt_pk_bf16_f32 v114, v232, v233
    v_exp_f16_sdwa v254, v255 dst_sel:WORD_0 dst_unused:UNUSED_PAD src0_sel:WORD_0
    v_cvt_pk_f16_f32 v248, v236, v237
    v_exp_f16_sdwa v254, v255 dst_sel:WORD_1 dst_unused:UNUSED_PRESERVE src0_sel:WORD_1
    v_pk_fma_f16 v249, v248, v248, s60
    v_pk_fma_f16 v254, v254, s61, s61
    v_rcp_f16_sdwa v255, v254 dst_sel:WORD_0 dst_unused:UNUSED_PAD src0_sel:WORD_0
    v_pk_mul_f16 v249, v248, v249 neg_lo:[1,0] neg_hi:[1,0]
    v_rcp_f16_sdwa v254, v254 dst_sel:WORD_0 dst_unused:UNUSED_PAD src0_sel:WORD_1
    v_fma_mix_f32 v234, v234, v255, 0 op_sel_hi:[0,1,0]
    v_fma_mix_f32 v235, v235, v254, 0 op_sel_hi:[0,1,0]
    v_cvt_pk_bf16_f32 v115, v234, v235
    v_exp_f16_sdwa v248, v249 dst_sel:WORD_0 dst_unused:UNUSED_PAD src0_sel:WORD_0
    v_cvt_pk_f16_f32 v250, v238, v239
    v_exp_f16_sdwa v248, v249 dst_sel:WORD_1 dst_unused:UNUSED_PRESERVE src0_sel:WORD_1
    v_pk_fma_f16 v251, v250, v250, s60
    v_pk_fma_f16 v248, v248, s61, s61
    v_rcp_f16_sdwa v249, v248 dst_sel:WORD_0 dst_unused:UNUSED_PAD src0_sel:WORD_0
    v_pk_mul_f16 v251, v250, v251 neg_lo:[1,0] neg_hi:[1,0]
    v_rcp_f16_sdwa v248, v248 dst_sel:WORD_0 dst_unused:UNUSED_PAD src0_sel:WORD_1
    v_fma_mix_f32 v236, v236, v249, 0 op_sel_hi:[0,1,0]
    v_fma_mix_f32 v237, v237, v248, 0 op_sel_hi:[0,1,0]
    v_cvt_pk_bf16_f32 v116, v236, v237
    v_exp_f16_sdwa v250, v251 dst_sel:WORD_0 dst_unused:UNUSED_PAD src0_sel:WORD_0
    v_cvt_pk_f16_f32 v252, v240, v241
    v_exp_f16_sdwa v250, v251 dst_sel:WORD_1 dst_unused:UNUSED_PRESERVE src0_sel:WORD_1
    v_pk_fma_f16 v253, v252, v252, s60
    v_pk_fma_f16 v250, v250, s61, s61
    v_rcp_f16_sdwa v251, v250 dst_sel:WORD_0 dst_unused:UNUSED_PAD src0_sel:WORD_0
    v_pk_mul_f16 v253, v252, v253 neg_lo:[1,0] neg_hi:[1,0]
    v_rcp_f16_sdwa v250, v250 dst_sel:WORD_0 dst_unused:UNUSED_PAD src0_sel:WORD_1
    v_fma_mix_f32 v238, v238, v251, 0 op_sel_hi:[0,1,0]
    v_fma_mix_f32 v239, v239, v250, 0 op_sel_hi:[0,1,0]
    v_cvt_pk_bf16_f32 v117, v238, v239
    v_exp_f16_sdwa v252, v253 dst_sel:WORD_0 dst_unused:UNUSED_PAD src0_sel:WORD_0
    v_cvt_pk_f16_f32 v254, v242, v243
    v_exp_f16_sdwa v252, v253 dst_sel:WORD_1 dst_unused:UNUSED_PRESERVE src0_sel:WORD_1
    v_pk_fma_f16 v255, v254, v254, s60
    v_pk_fma_f16 v252, v252, s61, s61
    s_waitcnt lgkmcnt(0)
    v_mfma_f32_16x16x32_bf16 v[220:223], v[196:199], v[12:15], 0
    ds_write2st64_b64 v2, v[108:109], v[110:111] offset0:61 offset1:62
    v_pk_mul_f16 v255, v254, v255 neg_lo:[1,0] neg_hi:[1,0]
    v_mfma_f32_16x16x32_bf16 v[220:223], v[200:203], v[16:19], v[220:223]
    v_rcp_f16_sdwa v253, v252 dst_sel:WORD_0 dst_unused:UNUSED_PAD src0_sel:WORD_0
    v_mfma_f32_16x16x32_bf16 v[220:223], v[204:207], v[20:23], v[220:223]
    v_rcp_f16_sdwa v252, v252 dst_sel:WORD_0 dst_unused:UNUSED_PAD src0_sel:WORD_1
    v_mfma_f32_16x16x32_bf16 v[220:223], v[208:211], v[24:27], v[220:223]
    v_exp_f16_sdwa v254, v255 dst_sel:WORD_0 dst_unused:UNUSED_PAD src0_sel:WORD_0
    v_mfma_f32_16x16x32_bf16 v[220:223], v[212:215], v[28:31], v[220:223]
    v_exp_f16_sdwa v254, v255 dst_sel:WORD_1 dst_unused:UNUSED_PRESERVE src0_sel:WORD_1
    v_mfma_f32_16x16x32_bf16 v[220:223], v[216:219], v[32:35], v[220:223]
    v_fma_mix_f32 v240, v240, v253, 0 op_sel_hi:[0,1,0]
    v_fma_mix_f32 v241, v241, v252, 0 op_sel_hi:[0,1,0]
    v_mfma_f32_16x16x32_bf16 v[224:227], v[196:199], v[36:39], 0
    v_cvt_pk_bf16_f32 v118, v240, v241
    v_pk_fma_f16 v254, v254, s61, s61
    v_mfma_f32_16x16x32_bf16 v[224:227], v[200:203], v[40:43], v[224:227]
    v_rcp_f16_sdwa v255, v254 dst_sel:WORD_0 dst_unused:UNUSED_PAD src0_sel:WORD_0
    v_mfma_f32_16x16x32_bf16 v[224:227], v[204:207], v[44:47], v[224:227]
    ds_write2st64_b64 v2, v[112:113], v[114:115] offset0:69 offset1:70
    v_fma_mix_f32 v242, v242, v255, 0 op_sel_hi:[0,1,0]
    v_mfma_f32_16x16x32_bf16 v[224:227], v[208:211], v[48:51], v[224:227]
    v_rcp_f16_sdwa v254, v254 dst_sel:WORD_0 dst_unused:UNUSED_PAD src0_sel:WORD_1
    v_mfma_f32_16x16x32_bf16 v[224:227], v[212:215], v[52:55], v[224:227]
    v_fma_mix_f32 v243, v243, v254, 0 op_sel_hi:[0,1,0]
    v_cvt_pk_bf16_f32 v119, v242, v243
    v_mfma_f32_16x16x32_bf16 v[224:227], v[216:219], v[56:59], v[224:227]
    v_cvt_pk_f16_f32 v248, v220, v221
    v_pk_fma_f16 v249, v248, v248, s60
    v_mfma_f32_16x16x32_bf16 v[228:231], v[196:199], v[60:63], 0
    v_pk_mul_f16 v249, v248, v249 neg_lo:[1,0] neg_hi:[1,0]
    v_cvt_pk_f16_f32 v250, v222, v223
    v_mfma_f32_16x16x32_bf16 v[228:231], v[200:203], v[64:67], v[228:231]
    v_exp_f16_sdwa v248, v249 dst_sel:WORD_0 dst_unused:UNUSED_PAD src0_sel:WORD_0
    v_mfma_f32_16x16x32_bf16 v[228:231], v[204:207], v[68:71], v[228:231]
    v_exp_f16_sdwa v248, v249 dst_sel:WORD_1 dst_unused:UNUSED_PRESERVE src0_sel:WORD_1
    v_mfma_f32_16x16x32_bf16 v[228:231], v[208:211], v[72:75], v[228:231]
    v_pk_fma_f16 v248, v248, s61, s61
    v_pk_fma_f16 v251, v250, v250, s60
    v_mfma_f32_16x16x32_bf16 v[228:231], v[212:215], v[76:79], v[228:231]
    ds_write2st64_b64 v2, v[116:117], v[118:119] offset0:77 offset1:78
    v_pk_mul_f16 v251, v250, v251 neg_lo:[1,0] neg_hi:[1,0]
    v_mfma_f32_16x16x32_bf16 v[228:231], v[216:219], v[80:83], v[228:231]
    v_rcp_f16_sdwa v249, v248 dst_sel:WORD_0 dst_unused:UNUSED_PAD src0_sel:WORD_0
    v_mfma_f32_16x16x32_bf16 v[232:235], v[196:199], v[84:87], 0
    v_rcp_f16_sdwa v248, v248 dst_sel:WORD_0 dst_unused:UNUSED_PAD src0_sel:WORD_1
    v_mfma_f32_16x16x32_bf16 v[232:235], v[200:203], v[88:91], v[232:235]
    v_exp_f16_sdwa v250, v251 dst_sel:WORD_0 dst_unused:UNUSED_PAD src0_sel:WORD_0
    v_mfma_f32_16x16x32_bf16 v[232:235], v[204:207], v[92:95], v[232:235]
    v_exp_f16_sdwa v250, v251 dst_sel:WORD_1 dst_unused:UNUSED_PRESERVE src0_sel:WORD_1
    v_mfma_f32_16x16x32_bf16 v[232:235], v[208:211], v[96:99], v[232:235]
    v_fma_mix_f32 v220, v220, v249, 0 op_sel_hi:[0,1,0]
    v_fma_mix_f32 v221, v221, v248, 0 op_sel_hi:[0,1,0]
    v_mfma_f32_16x16x32_bf16 v[232:235], v[212:215], v[100:103], v[232:235]
    v_cvt_pk_bf16_f32 v108, v220, v221
    v_pk_fma_f16 v250, v250, s61, s61
    v_mfma_f32_16x16x32_bf16 v[232:235], v[216:219], v[104:107], v[232:235]
    v_rcp_f16_sdwa v251, v250 dst_sel:WORD_0 dst_unused:UNUSED_PAD src0_sel:WORD_0
    s_waitcnt lgkmcnt(0)
    s_barrier
    v_mfma_f32_16x16x32_bf16 v[236:239], v[196:199], v[124:127], 0
    v_rcp_f16_sdwa v250, v250 dst_sel:WORD_0 dst_unused:UNUSED_PAD src0_sel:WORD_1
    v_mfma_f32_16x16x32_bf16 v[240:243], v[196:199], v[148:151], 0
    v_fma_mix_f32 v222, v222, v251, 0 op_sel_hi:[0,1,0]
    v_fma_mix_f32 v223, v223, v250, 0 op_sel_hi:[0,1,0]
    v_mfma_f32_16x16x32_bf16 v[236:239], v[200:203], v[128:131], v[236:239]
    ds_read_b64_tr_b16 v[196:197], v1 offset:24576
    v_cvt_pk_bf16_f32 v109, v222, v223
    v_mfma_f32_16x16x32_bf16 v[240:243], v[200:203], v[152:155], v[240:243]
    ds_read_b64_tr_b16 v[198:199], v1 offset:24832
    v_cvt_pk_f16_f32 v252, v224, v225
    v_mfma_f32_16x16x32_bf16 v[236:239], v[204:207], v[132:135], v[236:239]
    ds_read_b64_tr_b16 v[200:201], v1 offset:26624
    v_pk_fma_f16 v253, v252, v252, s60
    v_mfma_f32_16x16x32_bf16 v[240:243], v[204:207], v[156:159], v[240:243]
    ds_read_b64_tr_b16 v[202:203], v1 offset:26880
    v_pk_mul_f16 v253, v252, v253 neg_lo:[1,0] neg_hi:[1,0]
    v_mfma_f32_16x16x32_bf16 v[236:239], v[208:211], v[136:139], v[236:239]
    ds_read_b64_tr_b16 v[204:205], v1 offset:28672
    v_cvt_pk_f16_f32 v254, v226, v227
    v_mfma_f32_16x16x32_bf16 v[240:243], v[208:211], v[160:163], v[240:243]
    ds_read_b64_tr_b16 v[206:207], v1 offset:28928
    v_pk_fma_f16 v255, v254, v254, s60
    v_mfma_f32_16x16x32_bf16 v[236:239], v[212:215], v[140:143], v[236:239]
    ds_read_b64_tr_b16 v[208:209], v1 offset:30720
    v_pk_mul_f16 v255, v254, v255 neg_lo:[1,0] neg_hi:[1,0]
    v_mfma_f32_16x16x32_bf16 v[240:243], v[212:215], v[164:167], v[240:243]
    ds_read_b64_tr_b16 v[210:211], v1 offset:30976
    v_cvt_pk_f16_f32 v248, v228, v229
    v_mfma_f32_16x16x32_bf16 v[236:239], v[216:219], v[144:147], v[236:239]
    ds_read_b64_tr_b16 v[212:213], v1 offset:32768
    v_pk_fma_f16 v249, v248, v248, s60
    v_mfma_f32_16x16x32_bf16 v[240:243], v[216:219], v[168:171], v[240:243]
    ds_read_b64_tr_b16 v[214:215], v1 offset:33024
    ds_read_b64_tr_b16 v[216:217], v1 offset:34816
    ds_read_b64_tr_b16 v[218:219], v1 offset:35072
    v_exp_f16_sdwa v252, v253 dst_sel:WORD_0 dst_unused:UNUSED_PAD src0_sel:WORD_0
    v_exp_f16_sdwa v254, v255 dst_sel:WORD_0 dst_unused:UNUSED_PAD src0_sel:WORD_0
    v_exp_f16_sdwa v252, v253 dst_sel:WORD_1 dst_unused:UNUSED_PRESERVE src0_sel:WORD_1
    v_exp_f16_sdwa v254, v255 dst_sel:WORD_1 dst_unused:UNUSED_PRESERVE src0_sel:WORD_1
    v_pk_fma_f16 v252, v252, s61, s61
    v_rcp_f16_sdwa v253, v252 dst_sel:WORD_0 dst_unused:UNUSED_PAD src0_sel:WORD_0
    v_pk_fma_f16 v254, v254, s61, s61
    v_rcp_f16_sdwa v252, v252 dst_sel:WORD_0 dst_unused:UNUSED_PAD src0_sel:WORD_1
    v_fma_mix_f32 v224, v224, v253, 0 op_sel_hi:[0,1,0]
    v_fma_mix_f32 v225, v225, v252, 0 op_sel_hi:[0,1,0]
    v_cvt_pk_bf16_f32 v110, v224, v225
    v_rcp_f16_sdwa v255, v254 dst_sel:WORD_0 dst_unused:UNUSED_PAD src0_sel:WORD_0
    v_pk_mul_f16 v249, v248, v249 neg_lo:[1,0] neg_hi:[1,0]
    v_rcp_f16_sdwa v254, v254 dst_sel:WORD_0 dst_unused:UNUSED_PAD src0_sel:WORD_1
    v_fma_mix_f32 v226, v226, v255, 0 op_sel_hi:[0,1,0]
    v_fma_mix_f32 v227, v227, v254, 0 op_sel_hi:[0,1,0]
    v_cvt_pk_bf16_f32 v111, v226, v227
    v_exp_f16_sdwa v248, v249 dst_sel:WORD_0 dst_unused:UNUSED_PAD src0_sel:WORD_0
    v_cvt_pk_f16_f32 v250, v230, v231
    v_exp_f16_sdwa v248, v249 dst_sel:WORD_1 dst_unused:UNUSED_PRESERVE src0_sel:WORD_1
    v_pk_fma_f16 v251, v250, v250, s60
    v_pk_fma_f16 v248, v248, s61, s61
    v_rcp_f16_sdwa v249, v248 dst_sel:WORD_0 dst_unused:UNUSED_PAD src0_sel:WORD_0
    v_pk_mul_f16 v251, v250, v251 neg_lo:[1,0] neg_hi:[1,0]
    v_rcp_f16_sdwa v248, v248 dst_sel:WORD_0 dst_unused:UNUSED_PAD src0_sel:WORD_1
    v_fma_mix_f32 v228, v228, v249, 0 op_sel_hi:[0,1,0]
    v_fma_mix_f32 v229, v229, v248, 0 op_sel_hi:[0,1,0]
    v_cvt_pk_bf16_f32 v112, v228, v229
    v_exp_f16_sdwa v250, v251 dst_sel:WORD_0 dst_unused:UNUSED_PAD src0_sel:WORD_0
    v_cvt_pk_f16_f32 v252, v232, v233
    v_exp_f16_sdwa v250, v251 dst_sel:WORD_1 dst_unused:UNUSED_PRESERVE src0_sel:WORD_1
    v_pk_fma_f16 v253, v252, v252, s60
    v_pk_fma_f16 v250, v250, s61, s61
    v_rcp_f16_sdwa v251, v250 dst_sel:WORD_0 dst_unused:UNUSED_PAD src0_sel:WORD_0
    v_pk_mul_f16 v253, v252, v253 neg_lo:[1,0] neg_hi:[1,0]
    v_rcp_f16_sdwa v250, v250 dst_sel:WORD_0 dst_unused:UNUSED_PAD src0_sel:WORD_1
    v_fma_mix_f32 v230, v230, v251, 0 op_sel_hi:[0,1,0]
    v_fma_mix_f32 v231, v231, v250, 0 op_sel_hi:[0,1,0]
    v_cvt_pk_bf16_f32 v113, v230, v231
    v_exp_f16_sdwa v252, v253 dst_sel:WORD_0 dst_unused:UNUSED_PAD src0_sel:WORD_0
    v_cvt_pk_f16_f32 v254, v234, v235
    v_exp_f16_sdwa v252, v253 dst_sel:WORD_1 dst_unused:UNUSED_PRESERVE src0_sel:WORD_1
    v_pk_fma_f16 v255, v254, v254, s60
    v_pk_fma_f16 v252, v252, s61, s61
    v_rcp_f16_sdwa v253, v252 dst_sel:WORD_0 dst_unused:UNUSED_PAD src0_sel:WORD_0
    v_pk_mul_f16 v255, v254, v255 neg_lo:[1,0] neg_hi:[1,0]
    v_rcp_f16_sdwa v252, v252 dst_sel:WORD_0 dst_unused:UNUSED_PAD src0_sel:WORD_1
    v_fma_mix_f32 v232, v232, v253, 0 op_sel_hi:[0,1,0]
    v_fma_mix_f32 v233, v233, v252, 0 op_sel_hi:[0,1,0]
    v_cvt_pk_bf16_f32 v114, v232, v233
    v_exp_f16_sdwa v254, v255 dst_sel:WORD_0 dst_unused:UNUSED_PAD src0_sel:WORD_0
    v_cvt_pk_f16_f32 v248, v236, v237
    v_exp_f16_sdwa v254, v255 dst_sel:WORD_1 dst_unused:UNUSED_PRESERVE src0_sel:WORD_1
    v_pk_fma_f16 v249, v248, v248, s60
    v_pk_fma_f16 v254, v254, s61, s61
    v_rcp_f16_sdwa v255, v254 dst_sel:WORD_0 dst_unused:UNUSED_PAD src0_sel:WORD_0
    v_pk_mul_f16 v249, v248, v249 neg_lo:[1,0] neg_hi:[1,0]
    v_rcp_f16_sdwa v254, v254 dst_sel:WORD_0 dst_unused:UNUSED_PAD src0_sel:WORD_1
    v_fma_mix_f32 v234, v234, v255, 0 op_sel_hi:[0,1,0]
    v_fma_mix_f32 v235, v235, v254, 0 op_sel_hi:[0,1,0]
    v_cvt_pk_bf16_f32 v115, v234, v235
    v_exp_f16_sdwa v248, v249 dst_sel:WORD_0 dst_unused:UNUSED_PAD src0_sel:WORD_0
    v_cvt_pk_f16_f32 v250, v238, v239
    v_exp_f16_sdwa v248, v249 dst_sel:WORD_1 dst_unused:UNUSED_PRESERVE src0_sel:WORD_1
    v_pk_fma_f16 v251, v250, v250, s60
    v_pk_fma_f16 v248, v248, s61, s61
    v_rcp_f16_sdwa v249, v248 dst_sel:WORD_0 dst_unused:UNUSED_PAD src0_sel:WORD_0
    v_pk_mul_f16 v251, v250, v251 neg_lo:[1,0] neg_hi:[1,0]
    v_rcp_f16_sdwa v248, v248 dst_sel:WORD_0 dst_unused:UNUSED_PAD src0_sel:WORD_1
    v_fma_mix_f32 v236, v236, v249, 0 op_sel_hi:[0,1,0]
    v_fma_mix_f32 v237, v237, v248, 0 op_sel_hi:[0,1,0]
    v_cvt_pk_bf16_f32 v116, v236, v237
    v_exp_f16_sdwa v250, v251 dst_sel:WORD_0 dst_unused:UNUSED_PAD src0_sel:WORD_0
    v_cvt_pk_f16_f32 v252, v240, v241
    v_exp_f16_sdwa v250, v251 dst_sel:WORD_1 dst_unused:UNUSED_PRESERVE src0_sel:WORD_1
    v_pk_fma_f16 v253, v252, v252, s60
    v_pk_fma_f16 v250, v250, s61, s61
    v_rcp_f16_sdwa v251, v250 dst_sel:WORD_0 dst_unused:UNUSED_PAD src0_sel:WORD_0
    v_pk_mul_f16 v253, v252, v253 neg_lo:[1,0] neg_hi:[1,0]
    v_rcp_f16_sdwa v250, v250 dst_sel:WORD_0 dst_unused:UNUSED_PAD src0_sel:WORD_1
    v_fma_mix_f32 v238, v238, v251, 0 op_sel_hi:[0,1,0]
    v_fma_mix_f32 v239, v239, v250, 0 op_sel_hi:[0,1,0]
    v_cvt_pk_bf16_f32 v117, v238, v239
    v_exp_f16_sdwa v252, v253 dst_sel:WORD_0 dst_unused:UNUSED_PAD src0_sel:WORD_0
    v_cvt_pk_f16_f32 v254, v242, v243
    v_exp_f16_sdwa v252, v253 dst_sel:WORD_1 dst_unused:UNUSED_PRESERVE src0_sel:WORD_1
    v_pk_fma_f16 v255, v254, v254, s60
    v_pk_fma_f16 v252, v252, s61, s61
    s_waitcnt lgkmcnt(0)
    v_mfma_f32_16x16x32_bf16 v[220:223], v[196:199], v[12:15], 0
    ds_write2st64_b64 v2, v[108:109], v[110:111] offset0:0 offset1:1
    v_pk_mul_f16 v255, v254, v255 neg_lo:[1,0] neg_hi:[1,0]
    v_mfma_f32_16x16x32_bf16 v[220:223], v[200:203], v[16:19], v[220:223]
    v_rcp_f16_sdwa v253, v252 dst_sel:WORD_0 dst_unused:UNUSED_PAD src0_sel:WORD_0
    v_mfma_f32_16x16x32_bf16 v[220:223], v[204:207], v[20:23], v[220:223]
    v_rcp_f16_sdwa v252, v252 dst_sel:WORD_0 dst_unused:UNUSED_PAD src0_sel:WORD_1
    v_mfma_f32_16x16x32_bf16 v[220:223], v[208:211], v[24:27], v[220:223]
    v_exp_f16_sdwa v254, v255 dst_sel:WORD_0 dst_unused:UNUSED_PAD src0_sel:WORD_0
    v_mfma_f32_16x16x32_bf16 v[220:223], v[212:215], v[28:31], v[220:223]
    v_exp_f16_sdwa v254, v255 dst_sel:WORD_1 dst_unused:UNUSED_PRESERVE src0_sel:WORD_1
    v_mfma_f32_16x16x32_bf16 v[220:223], v[216:219], v[32:35], v[220:223]
    v_fma_mix_f32 v240, v240, v253, 0 op_sel_hi:[0,1,0]
    v_fma_mix_f32 v241, v241, v252, 0 op_sel_hi:[0,1,0]
    v_mfma_f32_16x16x32_bf16 v[224:227], v[196:199], v[36:39], 0
    v_cvt_pk_bf16_f32 v118, v240, v241
    v_pk_fma_f16 v254, v254, s61, s61
    v_mfma_f32_16x16x32_bf16 v[224:227], v[200:203], v[40:43], v[224:227]
    v_rcp_f16_sdwa v255, v254 dst_sel:WORD_0 dst_unused:UNUSED_PAD src0_sel:WORD_0
    v_mfma_f32_16x16x32_bf16 v[224:227], v[204:207], v[44:47], v[224:227]
    ds_write2st64_b64 v2, v[112:113], v[114:115] offset0:8 offset1:9
    v_fma_mix_f32 v242, v242, v255, 0 op_sel_hi:[0,1,0]
    v_mfma_f32_16x16x32_bf16 v[224:227], v[208:211], v[48:51], v[224:227]
    v_rcp_f16_sdwa v254, v254 dst_sel:WORD_0 dst_unused:UNUSED_PAD src0_sel:WORD_1
    v_mfma_f32_16x16x32_bf16 v[224:227], v[212:215], v[52:55], v[224:227]
    v_fma_mix_f32 v243, v243, v254, 0 op_sel_hi:[0,1,0]
    v_cvt_pk_bf16_f32 v119, v242, v243
    v_mfma_f32_16x16x32_bf16 v[224:227], v[216:219], v[56:59], v[224:227]
    v_cvt_pk_f16_f32 v248, v220, v221
    v_pk_fma_f16 v249, v248, v248, s60
    v_mfma_f32_16x16x32_bf16 v[228:231], v[196:199], v[60:63], 0
    v_pk_mul_f16 v249, v248, v249 neg_lo:[1,0] neg_hi:[1,0]
    v_cvt_pk_f16_f32 v250, v222, v223
    v_mfma_f32_16x16x32_bf16 v[228:231], v[200:203], v[64:67], v[228:231]
    v_exp_f16_sdwa v248, v249 dst_sel:WORD_0 dst_unused:UNUSED_PAD src0_sel:WORD_0
    v_mfma_f32_16x16x32_bf16 v[228:231], v[204:207], v[68:71], v[228:231]
    v_exp_f16_sdwa v248, v249 dst_sel:WORD_1 dst_unused:UNUSED_PRESERVE src0_sel:WORD_1
    v_mfma_f32_16x16x32_bf16 v[228:231], v[208:211], v[72:75], v[228:231]
    v_pk_fma_f16 v248, v248, s61, s61
    v_pk_fma_f16 v251, v250, v250, s60
    v_mfma_f32_16x16x32_bf16 v[228:231], v[212:215], v[76:79], v[228:231]
    ds_write2st64_b64 v2, v[116:117], v[118:119] offset0:16 offset1:17
    v_pk_mul_f16 v251, v250, v251 neg_lo:[1,0] neg_hi:[1,0]
    v_mfma_f32_16x16x32_bf16 v[228:231], v[216:219], v[80:83], v[228:231]
    v_rcp_f16_sdwa v249, v248 dst_sel:WORD_0 dst_unused:UNUSED_PAD src0_sel:WORD_0
    v_mfma_f32_16x16x32_bf16 v[232:235], v[196:199], v[84:87], 0
    v_rcp_f16_sdwa v248, v248 dst_sel:WORD_0 dst_unused:UNUSED_PAD src0_sel:WORD_1
    v_mfma_f32_16x16x32_bf16 v[232:235], v[200:203], v[88:91], v[232:235]
    v_exp_f16_sdwa v250, v251 dst_sel:WORD_0 dst_unused:UNUSED_PAD src0_sel:WORD_0
    v_mfma_f32_16x16x32_bf16 v[232:235], v[204:207], v[92:95], v[232:235]
    v_exp_f16_sdwa v250, v251 dst_sel:WORD_1 dst_unused:UNUSED_PRESERVE src0_sel:WORD_1
    v_mfma_f32_16x16x32_bf16 v[232:235], v[208:211], v[96:99], v[232:235]
    v_fma_mix_f32 v220, v220, v249, 0 op_sel_hi:[0,1,0]
    v_fma_mix_f32 v221, v221, v248, 0 op_sel_hi:[0,1,0]
    v_mfma_f32_16x16x32_bf16 v[232:235], v[212:215], v[100:103], v[232:235]
    v_cvt_pk_bf16_f32 v108, v220, v221
    v_pk_fma_f16 v250, v250, s61, s61
    v_mfma_f32_16x16x32_bf16 v[232:235], v[216:219], v[104:107], v[232:235]
    v_rcp_f16_sdwa v251, v250 dst_sel:WORD_0 dst_unused:UNUSED_PAD src0_sel:WORD_0
    s_waitcnt lgkmcnt(0)
    s_barrier
    v_mfma_f32_16x16x32_bf16 v[236:239], v[196:199], v[124:127], 0
    v_rcp_f16_sdwa v250, v250 dst_sel:WORD_0 dst_unused:UNUSED_PAD src0_sel:WORD_1
    v_mfma_f32_16x16x32_bf16 v[240:243], v[196:199], v[148:151], 0
    v_fma_mix_f32 v222, v222, v251, 0 op_sel_hi:[0,1,0]
    v_fma_mix_f32 v223, v223, v250, 0 op_sel_hi:[0,1,0]
    v_mfma_f32_16x16x32_bf16 v[236:239], v[200:203], v[128:131], v[236:239]
    ds_read_b64_tr_b16 v[196:197], v1 offset:0
    v_cvt_pk_bf16_f32 v109, v222, v223
    v_mfma_f32_16x16x32_bf16 v[240:243], v[200:203], v[152:155], v[240:243]
    ds_read_b64_tr_b16 v[198:199], v1 offset:256
    v_cvt_pk_f16_f32 v252, v224, v225
    v_mfma_f32_16x16x32_bf16 v[236:239], v[204:207], v[132:135], v[236:239]
    ds_read_b64_tr_b16 v[200:201], v1 offset:2048
    v_pk_fma_f16 v253, v252, v252, s60
    v_mfma_f32_16x16x32_bf16 v[240:243], v[204:207], v[156:159], v[240:243]
    ds_read_b64_tr_b16 v[202:203], v1 offset:2304
    v_pk_mul_f16 v253, v252, v253 neg_lo:[1,0] neg_hi:[1,0]
    v_mfma_f32_16x16x32_bf16 v[236:239], v[208:211], v[136:139], v[236:239]
    ds_read_b64_tr_b16 v[204:205], v1 offset:4096
    v_cvt_pk_f16_f32 v254, v226, v227
    v_mfma_f32_16x16x32_bf16 v[240:243], v[208:211], v[160:163], v[240:243]
    ds_read_b64_tr_b16 v[206:207], v1 offset:4352
    v_pk_fma_f16 v255, v254, v254, s60
    v_mfma_f32_16x16x32_bf16 v[236:239], v[212:215], v[140:143], v[236:239]
    ds_read_b64_tr_b16 v[208:209], v1 offset:6144
    v_pk_mul_f16 v255, v254, v255 neg_lo:[1,0] neg_hi:[1,0]
    v_mfma_f32_16x16x32_bf16 v[240:243], v[212:215], v[164:167], v[240:243]
    ds_read_b64_tr_b16 v[210:211], v1 offset:6400
    v_cvt_pk_f16_f32 v248, v228, v229
    v_mfma_f32_16x16x32_bf16 v[236:239], v[216:219], v[144:147], v[236:239]
    ds_read_b64_tr_b16 v[212:213], v1 offset:8192
    v_pk_fma_f16 v249, v248, v248, s60
    v_mfma_f32_16x16x32_bf16 v[240:243], v[216:219], v[168:171], v[240:243]
    ds_read_b64_tr_b16 v[214:215], v1 offset:8448
    ds_read_b64_tr_b16 v[216:217], v1 offset:10240
    ds_read_b64_tr_b16 v[218:219], v1 offset:10496
    v_exp_f16_sdwa v252, v253 dst_sel:WORD_0 dst_unused:UNUSED_PAD src0_sel:WORD_0
    v_exp_f16_sdwa v254, v255 dst_sel:WORD_0 dst_unused:UNUSED_PAD src0_sel:WORD_0
    v_exp_f16_sdwa v252, v253 dst_sel:WORD_1 dst_unused:UNUSED_PRESERVE src0_sel:WORD_1
    v_exp_f16_sdwa v254, v255 dst_sel:WORD_1 dst_unused:UNUSED_PRESERVE src0_sel:WORD_1
    v_pk_fma_f16 v252, v252, s61, s61
    v_rcp_f16_sdwa v253, v252 dst_sel:WORD_0 dst_unused:UNUSED_PAD src0_sel:WORD_0
    v_pk_fma_f16 v254, v254, s61, s61
    v_rcp_f16_sdwa v252, v252 dst_sel:WORD_0 dst_unused:UNUSED_PAD src0_sel:WORD_1
    v_fma_mix_f32 v224, v224, v253, 0 op_sel_hi:[0,1,0]
    v_fma_mix_f32 v225, v225, v252, 0 op_sel_hi:[0,1,0]
    v_cvt_pk_bf16_f32 v110, v224, v225
    v_rcp_f16_sdwa v255, v254 dst_sel:WORD_0 dst_unused:UNUSED_PAD src0_sel:WORD_0
    v_pk_mul_f16 v249, v248, v249 neg_lo:[1,0] neg_hi:[1,0]
    v_rcp_f16_sdwa v254, v254 dst_sel:WORD_0 dst_unused:UNUSED_PAD src0_sel:WORD_1
    v_fma_mix_f32 v226, v226, v255, 0 op_sel_hi:[0,1,0]
    v_fma_mix_f32 v227, v227, v254, 0 op_sel_hi:[0,1,0]
    v_cvt_pk_bf16_f32 v111, v226, v227
    v_exp_f16_sdwa v248, v249 dst_sel:WORD_0 dst_unused:UNUSED_PAD src0_sel:WORD_0
    v_cvt_pk_f16_f32 v250, v230, v231
    v_exp_f16_sdwa v248, v249 dst_sel:WORD_1 dst_unused:UNUSED_PRESERVE src0_sel:WORD_1
    v_pk_fma_f16 v251, v250, v250, s60
    v_pk_fma_f16 v248, v248, s61, s61
    v_rcp_f16_sdwa v249, v248 dst_sel:WORD_0 dst_unused:UNUSED_PAD src0_sel:WORD_0
    v_pk_mul_f16 v251, v250, v251 neg_lo:[1,0] neg_hi:[1,0]
    v_rcp_f16_sdwa v248, v248 dst_sel:WORD_0 dst_unused:UNUSED_PAD src0_sel:WORD_1
    v_fma_mix_f32 v228, v228, v249, 0 op_sel_hi:[0,1,0]
    v_fma_mix_f32 v229, v229, v248, 0 op_sel_hi:[0,1,0]
    v_cvt_pk_bf16_f32 v112, v228, v229
    v_exp_f16_sdwa v250, v251 dst_sel:WORD_0 dst_unused:UNUSED_PAD src0_sel:WORD_0
    v_cvt_pk_f16_f32 v252, v232, v233
    v_exp_f16_sdwa v250, v251 dst_sel:WORD_1 dst_unused:UNUSED_PRESERVE src0_sel:WORD_1
    v_pk_fma_f16 v253, v252, v252, s60
    v_pk_fma_f16 v250, v250, s61, s61
    v_rcp_f16_sdwa v251, v250 dst_sel:WORD_0 dst_unused:UNUSED_PAD src0_sel:WORD_0
    v_pk_mul_f16 v253, v252, v253 neg_lo:[1,0] neg_hi:[1,0]
    v_rcp_f16_sdwa v250, v250 dst_sel:WORD_0 dst_unused:UNUSED_PAD src0_sel:WORD_1
    v_fma_mix_f32 v230, v230, v251, 0 op_sel_hi:[0,1,0]
    v_fma_mix_f32 v231, v231, v250, 0 op_sel_hi:[0,1,0]
    v_cvt_pk_bf16_f32 v113, v230, v231
    v_exp_f16_sdwa v252, v253 dst_sel:WORD_0 dst_unused:UNUSED_PAD src0_sel:WORD_0
    v_cvt_pk_f16_f32 v254, v234, v235
    v_exp_f16_sdwa v252, v253 dst_sel:WORD_1 dst_unused:UNUSED_PRESERVE src0_sel:WORD_1
    v_pk_fma_f16 v255, v254, v254, s60
    v_pk_fma_f16 v252, v252, s61, s61
    v_rcp_f16_sdwa v253, v252 dst_sel:WORD_0 dst_unused:UNUSED_PAD src0_sel:WORD_0
    v_pk_mul_f16 v255, v254, v255 neg_lo:[1,0] neg_hi:[1,0]
    v_rcp_f16_sdwa v252, v252 dst_sel:WORD_0 dst_unused:UNUSED_PAD src0_sel:WORD_1
    v_fma_mix_f32 v232, v232, v253, 0 op_sel_hi:[0,1,0]
    v_fma_mix_f32 v233, v233, v252, 0 op_sel_hi:[0,1,0]
    v_cvt_pk_bf16_f32 v114, v232, v233
    v_exp_f16_sdwa v254, v255 dst_sel:WORD_0 dst_unused:UNUSED_PAD src0_sel:WORD_0
    v_cvt_pk_f16_f32 v248, v236, v237
    v_exp_f16_sdwa v254, v255 dst_sel:WORD_1 dst_unused:UNUSED_PRESERVE src0_sel:WORD_1
    v_pk_fma_f16 v249, v248, v248, s60
    v_pk_fma_f16 v254, v254, s61, s61
    v_rcp_f16_sdwa v255, v254 dst_sel:WORD_0 dst_unused:UNUSED_PAD src0_sel:WORD_0
    v_pk_mul_f16 v249, v248, v249 neg_lo:[1,0] neg_hi:[1,0]
    v_rcp_f16_sdwa v254, v254 dst_sel:WORD_0 dst_unused:UNUSED_PAD src0_sel:WORD_1
    v_fma_mix_f32 v234, v234, v255, 0 op_sel_hi:[0,1,0]
    v_fma_mix_f32 v235, v235, v254, 0 op_sel_hi:[0,1,0]
    v_cvt_pk_bf16_f32 v115, v234, v235
    v_exp_f16_sdwa v248, v249 dst_sel:WORD_0 dst_unused:UNUSED_PAD src0_sel:WORD_0
    v_cvt_pk_f16_f32 v250, v238, v239
    v_exp_f16_sdwa v248, v249 dst_sel:WORD_1 dst_unused:UNUSED_PRESERVE src0_sel:WORD_1
    v_pk_fma_f16 v251, v250, v250, s60
    v_pk_fma_f16 v248, v248, s61, s61
    v_rcp_f16_sdwa v249, v248 dst_sel:WORD_0 dst_unused:UNUSED_PAD src0_sel:WORD_0
    v_pk_mul_f16 v251, v250, v251 neg_lo:[1,0] neg_hi:[1,0]
    v_rcp_f16_sdwa v248, v248 dst_sel:WORD_0 dst_unused:UNUSED_PAD src0_sel:WORD_1
    v_fma_mix_f32 v236, v236, v249, 0 op_sel_hi:[0,1,0]
    v_fma_mix_f32 v237, v237, v248, 0 op_sel_hi:[0,1,0]
    v_cvt_pk_bf16_f32 v116, v236, v237
    v_exp_f16_sdwa v250, v251 dst_sel:WORD_0 dst_unused:UNUSED_PAD src0_sel:WORD_0
    v_cvt_pk_f16_f32 v252, v240, v241
    v_exp_f16_sdwa v250, v251 dst_sel:WORD_1 dst_unused:UNUSED_PRESERVE src0_sel:WORD_1
    v_pk_fma_f16 v253, v252, v252, s60
    v_pk_fma_f16 v250, v250, s61, s61
    v_rcp_f16_sdwa v251, v250 dst_sel:WORD_0 dst_unused:UNUSED_PAD src0_sel:WORD_0
    v_pk_mul_f16 v253, v252, v253 neg_lo:[1,0] neg_hi:[1,0]
    v_rcp_f16_sdwa v250, v250 dst_sel:WORD_0 dst_unused:UNUSED_PAD src0_sel:WORD_1
    v_fma_mix_f32 v238, v238, v251, 0 op_sel_hi:[0,1,0]
    v_fma_mix_f32 v239, v239, v250, 0 op_sel_hi:[0,1,0]
    v_cvt_pk_bf16_f32 v117, v238, v239
    v_exp_f16_sdwa v252, v253 dst_sel:WORD_0 dst_unused:UNUSED_PAD src0_sel:WORD_0
    v_cvt_pk_f16_f32 v254, v242, v243
    v_exp_f16_sdwa v252, v253 dst_sel:WORD_1 dst_unused:UNUSED_PRESERVE src0_sel:WORD_1
    v_pk_fma_f16 v255, v254, v254, s60
    v_pk_fma_f16 v252, v252, s61, s61
    s_waitcnt lgkmcnt(0)
    v_mfma_f32_16x16x32_bf16 v[220:223], v[196:199], v[12:15], 0
    ds_write2st64_b64 v2, v[108:109], v[110:111] offset0:26 offset1:27
    v_pk_mul_f16 v255, v254, v255 neg_lo:[1,0] neg_hi:[1,0]
    v_mfma_f32_16x16x32_bf16 v[220:223], v[200:203], v[16:19], v[220:223]
    v_rcp_f16_sdwa v253, v252 dst_sel:WORD_0 dst_unused:UNUSED_PAD src0_sel:WORD_0
    v_mfma_f32_16x16x32_bf16 v[220:223], v[204:207], v[20:23], v[220:223]
    v_rcp_f16_sdwa v252, v252 dst_sel:WORD_0 dst_unused:UNUSED_PAD src0_sel:WORD_1
    v_mfma_f32_16x16x32_bf16 v[220:223], v[208:211], v[24:27], v[220:223]
    v_exp_f16_sdwa v254, v255 dst_sel:WORD_0 dst_unused:UNUSED_PAD src0_sel:WORD_0
    v_mfma_f32_16x16x32_bf16 v[220:223], v[212:215], v[28:31], v[220:223]
    v_exp_f16_sdwa v254, v255 dst_sel:WORD_1 dst_unused:UNUSED_PRESERVE src0_sel:WORD_1
    v_mfma_f32_16x16x32_bf16 v[220:223], v[216:219], v[32:35], v[220:223]
    v_fma_mix_f32 v240, v240, v253, 0 op_sel_hi:[0,1,0]
    v_fma_mix_f32 v241, v241, v252, 0 op_sel_hi:[0,1,0]
    v_mfma_f32_16x16x32_bf16 v[224:227], v[196:199], v[36:39], 0
    v_cvt_pk_bf16_f32 v118, v240, v241
    v_pk_fma_f16 v254, v254, s61, s61
    v_mfma_f32_16x16x32_bf16 v[224:227], v[200:203], v[40:43], v[224:227]
    v_rcp_f16_sdwa v255, v254 dst_sel:WORD_0 dst_unused:UNUSED_PAD src0_sel:WORD_0
    v_mfma_f32_16x16x32_bf16 v[224:227], v[204:207], v[44:47], v[224:227]
    ds_write2st64_b64 v2, v[112:113], v[114:115] offset0:34 offset1:35
    v_fma_mix_f32 v242, v242, v255, 0 op_sel_hi:[0,1,0]
    v_mfma_f32_16x16x32_bf16 v[224:227], v[208:211], v[48:51], v[224:227]
    v_rcp_f16_sdwa v254, v254 dst_sel:WORD_0 dst_unused:UNUSED_PAD src0_sel:WORD_1
    v_mfma_f32_16x16x32_bf16 v[224:227], v[212:215], v[52:55], v[224:227]
    v_fma_mix_f32 v243, v243, v254, 0 op_sel_hi:[0,1,0]
    v_cvt_pk_bf16_f32 v119, v242, v243
    v_mfma_f32_16x16x32_bf16 v[224:227], v[216:219], v[56:59], v[224:227]
    v_cvt_pk_f16_f32 v248, v220, v221
    v_pk_fma_f16 v249, v248, v248, s60
    v_mfma_f32_16x16x32_bf16 v[228:231], v[196:199], v[60:63], 0
    v_pk_mul_f16 v249, v248, v249 neg_lo:[1,0] neg_hi:[1,0]
    v_cvt_pk_f16_f32 v250, v222, v223
    v_mfma_f32_16x16x32_bf16 v[228:231], v[200:203], v[64:67], v[228:231]
    v_exp_f16_sdwa v248, v249 dst_sel:WORD_0 dst_unused:UNUSED_PAD src0_sel:WORD_0
    v_mfma_f32_16x16x32_bf16 v[228:231], v[204:207], v[68:71], v[228:231]
    v_exp_f16_sdwa v248, v249 dst_sel:WORD_1 dst_unused:UNUSED_PRESERVE src0_sel:WORD_1
    v_mfma_f32_16x16x32_bf16 v[228:231], v[208:211], v[72:75], v[228:231]
    v_pk_fma_f16 v248, v248, s61, s61
    v_pk_fma_f16 v251, v250, v250, s60
    v_mfma_f32_16x16x32_bf16 v[228:231], v[212:215], v[76:79], v[228:231]
    ds_write2st64_b64 v2, v[116:117], v[118:119] offset0:42 offset1:43
    v_pk_mul_f16 v251, v250, v251 neg_lo:[1,0] neg_hi:[1,0]
    v_mfma_f32_16x16x32_bf16 v[228:231], v[216:219], v[80:83], v[228:231]
    v_rcp_f16_sdwa v249, v248 dst_sel:WORD_0 dst_unused:UNUSED_PAD src0_sel:WORD_0
    v_mfma_f32_16x16x32_bf16 v[232:235], v[196:199], v[84:87], 0
    v_rcp_f16_sdwa v248, v248 dst_sel:WORD_0 dst_unused:UNUSED_PAD src0_sel:WORD_1
    v_mfma_f32_16x16x32_bf16 v[232:235], v[200:203], v[88:91], v[232:235]
    v_exp_f16_sdwa v250, v251 dst_sel:WORD_0 dst_unused:UNUSED_PAD src0_sel:WORD_0
    v_mfma_f32_16x16x32_bf16 v[232:235], v[204:207], v[92:95], v[232:235]
    v_exp_f16_sdwa v250, v251 dst_sel:WORD_1 dst_unused:UNUSED_PRESERVE src0_sel:WORD_1
    v_mfma_f32_16x16x32_bf16 v[232:235], v[208:211], v[96:99], v[232:235]
    v_fma_mix_f32 v220, v220, v249, 0 op_sel_hi:[0,1,0]
    v_fma_mix_f32 v221, v221, v248, 0 op_sel_hi:[0,1,0]
    v_mfma_f32_16x16x32_bf16 v[232:235], v[212:215], v[100:103], v[232:235]
    v_cvt_pk_bf16_f32 v108, v220, v221
    v_pk_fma_f16 v250, v250, s61, s61
    v_mfma_f32_16x16x32_bf16 v[232:235], v[216:219], v[104:107], v[232:235]
    v_rcp_f16_sdwa v251, v250 dst_sel:WORD_0 dst_unused:UNUSED_PAD src0_sel:WORD_0
    s_waitcnt lgkmcnt(0)
    s_barrier
    v_mfma_f32_16x16x32_bf16 v[236:239], v[196:199], v[124:127], 0
    v_rcp_f16_sdwa v250, v250 dst_sel:WORD_0 dst_unused:UNUSED_PAD src0_sel:WORD_1
    v_mfma_f32_16x16x32_bf16 v[240:243], v[196:199], v[148:151], 0
    v_fma_mix_f32 v222, v222, v251, 0 op_sel_hi:[0,1,0]
    v_fma_mix_f32 v223, v223, v250, 0 op_sel_hi:[0,1,0]
    v_mfma_f32_16x16x32_bf16 v[236:239], v[200:203], v[128:131], v[236:239]
    ds_read_b64_tr_b16 v[196:197], v1 offset:12288
    v_cvt_pk_bf16_f32 v109, v222, v223
    v_mfma_f32_16x16x32_bf16 v[240:243], v[200:203], v[152:155], v[240:243]
    ds_read_b64_tr_b16 v[198:199], v1 offset:12544
    v_cvt_pk_f16_f32 v252, v224, v225
    v_mfma_f32_16x16x32_bf16 v[236:239], v[204:207], v[132:135], v[236:239]
    ds_read_b64_tr_b16 v[200:201], v1 offset:14336
    v_pk_fma_f16 v253, v252, v252, s60
    v_mfma_f32_16x16x32_bf16 v[240:243], v[204:207], v[156:159], v[240:243]
    ds_read_b64_tr_b16 v[202:203], v1 offset:14592
    v_pk_mul_f16 v253, v252, v253 neg_lo:[1,0] neg_hi:[1,0]
    v_mfma_f32_16x16x32_bf16 v[236:239], v[208:211], v[136:139], v[236:239]
    ds_read_b64_tr_b16 v[204:205], v1 offset:16384
    v_cvt_pk_f16_f32 v254, v226, v227
    v_mfma_f32_16x16x32_bf16 v[240:243], v[208:211], v[160:163], v[240:243]
    ds_read_b64_tr_b16 v[206:207], v1 offset:16640
    v_pk_fma_f16 v255, v254, v254, s60
    v_mfma_f32_16x16x32_bf16 v[236:239], v[212:215], v[140:143], v[236:239]
    ds_read_b64_tr_b16 v[208:209], v1 offset:18432
    v_pk_mul_f16 v255, v254, v255 neg_lo:[1,0] neg_hi:[1,0]
    v_mfma_f32_16x16x32_bf16 v[240:243], v[212:215], v[164:167], v[240:243]
    ds_read_b64_tr_b16 v[210:211], v1 offset:18688
    v_cvt_pk_f16_f32 v248, v228, v229
    v_mfma_f32_16x16x32_bf16 v[236:239], v[216:219], v[144:147], v[236:239]
    ds_read_b64_tr_b16 v[212:213], v1 offset:20480
    v_pk_fma_f16 v249, v248, v248, s60
    v_mfma_f32_16x16x32_bf16 v[240:243], v[216:219], v[168:171], v[240:243]
    ds_read_b64_tr_b16 v[214:215], v1 offset:20736
    ds_read_b64_tr_b16 v[216:217], v1 offset:22528
    ds_read_b64_tr_b16 v[218:219], v1 offset:22784
    v_exp_f16_sdwa v252, v253 dst_sel:WORD_0 dst_unused:UNUSED_PAD src0_sel:WORD_0
    v_exp_f16_sdwa v254, v255 dst_sel:WORD_0 dst_unused:UNUSED_PAD src0_sel:WORD_0
    v_exp_f16_sdwa v252, v253 dst_sel:WORD_1 dst_unused:UNUSED_PRESERVE src0_sel:WORD_1
    v_exp_f16_sdwa v254, v255 dst_sel:WORD_1 dst_unused:UNUSED_PRESERVE src0_sel:WORD_1
    v_pk_fma_f16 v252, v252, s61, s61
    v_rcp_f16_sdwa v253, v252 dst_sel:WORD_0 dst_unused:UNUSED_PAD src0_sel:WORD_0
    v_pk_fma_f16 v254, v254, s61, s61
    v_rcp_f16_sdwa v252, v252 dst_sel:WORD_0 dst_unused:UNUSED_PAD src0_sel:WORD_1
    v_fma_mix_f32 v224, v224, v253, 0 op_sel_hi:[0,1,0]
    v_fma_mix_f32 v225, v225, v252, 0 op_sel_hi:[0,1,0]
    v_cvt_pk_bf16_f32 v110, v224, v225
    v_rcp_f16_sdwa v255, v254 dst_sel:WORD_0 dst_unused:UNUSED_PAD src0_sel:WORD_0
    v_pk_mul_f16 v249, v248, v249 neg_lo:[1,0] neg_hi:[1,0]
    v_rcp_f16_sdwa v254, v254 dst_sel:WORD_0 dst_unused:UNUSED_PAD src0_sel:WORD_1
    v_fma_mix_f32 v226, v226, v255, 0 op_sel_hi:[0,1,0]
    v_fma_mix_f32 v227, v227, v254, 0 op_sel_hi:[0,1,0]
    v_cvt_pk_bf16_f32 v111, v226, v227
    v_exp_f16_sdwa v248, v249 dst_sel:WORD_0 dst_unused:UNUSED_PAD src0_sel:WORD_0
    v_cvt_pk_f16_f32 v250, v230, v231
    v_exp_f16_sdwa v248, v249 dst_sel:WORD_1 dst_unused:UNUSED_PRESERVE src0_sel:WORD_1
    v_pk_fma_f16 v251, v250, v250, s60
    v_pk_fma_f16 v248, v248, s61, s61
    v_rcp_f16_sdwa v249, v248 dst_sel:WORD_0 dst_unused:UNUSED_PAD src0_sel:WORD_0
    v_pk_mul_f16 v251, v250, v251 neg_lo:[1,0] neg_hi:[1,0]
    v_rcp_f16_sdwa v248, v248 dst_sel:WORD_0 dst_unused:UNUSED_PAD src0_sel:WORD_1
    v_fma_mix_f32 v228, v228, v249, 0 op_sel_hi:[0,1,0]
    v_fma_mix_f32 v229, v229, v248, 0 op_sel_hi:[0,1,0]
    v_cvt_pk_bf16_f32 v112, v228, v229
    v_exp_f16_sdwa v250, v251 dst_sel:WORD_0 dst_unused:UNUSED_PAD src0_sel:WORD_0
    v_cvt_pk_f16_f32 v252, v232, v233
    v_exp_f16_sdwa v250, v251 dst_sel:WORD_1 dst_unused:UNUSED_PRESERVE src0_sel:WORD_1
    v_pk_fma_f16 v253, v252, v252, s60
    v_pk_fma_f16 v250, v250, s61, s61
    v_rcp_f16_sdwa v251, v250 dst_sel:WORD_0 dst_unused:UNUSED_PAD src0_sel:WORD_0
    v_pk_mul_f16 v253, v252, v253 neg_lo:[1,0] neg_hi:[1,0]
    v_rcp_f16_sdwa v250, v250 dst_sel:WORD_0 dst_unused:UNUSED_PAD src0_sel:WORD_1
    v_fma_mix_f32 v230, v230, v251, 0 op_sel_hi:[0,1,0]
    v_fma_mix_f32 v231, v231, v250, 0 op_sel_hi:[0,1,0]
    v_cvt_pk_bf16_f32 v113, v230, v231
    v_exp_f16_sdwa v252, v253 dst_sel:WORD_0 dst_unused:UNUSED_PAD src0_sel:WORD_0
    v_cvt_pk_f16_f32 v254, v234, v235
    v_exp_f16_sdwa v252, v253 dst_sel:WORD_1 dst_unused:UNUSED_PRESERVE src0_sel:WORD_1
    v_pk_fma_f16 v255, v254, v254, s60
    v_pk_fma_f16 v252, v252, s61, s61
    v_rcp_f16_sdwa v253, v252 dst_sel:WORD_0 dst_unused:UNUSED_PAD src0_sel:WORD_0
    v_pk_mul_f16 v255, v254, v255 neg_lo:[1,0] neg_hi:[1,0]
    v_rcp_f16_sdwa v252, v252 dst_sel:WORD_0 dst_unused:UNUSED_PAD src0_sel:WORD_1
    v_fma_mix_f32 v232, v232, v253, 0 op_sel_hi:[0,1,0]
    v_fma_mix_f32 v233, v233, v252, 0 op_sel_hi:[0,1,0]
    v_cvt_pk_bf16_f32 v114, v232, v233
    v_exp_f16_sdwa v254, v255 dst_sel:WORD_0 dst_unused:UNUSED_PAD src0_sel:WORD_0
    v_cvt_pk_f16_f32 v248, v236, v237
    v_exp_f16_sdwa v254, v255 dst_sel:WORD_1 dst_unused:UNUSED_PRESERVE src0_sel:WORD_1
    v_pk_fma_f16 v249, v248, v248, s60
    v_pk_fma_f16 v254, v254, s61, s61
    v_rcp_f16_sdwa v255, v254 dst_sel:WORD_0 dst_unused:UNUSED_PAD src0_sel:WORD_0
    v_pk_mul_f16 v249, v248, v249 neg_lo:[1,0] neg_hi:[1,0]
    v_rcp_f16_sdwa v254, v254 dst_sel:WORD_0 dst_unused:UNUSED_PAD src0_sel:WORD_1
    v_fma_mix_f32 v234, v234, v255, 0 op_sel_hi:[0,1,0]
    v_fma_mix_f32 v235, v235, v254, 0 op_sel_hi:[0,1,0]
    v_cvt_pk_bf16_f32 v115, v234, v235
    v_exp_f16_sdwa v248, v249 dst_sel:WORD_0 dst_unused:UNUSED_PAD src0_sel:WORD_0
    v_cvt_pk_f16_f32 v250, v238, v239
    v_exp_f16_sdwa v248, v249 dst_sel:WORD_1 dst_unused:UNUSED_PRESERVE src0_sel:WORD_1
    v_pk_fma_f16 v251, v250, v250, s60
    v_pk_fma_f16 v248, v248, s61, s61
    v_rcp_f16_sdwa v249, v248 dst_sel:WORD_0 dst_unused:UNUSED_PAD src0_sel:WORD_0
    v_pk_mul_f16 v251, v250, v251 neg_lo:[1,0] neg_hi:[1,0]
    v_rcp_f16_sdwa v248, v248 dst_sel:WORD_0 dst_unused:UNUSED_PAD src0_sel:WORD_1
    v_fma_mix_f32 v236, v236, v249, 0 op_sel_hi:[0,1,0]
    v_fma_mix_f32 v237, v237, v248, 0 op_sel_hi:[0,1,0]
    v_cvt_pk_bf16_f32 v116, v236, v237
    v_exp_f16_sdwa v250, v251 dst_sel:WORD_0 dst_unused:UNUSED_PAD src0_sel:WORD_0
    v_cvt_pk_f16_f32 v252, v240, v241
    v_exp_f16_sdwa v250, v251 dst_sel:WORD_1 dst_unused:UNUSED_PRESERVE src0_sel:WORD_1
    v_pk_fma_f16 v253, v252, v252, s60
    v_pk_fma_f16 v250, v250, s61, s61
    v_rcp_f16_sdwa v251, v250 dst_sel:WORD_0 dst_unused:UNUSED_PAD src0_sel:WORD_0
    v_pk_mul_f16 v253, v252, v253 neg_lo:[1,0] neg_hi:[1,0]
    v_rcp_f16_sdwa v250, v250 dst_sel:WORD_0 dst_unused:UNUSED_PAD src0_sel:WORD_1
    v_fma_mix_f32 v238, v238, v251, 0 op_sel_hi:[0,1,0]
    v_fma_mix_f32 v239, v239, v250, 0 op_sel_hi:[0,1,0]
    v_cvt_pk_bf16_f32 v117, v238, v239
    v_exp_f16_sdwa v252, v253 dst_sel:WORD_0 dst_unused:UNUSED_PAD src0_sel:WORD_0
    v_cvt_pk_f16_f32 v254, v242, v243
    v_exp_f16_sdwa v252, v253 dst_sel:WORD_1 dst_unused:UNUSED_PRESERVE src0_sel:WORD_1
    v_pk_fma_f16 v255, v254, v254, s60
    v_pk_fma_f16 v252, v252, s61, s61
    s_waitcnt lgkmcnt(0)
    v_mfma_f32_16x16x32_bf16 v[220:223], v[196:199], v[12:15], 0
    ds_write2st64_b64 v2, v[108:109], v[110:111] offset0:61 offset1:62
    v_pk_mul_f16 v255, v254, v255 neg_lo:[1,0] neg_hi:[1,0]
    v_mfma_f32_16x16x32_bf16 v[220:223], v[200:203], v[16:19], v[220:223]
    v_rcp_f16_sdwa v253, v252 dst_sel:WORD_0 dst_unused:UNUSED_PAD src0_sel:WORD_0
    v_mfma_f32_16x16x32_bf16 v[220:223], v[204:207], v[20:23], v[220:223]
    v_rcp_f16_sdwa v252, v252 dst_sel:WORD_0 dst_unused:UNUSED_PAD src0_sel:WORD_1
    v_mfma_f32_16x16x32_bf16 v[220:223], v[208:211], v[24:27], v[220:223]
    v_exp_f16_sdwa v254, v255 dst_sel:WORD_0 dst_unused:UNUSED_PAD src0_sel:WORD_0
    v_mfma_f32_16x16x32_bf16 v[220:223], v[212:215], v[28:31], v[220:223]
    v_exp_f16_sdwa v254, v255 dst_sel:WORD_1 dst_unused:UNUSED_PRESERVE src0_sel:WORD_1
    v_mfma_f32_16x16x32_bf16 v[220:223], v[216:219], v[32:35], v[220:223]
    v_fma_mix_f32 v240, v240, v253, 0 op_sel_hi:[0,1,0]
    v_fma_mix_f32 v241, v241, v252, 0 op_sel_hi:[0,1,0]
    v_mfma_f32_16x16x32_bf16 v[224:227], v[196:199], v[36:39], 0
    v_cvt_pk_bf16_f32 v118, v240, v241
    v_pk_fma_f16 v254, v254, s61, s61
    v_mfma_f32_16x16x32_bf16 v[224:227], v[200:203], v[40:43], v[224:227]
    v_rcp_f16_sdwa v255, v254 dst_sel:WORD_0 dst_unused:UNUSED_PAD src0_sel:WORD_0
    v_mfma_f32_16x16x32_bf16 v[224:227], v[204:207], v[44:47], v[224:227]
    ds_write2st64_b64 v2, v[112:113], v[114:115] offset0:69 offset1:70
    v_fma_mix_f32 v242, v242, v255, 0 op_sel_hi:[0,1,0]
    v_mfma_f32_16x16x32_bf16 v[224:227], v[208:211], v[48:51], v[224:227]
    v_rcp_f16_sdwa v254, v254 dst_sel:WORD_0 dst_unused:UNUSED_PAD src0_sel:WORD_1
    v_mfma_f32_16x16x32_bf16 v[224:227], v[212:215], v[52:55], v[224:227]
    v_fma_mix_f32 v243, v243, v254, 0 op_sel_hi:[0,1,0]
    v_cvt_pk_bf16_f32 v119, v242, v243
    v_mfma_f32_16x16x32_bf16 v[224:227], v[216:219], v[56:59], v[224:227]
    v_cvt_pk_f16_f32 v248, v220, v221
    v_pk_fma_f16 v249, v248, v248, s60
    v_mfma_f32_16x16x32_bf16 v[228:231], v[196:199], v[60:63], 0
    v_pk_mul_f16 v249, v248, v249 neg_lo:[1,0] neg_hi:[1,0]
    v_cvt_pk_f16_f32 v250, v222, v223
    v_mfma_f32_16x16x32_bf16 v[228:231], v[200:203], v[64:67], v[228:231]
    v_exp_f16_sdwa v248, v249 dst_sel:WORD_0 dst_unused:UNUSED_PAD src0_sel:WORD_0
    v_mfma_f32_16x16x32_bf16 v[228:231], v[204:207], v[68:71], v[228:231]
    v_exp_f16_sdwa v248, v249 dst_sel:WORD_1 dst_unused:UNUSED_PRESERVE src0_sel:WORD_1
    v_mfma_f32_16x16x32_bf16 v[228:231], v[208:211], v[72:75], v[228:231]
    v_pk_fma_f16 v248, v248, s61, s61
    v_pk_fma_f16 v251, v250, v250, s60
    v_mfma_f32_16x16x32_bf16 v[228:231], v[212:215], v[76:79], v[228:231]
    ds_write2st64_b64 v2, v[116:117], v[118:119] offset0:77 offset1:78
    v_pk_mul_f16 v251, v250, v251 neg_lo:[1,0] neg_hi:[1,0]
    v_mfma_f32_16x16x32_bf16 v[228:231], v[216:219], v[80:83], v[228:231]
    v_rcp_f16_sdwa v249, v248 dst_sel:WORD_0 dst_unused:UNUSED_PAD src0_sel:WORD_0
    v_mfma_f32_16x16x32_bf16 v[232:235], v[196:199], v[84:87], 0
    v_rcp_f16_sdwa v248, v248 dst_sel:WORD_0 dst_unused:UNUSED_PAD src0_sel:WORD_1
    v_mfma_f32_16x16x32_bf16 v[232:235], v[200:203], v[88:91], v[232:235]
    v_exp_f16_sdwa v250, v251 dst_sel:WORD_0 dst_unused:UNUSED_PAD src0_sel:WORD_0
    v_mfma_f32_16x16x32_bf16 v[232:235], v[204:207], v[92:95], v[232:235]
    v_exp_f16_sdwa v250, v251 dst_sel:WORD_1 dst_unused:UNUSED_PRESERVE src0_sel:WORD_1
    v_mfma_f32_16x16x32_bf16 v[232:235], v[208:211], v[96:99], v[232:235]
    v_fma_mix_f32 v220, v220, v249, 0 op_sel_hi:[0,1,0]
    v_fma_mix_f32 v221, v221, v248, 0 op_sel_hi:[0,1,0]
    v_mfma_f32_16x16x32_bf16 v[232:235], v[212:215], v[100:103], v[232:235]
    v_cvt_pk_bf16_f32 v108, v220, v221
    v_pk_fma_f16 v250, v250, s61, s61
    v_mfma_f32_16x16x32_bf16 v[232:235], v[216:219], v[104:107], v[232:235]
    v_rcp_f16_sdwa v251, v250 dst_sel:WORD_0 dst_unused:UNUSED_PAD src0_sel:WORD_0
    s_add_u32 s64, s64, 2
    s_cmp_lt_u32 s64, 7
    s_waitcnt lgkmcnt(0)
    s_barrier
    s_cbranch_scc1 L_PN_loop
    v_mfma_f32_16x16x32_bf16 v[236:239], v[196:199], v[124:127], 0
    v_rcp_f16_sdwa v250, v250 dst_sel:WORD_0 dst_unused:UNUSED_PAD src0_sel:WORD_1
    v_mfma_f32_16x16x32_bf16 v[240:243], v[196:199], v[148:151], 0
    v_fma_mix_f32 v222, v222, v251, 0 op_sel_hi:[0,1,0]
    v_fma_mix_f32 v223, v223, v250, 0 op_sel_hi:[0,1,0]
    v_mfma_f32_16x16x32_bf16 v[236:239], v[200:203], v[128:131], v[236:239]
    ds_read_b64_tr_b16 v[196:197], v1 offset:24576
    v_cvt_pk_bf16_f32 v109, v222, v223
    v_mfma_f32_16x16x32_bf16 v[240:243], v[200:203], v[152:155], v[240:243]
    ds_read_b64_tr_b16 v[198:199], v1 offset:24832
    v_cvt_pk_f16_f32 v252, v224, v225
    v_mfma_f32_16x16x32_bf16 v[236:239], v[204:207], v[132:135], v[236:239]
    ds_read_b64_tr_b16 v[200:201], v1 offset:26624
    v_pk_fma_f16 v253, v252, v252, s60
    v_mfma_f32_16x16x32_bf16 v[240:243], v[204:207], v[156:159], v[240:243]
    ds_read_b64_tr_b16 v[202:203], v1 offset:26880
    v_pk_mul_f16 v253, v252, v253 neg_lo:[1,0] neg_hi:[1,0]
    v_mfma_f32_16x16x32_bf16 v[236:239], v[208:211], v[136:139], v[236:239]
    ds_read_b64_tr_b16 v[204:205], v1 offset:28672
    v_cvt_pk_f16_f32 v254, v226, v227
    v_mfma_f32_16x16x32_bf16 v[240:243], v[208:211], v[160:163], v[240:243]
    ds_read_b64_tr_b16 v[206:207], v1 offset:28928
    v_pk_fma_f16 v255, v254, v254, s60
    v_mfma_f32_16x16x32_bf16 v[236:239], v[212:215], v[140:143], v[236:239]
    ds_read_b64_tr_b16 v[208:209], v1 offset:30720
    v_pk_mul_f16 v255, v254, v255 neg_lo:[1,0] neg_hi:[1,0]
    v_mfma_f32_16x16x32_bf16 v[240:243], v[212:215], v[164:167], v[240:243]
    ds_read_b64_tr_b16 v[210:211], v1 offset:30976
    v_cvt_pk_f16_f32 v248, v228, v229
    v_mfma_f32_16x16x32_bf16 v[236:239], v[216:219], v[144:147], v[236:239]
    ds_read_b64_tr_b16 v[212:213], v1 offset:32768
    v_pk_fma_f16 v249, v248, v248, s60
    v_mfma_f32_16x16x32_bf16 v[240:243], v[216:219], v[168:171], v[240:243]
    ds_read_b64_tr_b16 v[214:215], v1 offset:33024
    ds_read_b64_tr_b16 v[216:217], v1 offset:34816
    ds_read_b64_tr_b16 v[218:219], v1 offset:35072
    v_exp_f16_sdwa v252, v253 dst_sel:WORD_0 dst_unused:UNUSED_PAD src0_sel:WORD_0
    v_exp_f16_sdwa v254, v255 dst_sel:WORD_0 dst_unused:UNUSED_PAD src0_sel:WORD_0
    v_exp_f16_sdwa v252, v253 dst_sel:WORD_1 dst_unused:UNUSED_PRESERVE src0_sel:WORD_1
    v_exp_f16_sdwa v254, v255 dst_sel:WORD_1 dst_unused:UNUSED_PRESERVE src0_sel:WORD_1
    v_pk_fma_f16 v252, v252, s61, s61
    v_rcp_f16_sdwa v253, v252 dst_sel:WORD_0 dst_unused:UNUSED_PAD src0_sel:WORD_0
    v_pk_fma_f16 v254, v254, s61, s61
    v_rcp_f16_sdwa v252, v252 dst_sel:WORD_0 dst_unused:UNUSED_PAD src0_sel:WORD_1
    v_fma_mix_f32 v224, v224, v253, 0 op_sel_hi:[0,1,0]
    v_fma_mix_f32 v225, v225, v252, 0 op_sel_hi:[0,1,0]
    v_cvt_pk_bf16_f32 v110, v224, v225
    v_rcp_f16_sdwa v255, v254 dst_sel:WORD_0 dst_unused:UNUSED_PAD src0_sel:WORD_0
    v_pk_mul_f16 v249, v248, v249 neg_lo:[1,0] neg_hi:[1,0]
    v_rcp_f16_sdwa v254, v254 dst_sel:WORD_0 dst_unused:UNUSED_PAD src0_sel:WORD_1
    v_fma_mix_f32 v226, v226, v255, 0 op_sel_hi:[0,1,0]
    v_fma_mix_f32 v227, v227, v254, 0 op_sel_hi:[0,1,0]
    v_cvt_pk_bf16_f32 v111, v226, v227
    v_exp_f16_sdwa v248, v249 dst_sel:WORD_0 dst_unused:UNUSED_PAD src0_sel:WORD_0
    v_cvt_pk_f16_f32 v250, v230, v231
    v_exp_f16_sdwa v248, v249 dst_sel:WORD_1 dst_unused:UNUSED_PRESERVE src0_sel:WORD_1
    v_pk_fma_f16 v251, v250, v250, s60
    v_pk_fma_f16 v248, v248, s61, s61
    v_rcp_f16_sdwa v249, v248 dst_sel:WORD_0 dst_unused:UNUSED_PAD src0_sel:WORD_0
    v_pk_mul_f16 v251, v250, v251 neg_lo:[1,0] neg_hi:[1,0]
    v_rcp_f16_sdwa v248, v248 dst_sel:WORD_0 dst_unused:UNUSED_PAD src0_sel:WORD_1
    v_fma_mix_f32 v228, v228, v249, 0 op_sel_hi:[0,1,0]
    v_fma_mix_f32 v229, v229, v248, 0 op_sel_hi:[0,1,0]
    v_cvt_pk_bf16_f32 v112, v228, v229
    v_exp_f16_sdwa v250, v251 dst_sel:WORD_0 dst_unused:UNUSED_PAD src0_sel:WORD_0
    v_cvt_pk_f16_f32 v252, v232, v233
    v_exp_f16_sdwa v250, v251 dst_sel:WORD_1 dst_unused:UNUSED_PRESERVE src0_sel:WORD_1
    v_pk_fma_f16 v253, v252, v252, s60
    v_pk_fma_f16 v250, v250, s61, s61
    v_rcp_f16_sdwa v251, v250 dst_sel:WORD_0 dst_unused:UNUSED_PAD src0_sel:WORD_0
    v_pk_mul_f16 v253, v252, v253 neg_lo:[1,0] neg_hi:[1,0]
    v_rcp_f16_sdwa v250, v250 dst_sel:WORD_0 dst_unused:UNUSED_PAD src0_sel:WORD_1
    v_fma_mix_f32 v230, v230, v251, 0 op_sel_hi:[0,1,0]
    v_fma_mix_f32 v231, v231, v250, 0 op_sel_hi:[0,1,0]
    v_cvt_pk_bf16_f32 v113, v230, v231
    v_exp_f16_sdwa v252, v253 dst_sel:WORD_0 dst_unused:UNUSED_PAD src0_sel:WORD_0
    v_cvt_pk_f16_f32 v254, v234, v235
    v_exp_f16_sdwa v252, v253 dst_sel:WORD_1 dst_unused:UNUSED_PRESERVE src0_sel:WORD_1
    v_pk_fma_f16 v255, v254, v254, s60
    v_pk_fma_f16 v252, v252, s61, s61
    v_rcp_f16_sdwa v253, v252 dst_sel:WORD_0 dst_unused:UNUSED_PAD src0_sel:WORD_0
    v_pk_mul_f16 v255, v254, v255 neg_lo:[1,0] neg_hi:[1,0]
    v_rcp_f16_sdwa v252, v252 dst_sel:WORD_0 dst_unused:UNUSED_PAD src0_sel:WORD_1
    v_fma_mix_f32 v232, v232, v253, 0 op_sel_hi:[0,1,0]
    v_fma_mix_f32 v233, v233, v252, 0 op_sel_hi:[0,1,0]
    v_cvt_pk_bf16_f32 v114, v232, v233
    v_exp_f16_sdwa v254, v255 dst_sel:WORD_0 dst_unused:UNUSED_PAD src0_sel:WORD_0
    v_cvt_pk_f16_f32 v248, v236, v237
    v_exp_f16_sdwa v254, v255 dst_sel:WORD_1 dst_unused:UNUSED_PRESERVE src0_sel:WORD_1
    v_pk_fma_f16 v249, v248, v248, s60
    v_pk_fma_f16 v254, v254, s61, s61
    v_rcp_f16_sdwa v255, v254 dst_sel:WORD_0 dst_unused:UNUSED_PAD src0_sel:WORD_0
    v_pk_mul_f16 v249, v248, v249 neg_lo:[1,0] neg_hi:[1,0]
    v_rcp_f16_sdwa v254, v254 dst_sel:WORD_0 dst_unused:UNUSED_PAD src0_sel:WORD_1
    v_fma_mix_f32 v234, v234, v255, 0 op_sel_hi:[0,1,0]
    v_fma_mix_f32 v235, v235, v254, 0 op_sel_hi:[0,1,0]
    v_cvt_pk_bf16_f32 v115, v234, v235
    v_exp_f16_sdwa v248, v249 dst_sel:WORD_0 dst_unused:UNUSED_PAD src0_sel:WORD_0
    v_cvt_pk_f16_f32 v250, v238, v239
    v_exp_f16_sdwa v248, v249 dst_sel:WORD_1 dst_unused:UNUSED_PRESERVE src0_sel:WORD_1
    v_pk_fma_f16 v251, v250, v250, s60
    v_pk_fma_f16 v248, v248, s61, s61
    v_rcp_f16_sdwa v249, v248 dst_sel:WORD_0 dst_unused:UNUSED_PAD src0_sel:WORD_0
    v_pk_mul_f16 v251, v250, v251 neg_lo:[1,0] neg_hi:[1,0]
    v_rcp_f16_sdwa v248, v248 dst_sel:WORD_0 dst_unused:UNUSED_PAD src0_sel:WORD_1
    v_fma_mix_f32 v236, v236, v249, 0 op_sel_hi:[0,1,0]
    v_fma_mix_f32 v237, v237, v248, 0 op_sel_hi:[0,1,0]
    v_cvt_pk_bf16_f32 v116, v236, v237
    v_exp_f16_sdwa v250, v251 dst_sel:WORD_0 dst_unused:UNUSED_PAD src0_sel:WORD_0
    v_cvt_pk_f16_f32 v252, v240, v241
    v_exp_f16_sdwa v250, v251 dst_sel:WORD_1 dst_unused:UNUSED_PRESERVE src0_sel:WORD_1
    v_pk_fma_f16 v253, v252, v252, s60
    v_pk_fma_f16 v250, v250, s61, s61
    v_rcp_f16_sdwa v251, v250 dst_sel:WORD_0 dst_unused:UNUSED_PAD src0_sel:WORD_0
    v_pk_mul_f16 v253, v252, v253 neg_lo:[1,0] neg_hi:[1,0]
    v_rcp_f16_sdwa v250, v250 dst_sel:WORD_0 dst_unused:UNUSED_PAD src0_sel:WORD_1
    v_fma_mix_f32 v238, v238, v251, 0 op_sel_hi:[0,1,0]
    v_fma_mix_f32 v239, v239, v250, 0 op_sel_hi:[0,1,0]
    v_cvt_pk_bf16_f32 v117, v238, v239
    v_exp_f16_sdwa v252, v253 dst_sel:WORD_0 dst_unused:UNUSED_PAD src0_sel:WORD_0
    v_cvt_pk_f16_f32 v254, v242, v243
    v_exp_f16_sdwa v252, v253 dst_sel:WORD_1 dst_unused:UNUSED_PRESERVE src0_sel:WORD_1
    v_pk_fma_f16 v255, v254, v254, s60
    v_pk_fma_f16 v252, v252, s61, s61
    s_waitcnt lgkmcnt(0)
    v_mfma_f32_16x16x32_bf16 v[220:223], v[196:199], v[12:15], 0
    ds_write2st64_b64 v2, v[108:109], v[110:111] offset0:0 offset1:1
    v_pk_mul_f16 v255, v254, v255 neg_lo:[1,0] neg_hi:[1,0]
    v_mfma_f32_16x16x32_bf16 v[220:223], v[200:203], v[16:19], v[220:223]
    v_rcp_f16_sdwa v253, v252 dst_sel:WORD_0 dst_unused:UNUSED_PAD src0_sel:WORD_0
    v_mfma_f32_16x16x32_bf16 v[220:223], v[204:207], v[20:23], v[220:223]
    v_rcp_f16_sdwa v252, v252 dst_sel:WORD_0 dst_unused:UNUSED_PAD src0_sel:WORD_1
    v_mfma_f32_16x16x32_bf16 v[220:223], v[208:211], v[24:27], v[220:223]
    v_exp_f16_sdwa v254, v255 dst_sel:WORD_0 dst_unused:UNUSED_PAD src0_sel:WORD_0
    v_mfma_f32_16x16x32_bf16 v[220:223], v[212:215], v[28:31], v[220:223]
    v_exp_f16_sdwa v254, v255 dst_sel:WORD_1 dst_unused:UNUSED_PRESERVE src0_sel:WORD_1
    v_mfma_f32_16x16x32_bf16 v[220:223], v[216:219], v[32:35], v[220:223]
    v_fma_mix_f32 v240, v240, v253, 0 op_sel_hi:[0,1,0]
    v_fma_mix_f32 v241, v241, v252, 0 op_sel_hi:[0,1,0]
    v_mfma_f32_16x16x32_bf16 v[224:227], v[196:199], v[36:39], 0
    v_cvt_pk_bf16_f32 v118, v240, v241
    v_pk_fma_f16 v254, v254, s61, s61
    v_mfma_f32_16x16x32_bf16 v[224:227], v[200:203], v[40:43], v[224:227]
    v_rcp_f16_sdwa v255, v254 dst_sel:WORD_0 dst_unused:UNUSED_PAD src0_sel:WORD_0
    v_mfma_f32_16x16x32_bf16 v[224:227], v[204:207], v[44:47], v[224:227]
    ds_write2st64_b64 v2, v[112:113], v[114:115] offset0:8 offset1:9
    v_fma_mix_f32 v242, v242, v255, 0 op_sel_hi:[0,1,0]
    v_mfma_f32_16x16x32_bf16 v[224:227], v[208:211], v[48:51], v[224:227]
    v_rcp_f16_sdwa v254, v254 dst_sel:WORD_0 dst_unused:UNUSED_PAD src0_sel:WORD_1
    v_mfma_f32_16x16x32_bf16 v[224:227], v[212:215], v[52:55], v[224:227]
    v_fma_mix_f32 v243, v243, v254, 0 op_sel_hi:[0,1,0]
    v_cvt_pk_bf16_f32 v119, v242, v243
    v_mfma_f32_16x16x32_bf16 v[224:227], v[216:219], v[56:59], v[224:227]
    v_cvt_pk_f16_f32 v248, v220, v221
    v_pk_fma_f16 v249, v248, v248, s60
    v_mfma_f32_16x16x32_bf16 v[228:231], v[196:199], v[60:63], 0
    v_pk_mul_f16 v249, v248, v249 neg_lo:[1,0] neg_hi:[1,0]
    v_cvt_pk_f16_f32 v250, v222, v223
    v_mfma_f32_16x16x32_bf16 v[228:231], v[200:203], v[64:67], v[228:231]
    v_exp_f16_sdwa v248, v249 dst_sel:WORD_0 dst_unused:UNUSED_PAD src0_sel:WORD_0
    v_mfma_f32_16x16x32_bf16 v[228:231], v[204:207], v[68:71], v[228:231]
    v_exp_f16_sdwa v248, v249 dst_sel:WORD_1 dst_unused:UNUSED_PRESERVE src0_sel:WORD_1
    v_mfma_f32_16x16x32_bf16 v[228:231], v[208:211], v[72:75], v[228:231]
    v_pk_fma_f16 v248, v248, s61, s61
    v_pk_fma_f16 v251, v250, v250, s60
    v_mfma_f32_16x16x32_bf16 v[228:231], v[212:215], v[76:79], v[228:231]
    ds_write2st64_b64 v2, v[116:117], v[118:119] offset0:16 offset1:17
    v_pk_mul_f16 v251, v250, v251 neg_lo:[1,0] neg_hi:[1,0]
    v_mfma_f32_16x16x32_bf16 v[228:231], v[216:219], v[80:83], v[228:231]
    v_rcp_f16_sdwa v249, v248 dst_sel:WORD_0 dst_unused:UNUSED_PAD src0_sel:WORD_0
    v_mfma_f32_16x16x32_bf16 v[232:235], v[196:199], v[84:87], 0
    v_rcp_f16_sdwa v248, v248 dst_sel:WORD_0 dst_unused:UNUSED_PAD src0_sel:WORD_1
    v_mfma_f32_16x16x32_bf16 v[232:235], v[200:203], v[88:91], v[232:235]
    v_exp_f16_sdwa v250, v251 dst_sel:WORD_0 dst_unused:UNUSED_PAD src0_sel:WORD_0
    v_mfma_f32_16x16x32_bf16 v[232:235], v[204:207], v[92:95], v[232:235]
    v_exp_f16_sdwa v250, v251 dst_sel:WORD_1 dst_unused:UNUSED_PRESERVE src0_sel:WORD_1
    v_mfma_f32_16x16x32_bf16 v[232:235], v[208:211], v[96:99], v[232:235]
    v_fma_mix_f32 v220, v220, v249, 0 op_sel_hi:[0,1,0]
    v_fma_mix_f32 v221, v221, v248, 0 op_sel_hi:[0,1,0]
    v_mfma_f32_16x16x32_bf16 v[232:235], v[212:215], v[100:103], v[232:235]
    v_cvt_pk_bf16_f32 v108, v220, v221
    v_pk_fma_f16 v250, v250, s61, s61
    v_mfma_f32_16x16x32_bf16 v[232:235], v[216:219], v[104:107], v[232:235]
    v_rcp_f16_sdwa v251, v250 dst_sel:WORD_0 dst_unused:UNUSED_PAD src0_sel:WORD_0
    s_waitcnt lgkmcnt(0)
    s_barrier
    v_mfma_f32_16x16x32_bf16 v[236:239], v[196:199], v[124:127], 0
    v_rcp_f16_sdwa v250, v250 dst_sel:WORD_0 dst_unused:UNUSED_PAD src0_sel:WORD_1
    v_mfma_f32_16x16x32_bf16 v[240:243], v[196:199], v[148:151], 0
    v_fma_mix_f32 v222, v222, v251, 0 op_sel_hi:[0,1,0]
    v_fma_mix_f32 v223, v223, v250, 0 op_sel_hi:[0,1,0]
    v_mfma_f32_16x16x32_bf16 v[236:239], v[200:203], v[128:131], v[236:239]
    ds_read_b64_tr_b16 v[196:197], v1 offset:0
    v_cvt_pk_bf16_f32 v109, v222, v223
    v_mfma_f32_16x16x32_bf16 v[240:243], v[200:203], v[152:155], v[240:243]
    ds_read_b64_tr_b16 v[198:199], v1 offset:256
    v_cvt_pk_f16_f32 v252, v224, v225
    v_mfma_f32_16x16x32_bf16 v[236:239], v[204:207], v[132:135], v[236:239]
    ds_read_b64_tr_b16 v[200:201], v1 offset:2048
    v_pk_fma_f16 v253, v252, v252, s60
    v_mfma_f32_16x16x32_bf16 v[240:243], v[204:207], v[156:159], v[240:243]
    ds_read_b64_tr_b16 v[202:203], v1 offset:2304
    v_pk_mul_f16 v253, v252, v253 neg_lo:[1,0] neg_hi:[1,0]
    v_mfma_f32_16x16x32_bf16 v[236:239], v[208:211], v[136:139], v[236:239]
    ds_read_b64_tr_b16 v[204:205], v1 offset:4096
    v_cvt_pk_f16_f32 v254, v226, v227
    v_mfma_f32_16x16x32_bf16 v[240:243], v[208:211], v[160:163], v[240:243]
    ds_read_b64_tr_b16 v[206:207], v1 offset:4352
    v_pk_fma_f16 v255, v254, v254, s60
    v_mfma_f32_16x16x32_bf16 v[236:239], v[212:215], v[140:143], v[236:239]
    ds_read_b64_tr_b16 v[208:209], v1 offset:6144
    v_pk_mul_f16 v255, v254, v255 neg_lo:[1,0] neg_hi:[1,0]
    v_mfma_f32_16x16x32_bf16 v[240:243], v[212:215], v[164:167], v[240:243]
    ds_read_b64_tr_b16 v[210:211], v1 offset:6400
    v_cvt_pk_f16_f32 v248, v228, v229
    v_mfma_f32_16x16x32_bf16 v[236:239], v[216:219], v[144:147], v[236:239]
    ds_read_b64_tr_b16 v[212:213], v1 offset:8192
    v_pk_fma_f16 v249, v248, v248, s60
    v_mfma_f32_16x16x32_bf16 v[240:243], v[216:219], v[168:171], v[240:243]
    ds_read_b64_tr_b16 v[214:215], v1 offset:8448
    ds_read_b64_tr_b16 v[216:217], v1 offset:10240
    ds_read_b64_tr_b16 v[218:219], v1 offset:10496
    v_exp_f16_sdwa v252, v253 dst_sel:WORD_0 dst_unused:UNUSED_PAD src0_sel:WORD_0
    v_exp_f16_sdwa v254, v255 dst_sel:WORD_0 dst_unused:UNUSED_PAD src0_sel:WORD_0
    v_exp_f16_sdwa v252, v253 dst_sel:WORD_1 dst_unused:UNUSED_PRESERVE src0_sel:WORD_1
    v_exp_f16_sdwa v254, v255 dst_sel:WORD_1 dst_unused:UNUSED_PRESERVE src0_sel:WORD_1
    v_pk_fma_f16 v252, v252, s61, s61
    v_rcp_f16_sdwa v253, v252 dst_sel:WORD_0 dst_unused:UNUSED_PAD src0_sel:WORD_0
    v_pk_fma_f16 v254, v254, s61, s61
    v_rcp_f16_sdwa v252, v252 dst_sel:WORD_0 dst_unused:UNUSED_PAD src0_sel:WORD_1
    v_fma_mix_f32 v224, v224, v253, 0 op_sel_hi:[0,1,0]
    v_fma_mix_f32 v225, v225, v252, 0 op_sel_hi:[0,1,0]
    v_cvt_pk_bf16_f32 v110, v224, v225
    v_rcp_f16_sdwa v255, v254 dst_sel:WORD_0 dst_unused:UNUSED_PAD src0_sel:WORD_0
    v_pk_mul_f16 v249, v248, v249 neg_lo:[1,0] neg_hi:[1,0]
    v_rcp_f16_sdwa v254, v254 dst_sel:WORD_0 dst_unused:UNUSED_PAD src0_sel:WORD_1
    v_fma_mix_f32 v226, v226, v255, 0 op_sel_hi:[0,1,0]
    v_fma_mix_f32 v227, v227, v254, 0 op_sel_hi:[0,1,0]
    v_cvt_pk_bf16_f32 v111, v226, v227
    v_exp_f16_sdwa v248, v249 dst_sel:WORD_0 dst_unused:UNUSED_PAD src0_sel:WORD_0
    v_cvt_pk_f16_f32 v250, v230, v231
    v_exp_f16_sdwa v248, v249 dst_sel:WORD_1 dst_unused:UNUSED_PRESERVE src0_sel:WORD_1
    v_pk_fma_f16 v251, v250, v250, s60
    v_pk_fma_f16 v248, v248, s61, s61
    v_rcp_f16_sdwa v249, v248 dst_sel:WORD_0 dst_unused:UNUSED_PAD src0_sel:WORD_0
    v_pk_mul_f16 v251, v250, v251 neg_lo:[1,0] neg_hi:[1,0]
    v_rcp_f16_sdwa v248, v248 dst_sel:WORD_0 dst_unused:UNUSED_PAD src0_sel:WORD_1
    v_fma_mix_f32 v228, v228, v249, 0 op_sel_hi:[0,1,0]
    v_fma_mix_f32 v229, v229, v248, 0 op_sel_hi:[0,1,0]
    v_cvt_pk_bf16_f32 v112, v228, v229
    v_exp_f16_sdwa v250, v251 dst_sel:WORD_0 dst_unused:UNUSED_PAD src0_sel:WORD_0
    v_cvt_pk_f16_f32 v252, v232, v233
    v_exp_f16_sdwa v250, v251 dst_sel:WORD_1 dst_unused:UNUSED_PRESERVE src0_sel:WORD_1
    v_pk_fma_f16 v253, v252, v252, s60
    v_pk_fma_f16 v250, v250, s61, s61
    v_rcp_f16_sdwa v251, v250 dst_sel:WORD_0 dst_unused:UNUSED_PAD src0_sel:WORD_0
    v_pk_mul_f16 v253, v252, v253 neg_lo:[1,0] neg_hi:[1,0]
    v_rcp_f16_sdwa v250, v250 dst_sel:WORD_0 dst_unused:UNUSED_PAD src0_sel:WORD_1
    v_fma_mix_f32 v230, v230, v251, 0 op_sel_hi:[0,1,0]
    v_fma_mix_f32 v231, v231, v250, 0 op_sel_hi:[0,1,0]
    v_cvt_pk_bf16_f32 v113, v230, v231
    v_exp_f16_sdwa v252, v253 dst_sel:WORD_0 dst_unused:UNUSED_PAD src0_sel:WORD_0
    v_cvt_pk_f16_f32 v254, v234, v235
    v_exp_f16_sdwa v252, v253 dst_sel:WORD_1 dst_unused:UNUSED_PRESERVE src0_sel:WORD_1
    v_pk_fma_f16 v255, v254, v254, s60
    v_pk_fma_f16 v252, v252, s61, s61
    v_rcp_f16_sdwa v253, v252 dst_sel:WORD_0 dst_unused:UNUSED_PAD src0_sel:WORD_0
    v_pk_mul_f16 v255, v254, v255 neg_lo:[1,0] neg_hi:[1,0]
    v_rcp_f16_sdwa v252, v252 dst_sel:WORD_0 dst_unused:UNUSED_PAD src0_sel:WORD_1
    v_fma_mix_f32 v232, v232, v253, 0 op_sel_hi:[0,1,0]
    v_fma_mix_f32 v233, v233, v252, 0 op_sel_hi:[0,1,0]
    v_cvt_pk_bf16_f32 v114, v232, v233
    v_exp_f16_sdwa v254, v255 dst_sel:WORD_0 dst_unused:UNUSED_PAD src0_sel:WORD_0
    v_cvt_pk_f16_f32 v248, v236, v237
    v_exp_f16_sdwa v254, v255 dst_sel:WORD_1 dst_unused:UNUSED_PRESERVE src0_sel:WORD_1
    v_pk_fma_f16 v249, v248, v248, s60
    v_pk_fma_f16 v254, v254, s61, s61
    v_rcp_f16_sdwa v255, v254 dst_sel:WORD_0 dst_unused:UNUSED_PAD src0_sel:WORD_0
    v_pk_mul_f16 v249, v248, v249 neg_lo:[1,0] neg_hi:[1,0]
    v_rcp_f16_sdwa v254, v254 dst_sel:WORD_0 dst_unused:UNUSED_PAD src0_sel:WORD_1
    v_fma_mix_f32 v234, v234, v255, 0 op_sel_hi:[0,1,0]
    v_fma_mix_f32 v235, v235, v254, 0 op_sel_hi:[0,1,0]
    v_cvt_pk_bf16_f32 v115, v234, v235
    v_exp_f16_sdwa v248, v249 dst_sel:WORD_0 dst_unused:UNUSED_PAD src0_sel:WORD_0
    v_cvt_pk_f16_f32 v250, v238, v239
    v_exp_f16_sdwa v248, v249 dst_sel:WORD_1 dst_unused:UNUSED_PRESERVE src0_sel:WORD_1
    v_pk_fma_f16 v251, v250, v250, s60
    v_pk_fma_f16 v248, v248, s61, s61
    v_rcp_f16_sdwa v249, v248 dst_sel:WORD_0 dst_unused:UNUSED_PAD src0_sel:WORD_0
    v_pk_mul_f16 v251, v250, v251 neg_lo:[1,0] neg_hi:[1,0]
    v_rcp_f16_sdwa v248, v248 dst_sel:WORD_0 dst_unused:UNUSED_PAD src0_sel:WORD_1
    v_fma_mix_f32 v236, v236, v249, 0 op_sel_hi:[0,1,0]
    v_fma_mix_f32 v237, v237, v248, 0 op_sel_hi:[0,1,0]
    v_cvt_pk_bf16_f32 v116, v236, v237
    v_exp_f16_sdwa v250, v251 dst_sel:WORD_0 dst_unused:UNUSED_PAD src0_sel:WORD_0
    v_cvt_pk_f16_f32 v252, v240, v241
    v_exp_f16_sdwa v250, v251 dst_sel:WORD_1 dst_unused:UNUSED_PRESERVE src0_sel:WORD_1
    v_pk_fma_f16 v253, v252, v252, s60
    v_pk_fma_f16 v250, v250, s61, s61
    v_rcp_f16_sdwa v251, v250 dst_sel:WORD_0 dst_unused:UNUSED_PAD src0_sel:WORD_0
    v_pk_mul_f16 v253, v252, v253 neg_lo:[1,0] neg_hi:[1,0]
    v_rcp_f16_sdwa v250, v250 dst_sel:WORD_0 dst_unused:UNUSED_PAD src0_sel:WORD_1
    v_fma_mix_f32 v238, v238, v251, 0 op_sel_hi:[0,1,0]
    v_fma_mix_f32 v239, v239, v250, 0 op_sel_hi:[0,1,0]
    v_cvt_pk_bf16_f32 v117, v238, v239
    v_exp_f16_sdwa v252, v253 dst_sel:WORD_0 dst_unused:UNUSED_PAD src0_sel:WORD_0
    v_cvt_pk_f16_f32 v254, v242, v243
    v_exp_f16_sdwa v252, v253 dst_sel:WORD_1 dst_unused:UNUSED_PRESERVE src0_sel:WORD_1
    v_pk_fma_f16 v255, v254, v254, s60
    v_pk_fma_f16 v252, v252, s61, s61
    s_waitcnt lgkmcnt(0)
    v_mfma_f32_16x16x32_bf16 v[220:223], v[196:199], v[12:15], 0
    ds_write2st64_b64 v2, v[108:109], v[110:111] offset0:26 offset1:27
    v_pk_mul_f16 v255, v254, v255 neg_lo:[1,0] neg_hi:[1,0]
    v_mfma_f32_16x16x32_bf16 v[220:223], v[200:203], v[16:19], v[220:223]
    v_rcp_f16_sdwa v253, v252 dst_sel:WORD_0 dst_unused:UNUSED_PAD src0_sel:WORD_0
    v_mfma_f32_16x16x32_bf16 v[220:223], v[204:207], v[20:23], v[220:223]
    v_rcp_f16_sdwa v252, v252 dst_sel:WORD_0 dst_unused:UNUSED_PAD src0_sel:WORD_1
    v_mfma_f32_16x16x32_bf16 v[220:223], v[208:211], v[24:27], v[220:223]
    v_exp_f16_sdwa v254, v255 dst_sel:WORD_0 dst_unused:UNUSED_PAD src0_sel:WORD_0
    v_mfma_f32_16x16x32_bf16 v[220:223], v[212:215], v[28:31], v[220:223]
    v_exp_f16_sdwa v254, v255 dst_sel:WORD_1 dst_unused:UNUSED_PRESERVE src0_sel:WORD_1
    v_mfma_f32_16x16x32_bf16 v[220:223], v[216:219], v[32:35], v[220:223]
    v_fma_mix_f32 v240, v240, v253, 0 op_sel_hi:[0,1,0]
    v_fma_mix_f32 v241, v241, v252, 0 op_sel_hi:[0,1,0]
    v_mfma_f32_16x16x32_bf16 v[224:227], v[196:199], v[36:39], 0
    v_cvt_pk_bf16_f32 v118, v240, v241
    v_pk_fma_f16 v254, v254, s61, s61
    v_mfma_f32_16x16x32_bf16 v[224:227], v[200:203], v[40:43], v[224:227]
    v_rcp_f16_sdwa v255, v254 dst_sel:WORD_0 dst_unused:UNUSED_PAD src0_sel:WORD_0
    v_mfma_f32_16x16x32_bf16 v[224:227], v[204:207], v[44:47], v[224:227]
    ds_write2st64_b64 v2, v[112:113], v[114:115] offset0:34 offset1:35
    v_fma_mix_f32 v242, v242, v255, 0 op_sel_hi:[0,1,0]
    v_mfma_f32_16x16x32_bf16 v[224:227], v[208:211], v[48:51], v[224:227]
    v_rcp_f16_sdwa v254, v254 dst_sel:WORD_0 dst_unused:UNUSED_PAD src0_sel:WORD_1
    v_mfma_f32_16x16x32_bf16 v[224:227], v[212:215], v[52:55], v[224:227]
    v_fma_mix_f32 v243, v243, v254, 0 op_sel_hi:[0,1,0]
    v_cvt_pk_bf16_f32 v119, v242, v243
    v_mfma_f32_16x16x32_bf16 v[224:227], v[216:219], v[56:59], v[224:227]
    v_cvt_pk_f16_f32 v248, v220, v221
    v_pk_fma_f16 v249, v248, v248, s60
    v_mfma_f32_16x16x32_bf16 v[228:231], v[196:199], v[60:63], 0
    v_pk_mul_f16 v249, v248, v249 neg_lo:[1,0] neg_hi:[1,0]
    v_cvt_pk_f16_f32 v250, v222, v223
    v_mfma_f32_16x16x32_bf16 v[228:231], v[200:203], v[64:67], v[228:231]
    v_exp_f16_sdwa v248, v249 dst_sel:WORD_0 dst_unused:UNUSED_PAD src0_sel:WORD_0
    v_mfma_f32_16x16x32_bf16 v[228:231], v[204:207], v[68:71], v[228:231]
    v_exp_f16_sdwa v248, v249 dst_sel:WORD_1 dst_unused:UNUSED_PRESERVE src0_sel:WORD_1
    v_mfma_f32_16x16x32_bf16 v[228:231], v[208:211], v[72:75], v[228:231]
    v_pk_fma_f16 v248, v248, s61, s61
    v_pk_fma_f16 v251, v250, v250, s60
    v_mfma_f32_16x16x32_bf16 v[228:231], v[212:215], v[76:79], v[228:231]
    ds_write2st64_b64 v2, v[116:117], v[118:119] offset0:42 offset1:43
    v_pk_mul_f16 v251, v250, v251 neg_lo:[1,0] neg_hi:[1,0]
    v_mfma_f32_16x16x32_bf16 v[228:231], v[216:219], v[80:83], v[228:231]
    v_rcp_f16_sdwa v249, v248 dst_sel:WORD_0 dst_unused:UNUSED_PAD src0_sel:WORD_0
    v_mfma_f32_16x16x32_bf16 v[232:235], v[196:199], v[84:87], 0
    v_rcp_f16_sdwa v248, v248 dst_sel:WORD_0 dst_unused:UNUSED_PAD src0_sel:WORD_1
    v_mfma_f32_16x16x32_bf16 v[232:235], v[200:203], v[88:91], v[232:235]
    v_exp_f16_sdwa v250, v251 dst_sel:WORD_0 dst_unused:UNUSED_PAD src0_sel:WORD_0
    v_mfma_f32_16x16x32_bf16 v[232:235], v[204:207], v[92:95], v[232:235]
    v_exp_f16_sdwa v250, v251 dst_sel:WORD_1 dst_unused:UNUSED_PRESERVE src0_sel:WORD_1
    v_mfma_f32_16x16x32_bf16 v[232:235], v[208:211], v[96:99], v[232:235]
    v_fma_mix_f32 v220, v220, v249, 0 op_sel_hi:[0,1,0]
    v_fma_mix_f32 v221, v221, v248, 0 op_sel_hi:[0,1,0]
    v_mfma_f32_16x16x32_bf16 v[232:235], v[212:215], v[100:103], v[232:235]
    v_cvt_pk_bf16_f32 v108, v220, v221
    v_pk_fma_f16 v250, v250, s61, s61
    v_mfma_f32_16x16x32_bf16 v[232:235], v[216:219], v[104:107], v[232:235]
    v_rcp_f16_sdwa v251, v250 dst_sel:WORD_0 dst_unused:UNUSED_PAD src0_sel:WORD_0
    s_waitcnt lgkmcnt(0)
    s_barrier
    v_mfma_f32_16x16x32_bf16 v[236:239], v[196:199], v[124:127], 0
    v_rcp_f16_sdwa v250, v250 dst_sel:WORD_0 dst_unused:UNUSED_PAD src0_sel:WORD_1
    v_mfma_f32_16x16x32_bf16 v[240:243], v[196:199], v[148:151], 0
    v_fma_mix_f32 v222, v222, v251, 0 op_sel_hi:[0,1,0]
    v_fma_mix_f32 v223, v223, v250, 0 op_sel_hi:[0,1,0]
    v_mfma_f32_16x16x32_bf16 v[236:239], v[200:203], v[128:131], v[236:239]
    v_cvt_pk_bf16_f32 v109, v222, v223
    v_mfma_f32_16x16x32_bf16 v[240:243], v[200:203], v[152:155], v[240:243]
    v_cvt_pk_f16_f32 v252, v224, v225
    v_mfma_f32_16x16x32_bf16 v[236:239], v[204:207], v[132:135], v[236:239]
    v_pk_fma_f16 v253, v252, v252, s60
    v_mfma_f32_16x16x32_bf16 v[240:243], v[204:207], v[156:159], v[240:243]
    v_pk_mul_f16 v253, v252, v253 neg_lo:[1,0] neg_hi:[1,0]
    v_mfma_f32_16x16x32_bf16 v[236:239], v[208:211], v[136:139], v[236:239]
    v_cvt_pk_f16_f32 v254, v226, v227
    v_mfma_f32_16x16x32_bf16 v[240:243], v[208:211], v[160:163], v[240:243]
    v_pk_fma_f16 v255, v254, v254, s60
    v_mfma_f32_16x16x32_bf16 v[236:239], v[212:215], v[140:143], v[236:239]
    v_pk_mul_f16 v255, v254, v255 neg_lo:[1,0] neg_hi:[1,0]
    v_mfma_f32_16x16x32_bf16 v[240:243], v[212:215], v[164:167], v[240:243]
    v_cvt_pk_f16_f32 v248, v228, v229
    v_mfma_f32_16x16x32_bf16 v[236:239], v[216:219], v[144:147], v[236:239]
    v_pk_fma_f16 v249, v248, v248, s60
    v_mfma_f32_16x16x32_bf16 v[240:243], v[216:219], v[168:171], v[240:243]
    v_exp_f16_sdwa v252, v253 dst_sel:WORD_0 dst_unused:UNUSED_PAD src0_sel:WORD_0
    v_exp_f16_sdwa v254, v255 dst_sel:WORD_0 dst_unused:UNUSED_PAD src0_sel:WORD_0
    v_exp_f16_sdwa v252, v253 dst_sel:WORD_1 dst_unused:UNUSED_PRESERVE src0_sel:WORD_1
    v_exp_f16_sdwa v254, v255 dst_sel:WORD_1 dst_unused:UNUSED_PRESERVE src0_sel:WORD_1
    v_pk_fma_f16 v252, v252, s61, s61
    v_rcp_f16_sdwa v253, v252 dst_sel:WORD_0 dst_unused:UNUSED_PAD src0_sel:WORD_0
    v_pk_fma_f16 v254, v254, s61, s61
    v_rcp_f16_sdwa v252, v252 dst_sel:WORD_0 dst_unused:UNUSED_PAD src0_sel:WORD_1
    v_fma_mix_f32 v224, v224, v253, 0 op_sel_hi:[0,1,0]
    v_fma_mix_f32 v225, v225, v252, 0 op_sel_hi:[0,1,0]
    v_cvt_pk_bf16_f32 v110, v224, v225
    v_rcp_f16_sdwa v255, v254 dst_sel:WORD_0 dst_unused:UNUSED_PAD src0_sel:WORD_0
    v_pk_mul_f16 v249, v248, v249 neg_lo:[1,0] neg_hi:[1,0]
    v_rcp_f16_sdwa v254, v254 dst_sel:WORD_0 dst_unused:UNUSED_PAD src0_sel:WORD_1
    v_fma_mix_f32 v226, v226, v255, 0 op_sel_hi:[0,1,0]
    v_fma_mix_f32 v227, v227, v254, 0 op_sel_hi:[0,1,0]
    v_cvt_pk_bf16_f32 v111, v226, v227
    v_exp_f16_sdwa v248, v249 dst_sel:WORD_0 dst_unused:UNUSED_PAD src0_sel:WORD_0
    v_cvt_pk_f16_f32 v250, v230, v231
    v_exp_f16_sdwa v248, v249 dst_sel:WORD_1 dst_unused:UNUSED_PRESERVE src0_sel:WORD_1
    v_pk_fma_f16 v251, v250, v250, s60
    v_pk_fma_f16 v248, v248, s61, s61
    v_rcp_f16_sdwa v249, v248 dst_sel:WORD_0 dst_unused:UNUSED_PAD src0_sel:WORD_0
    v_pk_mul_f16 v251, v250, v251 neg_lo:[1,0] neg_hi:[1,0]
    v_rcp_f16_sdwa v248, v248 dst_sel:WORD_0 dst_unused:UNUSED_PAD src0_sel:WORD_1
    v_fma_mix_f32 v228, v228, v249, 0 op_sel_hi:[0,1,0]
    v_fma_mix_f32 v229, v229, v248, 0 op_sel_hi:[0,1,0]
    v_cvt_pk_bf16_f32 v112, v228, v229
    v_exp_f16_sdwa v250, v251 dst_sel:WORD_0 dst_unused:UNUSED_PAD src0_sel:WORD_0
    v_cvt_pk_f16_f32 v252, v232, v233
    v_exp_f16_sdwa v250, v251 dst_sel:WORD_1 dst_unused:UNUSED_PRESERVE src0_sel:WORD_1
    v_pk_fma_f16 v253, v252, v252, s60
    v_pk_fma_f16 v250, v250, s61, s61
    v_rcp_f16_sdwa v251, v250 dst_sel:WORD_0 dst_unused:UNUSED_PAD src0_sel:WORD_0
    v_pk_mul_f16 v253, v252, v253 neg_lo:[1,0] neg_hi:[1,0]
    v_rcp_f16_sdwa v250, v250 dst_sel:WORD_0 dst_unused:UNUSED_PAD src0_sel:WORD_1
    v_fma_mix_f32 v230, v230, v251, 0 op_sel_hi:[0,1,0]
    v_fma_mix_f32 v231, v231, v250, 0 op_sel_hi:[0,1,0]
    v_cvt_pk_bf16_f32 v113, v230, v231
    v_exp_f16_sdwa v252, v253 dst_sel:WORD_0 dst_unused:UNUSED_PAD src0_sel:WORD_0
    v_cvt_pk_f16_f32 v254, v234, v235
    v_exp_f16_sdwa v252, v253 dst_sel:WORD_1 dst_unused:UNUSED_PRESERVE src0_sel:WORD_1
    v_pk_fma_f16 v255, v254, v254, s60
    v_pk_fma_f16 v252, v252, s61, s61
    v_rcp_f16_sdwa v253, v252 dst_sel:WORD_0 dst_unused:UNUSED_PAD src0_sel:WORD_0
    v_pk_mul_f16 v255, v254, v255 neg_lo:[1,0] neg_hi:[1,0]
    v_rcp_f16_sdwa v252, v252 dst_sel:WORD_0 dst_unused:UNUSED_PAD src0_sel:WORD_1
    v_fma_mix_f32 v232, v232, v253, 0 op_sel_hi:[0,1,0]
    v_fma_mix_f32 v233, v233, v252, 0 op_sel_hi:[0,1,0]
    v_cvt_pk_bf16_f32 v114, v232, v233
    v_exp_f16_sdwa v254, v255 dst_sel:WORD_0 dst_unused:UNUSED_PAD src0_sel:WORD_0
    v_cvt_pk_f16_f32 v248, v236, v237
    v_exp_f16_sdwa v254, v255 dst_sel:WORD_1 dst_unused:UNUSED_PRESERVE src0_sel:WORD_1
    v_pk_fma_f16 v249, v248, v248, s60
    v_pk_fma_f16 v254, v254, s61, s61
    v_rcp_f16_sdwa v255, v254 dst_sel:WORD_0 dst_unused:UNUSED_PAD src0_sel:WORD_0
    v_pk_mul_f16 v249, v248, v249 neg_lo:[1,0] neg_hi:[1,0]
    v_rcp_f16_sdwa v254, v254 dst_sel:WORD_0 dst_unused:UNUSED_PAD src0_sel:WORD_1
    v_fma_mix_f32 v234, v234, v255, 0 op_sel_hi:[0,1,0]
    v_fma_mix_f32 v235, v235, v254, 0 op_sel_hi:[0,1,0]
    v_cvt_pk_bf16_f32 v115, v234, v235
    v_exp_f16_sdwa v248, v249 dst_sel:WORD_0 dst_unused:UNUSED_PAD src0_sel:WORD_0
    v_cvt_pk_f16_f32 v250, v238, v239
    v_exp_f16_sdwa v248, v249 dst_sel:WORD_1 dst_unused:UNUSED_PRESERVE src0_sel:WORD_1
    v_pk_fma_f16 v251, v250, v250, s60
    v_pk_fma_f16 v248, v248, s61, s61
    v_rcp_f16_sdwa v249, v248 dst_sel:WORD_0 dst_unused:UNUSED_PAD src0_sel:WORD_0
    v_pk_mul_f16 v251, v250, v251 neg_lo:[1,0] neg_hi:[1,0]
    v_rcp_f16_sdwa v248, v248 dst_sel:WORD_0 dst_unused:UNUSED_PAD src0_sel:WORD_1
    v_fma_mix_f32 v236, v236, v249, 0 op_sel_hi:[0,1,0]
    v_fma_mix_f32 v237, v237, v248, 0 op_sel_hi:[0,1,0]
    v_cvt_pk_bf16_f32 v116, v236, v237
    v_exp_f16_sdwa v250, v251 dst_sel:WORD_0 dst_unused:UNUSED_PAD src0_sel:WORD_0
    v_cvt_pk_f16_f32 v252, v240, v241
    v_exp_f16_sdwa v250, v251 dst_sel:WORD_1 dst_unused:UNUSED_PRESERVE src0_sel:WORD_1
    v_pk_fma_f16 v253, v252, v252, s60
    v_pk_fma_f16 v250, v250, s61, s61
    v_rcp_f16_sdwa v251, v250 dst_sel:WORD_0 dst_unused:UNUSED_PAD src0_sel:WORD_0
    v_pk_mul_f16 v253, v252, v253 neg_lo:[1,0] neg_hi:[1,0]
    v_rcp_f16_sdwa v250, v250 dst_sel:WORD_0 dst_unused:UNUSED_PAD src0_sel:WORD_1
    v_fma_mix_f32 v238, v238, v251, 0 op_sel_hi:[0,1,0]
    v_fma_mix_f32 v239, v239, v250, 0 op_sel_hi:[0,1,0]
    v_cvt_pk_bf16_f32 v117, v238, v239
    v_exp_f16_sdwa v252, v253 dst_sel:WORD_0 dst_unused:UNUSED_PAD src0_sel:WORD_0
    v_cvt_pk_f16_f32 v254, v242, v243
    v_exp_f16_sdwa v252, v253 dst_sel:WORD_1 dst_unused:UNUSED_PRESERVE src0_sel:WORD_1
    v_pk_fma_f16 v255, v254, v254, s60
    v_pk_fma_f16 v252, v252, s61, s61
    ds_write2st64_b64 v2, v[108:109], v[110:111] offset0:61 offset1:62
    v_pk_mul_f16 v255, v254, v255 neg_lo:[1,0] neg_hi:[1,0]
    v_rcp_f16_sdwa v253, v252 dst_sel:WORD_0 dst_unused:UNUSED_PAD src0_sel:WORD_0
    v_rcp_f16_sdwa v252, v252 dst_sel:WORD_0 dst_unused:UNUSED_PAD src0_sel:WORD_1
    v_exp_f16_sdwa v254, v255 dst_sel:WORD_0 dst_unused:UNUSED_PAD src0_sel:WORD_0
    s_nop 0
    v_exp_f16_sdwa v254, v255 dst_sel:WORD_1 dst_unused:UNUSED_PRESERVE src0_sel:WORD_1
    v_fma_mix_f32 v240, v240, v253, 0 op_sel_hi:[0,1,0]
    v_fma_mix_f32 v241, v241, v252, 0 op_sel_hi:[0,1,0]
    v_cvt_pk_bf16_f32 v118, v240, v241
    v_pk_fma_f16 v254, v254, s61, s61
    v_rcp_f16_sdwa v255, v254 dst_sel:WORD_0 dst_unused:UNUSED_PAD src0_sel:WORD_0
    ds_write2st64_b64 v2, v[112:113], v[114:115] offset0:69 offset1:70
    v_fma_mix_f32 v242, v242, v255, 0 op_sel_hi:[0,1,0]
    v_rcp_f16_sdwa v254, v254 dst_sel:WORD_0 dst_unused:UNUSED_PAD src0_sel:WORD_1
    s_nop 0
    v_fma_mix_f32 v243, v243, v254, 0 op_sel_hi:[0,1,0]
    v_cvt_pk_bf16_f32 v119, v242, v243
    ds_write2st64_b64 v2, v[116:117], v[118:119] offset0:77 offset1:78
    s_waitcnt lgkmcnt(0)
    s_barrier
    s_endpgm
L_Q:
    s_setprio 3
    ds_read_b128 v[108:111], v3 offset:0
    ds_read_b128 v[112:115], v4 offset:0
    ds_read_b128 v[116:119], v5 offset:0
    ds_read_b128 v[120:123], v6 offset:0
    ds_read_b128 v[124:127], v3 offset:31232
    ds_read_b128 v[132:135], v3 offset:160
    ds_read_b128 v[136:139], v4 offset:160
    ds_read_b128 v[140:143], v5 offset:160
    ds_read_b128 v[144:147], v6 offset:160
    ds_read_b128 v[148:151], v3 offset:31392
    v_and_b32 v28, 15, v9
    v_lshlrev_b32 v28, 3, v28
    v_bfe_u32 v29, v9, 4, 1
    v_mul_u32_u24 v29, 30592, v29
    v_add_u32 v28, v28, v29
    v_lshrrev_b32 v29, 5, v9
    v_mul_u32_u24 v29, 1296, v29
    v_add_u32 v28, v28, v29
    s_mul_i32 s26, s24, 320
    s_mul_i32 s27, s25, 15552
    s_add_u32 s26, s26, s27
    s_add_u32 s26, s26, 656
    v_add_u32 v28, s26, v28
    v_and_b32 v30, 15, v9
    v_lshlrev_b32 v30, 3, v30
    v_bfe_u32 v31, v9, 4, 1
    v_mul_u32_u24 v31, 160, v31
    v_add_u32 v30, v30, v31
    v_lshrrev_b32 v31, 5, v9
    v_mul_u32_u24 v31, 1296, v31
    v_add_u32 v30, v30, v31
    s_and_b32 s26, s20, 3
    s_mul_i32 s26, s26, 7776
    s_add_u32 s26, s26, 336
    v_add_u32 v30, s26, v30
    s_setprio 2
    s_waitcnt lgkmcnt(5)
    v_smfmac_f32_16x16x64_bf16 v[232:235], v[172:175], v[108:115], v8
    v_smfmac_f32_16x16x64_bf16 v[232:235], v[176:179], v[116:123], v8
    ds_read_b128 v[108:111], v3 offset:1296
    ds_read_b128 v[112:115], v4 offset:1296
    ds_read_b128 v[116:119], v5 offset:1296
    ds_read_b128 v[120:123], v6 offset:1296
    s_nop 1
    v_smfmac_f32_16x16x32_bf16 v[232:235], v[180:181], v[124:127], v8
    ds_read_b128 v[124:127], v3 offset:32528
    ds_read_b64 v[36:37], v28 offset:0
    ds_read_b64 v[38:39], v28 offset:160
    ds_read_b64 v[40:41], v28 offset:2592
    ds_read_b64 v[42:43], v28 offset:2752
    s_mul_i32 s26, s30, 86016
    buffer_load_dwordx4 v[156:159], v1, s[32:35], s26 offen
    s_add_u32 s30, s30, 1
    s_waitcnt lgkmcnt(9)
    v_smfmac_f32_16x16x64_bf16 v[236:239], v[182:185], v[132:139], v8
    v_smfmac_f32_16x16x64_bf16 v[236:239], v[186:189], v[140:147], v8
    ds_read_b128 v[132:135], v3 offset:1456
    ds_read_b128 v[136:139], v4 offset:1456
    ds_read_b128 v[140:143], v5 offset:1456
    ds_read_b128 v[144:147], v6 offset:1456
    v_mov_b32 v54, v232
    v_mul_f32 v55, v232, v232
    v_add_f32 v54, v54, v233
    v_fmac_f32 v55, v233, v233
    v_add_f32 v54, v54, v234
    v_fmac_f32 v55, v234, v234
    v_add_f32 v54, v54, v235
    v_fmac_f32 v55, v235, v235
    v_smfmac_f32_16x16x32_bf16 v[236:239], v[190:191], v[148:151], v8
    ds_read_b128 v[148:151], v3 offset:32688
    ds_read_b64 v[44:45], v28 offset:5184
    ds_read_b64 v[46:47], v28 offset:5344
    ds_read_b64 v[48:49], v28 offset:7776
    ds_read_b64 v[50:51], v28 offset:7936
    s_mul_i32 s26, s30, 86016
    buffer_load_dwordx4 v[160:163], v1, s[32:35], s26 offen
    s_add_u32 s30, s30, 1
    s_setprio 1
    s_waitcnt lgkmcnt(13)
    v_smfmac_f32_16x16x64_bf16 v[240:243], v[192:195], v[108:115], v8
    v_smfmac_f32_16x16x64_bf16 v[240:243], v[196:199], v[116:123], v8
    ds_read_b128 v[108:111], v3 offset:2592
    ds_read_b128 v[112:115], v4 offset:2592
    ds_read_b128 v[116:119], v5 offset:2592
    ds_read_b128 v[120:123], v6 offset:2592
    v_add_f32 v54, v54, v236
    v_fmac_f32 v55, v236, v236
    v_add_f32 v54, v54, v237
    v_fmac_f32 v55, v237, v237
    v_add_f32 v54, v54, v238
    v_fmac_f32 v55, v238, v238
    v_add_f32 v54, v54, v239
    v_fmac_f32 v55, v239, v239
    v_smfmac_f32_16x16x32_bf16 v[240:243], v[200:201], v[124:127], v8
    ds_read_b128 v[124:127], v3 offset:33824
    s_mul_i32 s26, s30, 86016
    s_cmp_lt_u32 s30, 224
    s_cselect_b32 s26, s26, 0
    s_cselect_b32 s34, 19267584, 0
    buffer_load_dwordx4 v[164:167], v1, s[32:35], s26 offen
    s_add_u32 s30, s30, 1
    s_and_b32 s31, s20, 3
    s_lshl_b32 s31, s31, 13
    v_lshl_add_u32 v10, v9, 7, s31
    s_mul_i32 s31, s29, 12288
    buffer_load_dword v90, v10, s[44:47], s31 offen
    s_waitcnt lgkmcnt(9)
    v_smfmac_f32_16x16x64_bf16 v[244:247], v[202:205], v[132:139], v8
    v_smfmac_f32_16x16x64_bf16 v[244:247], v[206:209], v[140:147], v8
    ds_read_b128 v[132:135], v3 offset:2752
    ds_read_b128 v[136:139], v4 offset:2752
    ds_read_b128 v[140:143], v5 offset:2752
    ds_read_b128 v[144:147], v6 offset:2752
    v_add_f32 v54, v54, v240
    v_fmac_f32 v55, v240, v240
    v_add_f32 v54, v54, v241
    v_fmac_f32 v55, v241, v241
    v_add_f32 v54, v54, v242
    v_fmac_f32 v55, v242, v242
    v_add_f32 v54, v54, v243
    v_fmac_f32 v55, v243, v243
    v_smfmac_f32_16x16x32_bf16 v[244:247], v[210:211], v[148:151], v8
    ds_read_b128 v[148:151], v3 offset:33984
    ds_read_b64 v[12:13], v30 offset:0
    ds_read_b64 v[14:15], v30 offset:2592
    ds_read_b64 v[16:17], v30 offset:5184
    s_mul_i32 s26, s30, 86016
    s_cmp_lt_u32 s30, 224
    s_cselect_b32 s26, s26, 0
    s_cselect_b32 s34, 19267584, 0
    buffer_load_dwordx4 v[168:171], v1, s[32:35], s26 offen
    s_add_u32 s30, s30, 1
    v_mov_b32 v1, v91
    s_setprio 0
    s_waitcnt lgkmcnt(8)
    v_smfmac_f32_16x16x64_bf16 v[248:251], v[212:215], v[108:115], v8
    v_smfmac_f32_16x16x64_bf16 v[248:251], v[216:219], v[116:123], v8
    v_add_f32 v54, v54, v244
    v_fmac_f32 v55, v244, v244
    v_add_f32 v54, v54, v245
    v_fmac_f32 v55, v245, v245
    v_add_f32 v54, v54, v246
    v_fmac_f32 v55, v246, v246
    v_add_f32 v54, v54, v247
    v_fmac_f32 v55, v247, v247
    v_smfmac_f32_16x16x32_bf16 v[248:251], v[220:221], v[124:127], v8
    s_waitcnt vmcnt(6)
    ds_write2_b64 v2, v[92:93], v[94:95] offset0:0 offset1:20
    ds_write2_b64 v2, v[96:97], v[98:99] offset0:40 offset1:60
    s_waitcnt lgkmcnt(5)
    v_smfmac_f32_16x16x64_bf16 v[252:255], v[222:225], v[132:139], v8
    v_smfmac_f32_16x16x64_bf16 v[252:255], v[226:229], v[140:147], v8
    s_nop 1
    v_add_f32 v54, v54, v248
    v_fmac_f32 v55, v248, v248
    v_add_f32 v54, v54, v249
    v_fmac_f32 v55, v249, v249
    v_add_f32 v54, v54, v250
    v_fmac_f32 v55, v250, v250
    v_add_f32 v54, v54, v251
    v_fmac_f32 v55, v251, v251
    v_smfmac_f32_16x16x32_bf16 v[252:255], v[230:231], v[148:151], v8
    s_waitcnt vmcnt(4)
    ds_write2_b64 v2, v[100:101], v[102:103] offset0:80 offset1:100
    ds_write2_b64 v2, v[104:105], v[106:107] offset0:120 offset1:140
    v_add_u32 v2, 31232, v2
    s_lshl_b32 s26, s20, 10
    v_add_u32 v108, s26, v0
    s_nop 1
    v_add_f32 v54, v54, v252
    v_fmac_f32 v55, v252, v252
    v_add_f32 v54, v54, v253
    v_fmac_f32 v55, v253, v253
    v_add_f32 v54, v54, v254
    v_fmac_f32 v55, v254, v254
    v_add_f32 v54, v54, v255
    v_fmac_f32 v55, v255, v255
    ds_write_b128 v108, v[52:55]
    ds_read_b64 v[52:53], v28 offset:10368
    ds_read_b64 v[54:55], v28 offset:10528
    ds_read_b64 v[56:57], v28 offset:12960
    ds_read_b64 v[58:59], v28 offset:13120
    v_mov_b32 v3, v86
    v_mov_b32 v4, v87
    v_mov_b32 v5, v88
    v_mov_b32 v6, v89
    s_waitcnt lgkmcnt(0)
    s_barrier
    s_setprio 3
    ds_read_b128 v[108:111], v0 offset:0
    ds_read_b128 v[112:115], v0 offset:1024
    ds_read_b128 v[116:119], v0 offset:2048
    ds_read_b128 v[120:123], v0 offset:3072
    ds_read_b128 v[124:127], v0 offset:4096
    ds_read_b128 v[128:131], v0 offset:5120
    ds_read_b128 v[132:135], v0 offset:6144
    ds_read_b128 v[136:139], v0 offset:7168
    s_waitcnt lgkmcnt(0)
    v_pk_add_f32 v[108:109], v[108:109], v[112:113]
    v_pk_add_f32 v[110:111], v[110:111], v[114:115]
    v_pk_add_f32 v[116:117], v[116:117], v[120:121]
    v_pk_add_f32 v[118:119], v[118:119], v[122:123]
    v_pk_add_f32 v[124:125], v[124:125], v[128:129]
    v_pk_add_f32 v[126:127], v[126:127], v[130:131]
    v_pk_add_f32 v[132:133], v[132:133], v[136:137]
    v_pk_add_f32 v[134:135], v[134:135], v[138:139]
    v_pk_add_f32 v[108:109], v[108:109], v[116:117]
    v_pk_add_f32 v[110:111], v[110:111], v[118:119]
    v_pk_add_f32 v[124:125], v[124:125], v[132:133]
    v_pk_add_f32 v[126:127], v[126:127], v[134:135]
    v_pk_add_f32 v[24:25], v[108:109], v[124:125]
    v_pk_add_f32 v[26:27], v[110:111], v[126:127]
    v_mul_f32 v24, s18, v24
    v_mul_f32 v25, s18, v25
    v_mul_f32 v26, s18, v26
    v_mul_f32 v27, s18, v27
    v_fma_f32 v25, -v24, v24, v25
    v_fma_f32 v27, -v26, v26, v27
    v_max_f32 v25, 0, v25
    v_max_f32 v27, 0, v27
    v_add_f32 v25, 0x3727c5ac, v25
    v_add_f32 v27, 0x3727c5ac, v27
    v_rsq_f32 v25, v25
    v_rsq_f32 v27, v27
    v_mul_f32 v25, 0x3eeff558, v25
    v_mul_f32 v27, 0x3eeff558, v27
    v_mul_f32_e64 v24, -v24, v25
    v_mul_f32_e64 v26, -v26, v27
    s_cmp_eq_u32 s23, 0
    s_cbranch_scc1 L_ln0Q
    v_pk_fma_f32 v[60:61], v[60:61], v[24:25], v[24:25] op_sel:[0,1,0] op_sel_hi:[1,1,0]
    v_pk_fma_f32 v[62:63], v[62:63], v[24:25], v[24:25] op_sel:[0,1,0] op_sel_hi:[1,1,0]
    v_pk_fma_f32 v[64:65], v[64:65], v[24:25], v[24:25] op_sel:[0,1,0] op_sel_hi:[1,1,0]
    v_pk_fma_f32 v[66:67], v[66:67], v[24:25], v[24:25] op_sel:[0,1,0] op_sel_hi:[1,1,0]
    v_cvt_pk_bf16_f32 v60, v60, v61
    v_cvt_pk_bf16_f32 v61, v62, v63
    v_cvt_pk_bf16_f32 v62, v64, v65
    v_cvt_pk_bf16_f32 v63, v66, v67
    ds_write_b128 v84, v[60:63] offset:0
    v_pk_fma_f32 v[68:69], v[68:69], v[24:25], v[24:25] op_sel:[0,1,0] op_sel_hi:[1,1,0]
    v_pk_fma_f32 v[70:71], v[70:71], v[24:25], v[24:25] op_sel:[0,1,0] op_sel_hi:[1,1,0]
    v_pk_fma_f32 v[72:73], v[72:73], v[24:25], v[24:25] op_sel:[0,1,0] op_sel_hi:[1,1,0]
    v_pk_fma_f32 v[74:75], v[74:75], v[24:25], v[24:25] op_sel:[0,1,0] op_sel_hi:[1,1,0]
    v_cvt_pk_bf16_f32 v68, v68, v69
    v_cvt_pk_bf16_f32 v69, v70, v71
    v_cvt_pk_bf16_f32 v70, v72, v73
    v_cvt_pk_bf16_f32 v71, v74, v75
    ds_write_b128 v84, v[68:71] offset:256
    v_pk_fma_f32 v[76:77], v[76:77], v[24:25], v[24:25] op_sel:[0,1,0] op_sel_hi:[1,1,0]
    v_pk_fma_f32 v[78:79], v[78:79], v[24:25], v[24:25] op_sel:[0,1,0] op_sel_hi:[1,1,0]
    v_pk_fma_f32 v[80:81], v[80:81], v[24:25], v[24:25] op_sel:[0,1,0] op_sel_hi:[1,1,0]
    v_pk_fma_f32 v[82:83], v[82:83], v[24:25], v[24:25] op_sel:[0,1,0] op_sel_hi:[1,1,0]
    v_cvt_pk_bf16_f32 v76, v76, v77
    v_cvt_pk_bf16_f32 v77, v78, v79
    v_cvt_pk_bf16_f32 v78, v80, v81
    v_cvt_pk_bf16_f32 v79, v82, v83
    ds_write_b128 v84, v[76:79] offset:512
L_ln0Q:
    v_pk_fma_f32 v[232:233], v[232:233], v[26:27], v[26:27] op_sel:[0,1,0] op_sel_hi:[1,1,0]
    v_pk_fma_f32 v[234:235], v[234:235], v[26:27], v[26:27] op_sel:[0,1,0] op_sel_hi:[1,1,0]
    v_pk_fma_f32 v[236:237], v[236:237], v[26:27], v[26:27] op_sel:[0,1,0] op_sel_hi:[1,1,0]
    v_pk_fma_f32 v[238:239], v[238:239], v[26:27], v[26:27] op_sel:[0,1,0] op_sel_hi:[1,1,0]
    v_cvt_pk_bf16_f32 v232, v232, v233
    v_cvt_pk_bf16_f32 v233, v234, v235
    v_cvt_pk_bf16_f32 v234, v236, v237
    v_cvt_pk_bf16_f32 v235, v238, v239
    ds_write_b128 v85, v[232:235] offset:0
    v_pk_fma_f32 v[240:241], v[240:241], v[26:27], v[26:27] op_sel:[0,1,0] op_sel_hi:[1,1,0]
    v_pk_fma_f32 v[242:243], v[242:243], v[26:27], v[26:27] op_sel:[0,1,0] op_sel_hi:[1,1,0]
    v_pk_fma_f32 v[244:245], v[244:245], v[26:27], v[26:27] op_sel:[0,1,0] op_sel_hi:[1,1,0]
    v_pk_fma_f32 v[246:247], v[246:247], v[26:27], v[26:27] op_sel:[0,1,0] op_sel_hi:[1,1,0]
    v_cvt_pk_bf16_f32 v240, v240, v241
    v_cvt_pk_bf16_f32 v241, v242, v243
    v_cvt_pk_bf16_f32 v242, v244, v245
    v_cvt_pk_bf16_f32 v243, v246, v247
    ds_write_b128 v85, v[240:243] offset:256
    v_pk_fma_f32 v[248:249], v[248:249], v[26:27], v[26:27] op_sel:[0,1,0] op_sel_hi:[1,1,0]
    v_pk_fma_f32 v[250:251], v[250:251], v[26:27], v[26:27] op_sel:[0,1,0] op_sel_hi:[1,1,0]
    v_pk_fma_f32 v[252:253], v[252:253], v[26:27], v[26:27] op_sel:[0,1,0] op_sel_hi:[1,1,0]
    v_pk_fma_f32 v[254:255], v[254:255], v[26:27], v[26:27] op_sel:[0,1,0] op_sel_hi:[1,1,0]
    v_cvt_pk_bf16_f32 v248, v248, v249
    v_cvt_pk_bf16_f32 v249, v250, v251
    v_cvt_pk_bf16_f32 v250, v252, v253
    v_cvt_pk_bf16_f32 v251, v254, v255
    ds_write_b128 v85, v[248:251] offset:512
    s_waitcnt vmcnt(0)
    ds_write2_b64 v2, v[156:157], v[158:159] offset0:0 offset1:20
    ds_write2_b64 v2, v[160:161], v[162:163] offset0:40 offset1:60
    ds_write2_b64 v2, v[164:165], v[166:167] offset0:80 offset1:100
    ds_write2_b64 v2, v[168:169], v[170:171] offset0:120 offset1:140
    s_waitcnt lgkmcnt(0)
    s_barrier
    ds_read_b128 v[108:111], v3 offset:0
    ds_read_b128 v[112:115], v4 offset:0
    ds_read_b128 v[116:119], v5 offset:0
    ds_read_b128 v[120:123], v6 offset:0
    ds_read_b128 v[124:127], v3 offset:31232
    ds_read_b128 v[128:131], v4 offset:31232
    ds_read_b128 v[132:135], v3 offset:160
    ds_read_b128 v[136:139], v4 offset:160
    ds_read_b128 v[140:143], v5 offset:160
    ds_read_b128 v[144:147], v6 offset:160
    ds_read_b128 v[148:151], v3 offset:31392
    ds_read_b128 v[152:155], v4 offset:31392
    v_mov_b64 v[60:61], 0
    v_mov_b64 v[62:63], 0
    v_mov_b64 v[64:65], 0
    v_mov_b64 v[66:67], 0
    v_mov_b64 v[232:233], 0
    v_mov_b64 v[234:235], 0
    v_mov_b64 v[236:237], 0
    v_mov_b64 v[238:239], 0
    s_setprio 2
    s_waitcnt lgkmcnt(6)
    v_smfmac_f32_16x16x64_bf16 v[60:63], v[172:175], v[108:115], v8
    v_smfmac_f32_16x16x64_bf16 v[60:63], v[176:179], v[116:123], v8
    v_smfmac_f32_16x16x64_bf16 v[232:235], v[172:175], v[112:119], v8
    v_smfmac_f32_16x16x64_bf16 v[232:235], v[176:179], v[120:127], v8
    ds_read_b128 v[108:111], v3 offset:1296
    ds_read_b128 v[112:115], v4 offset:1296
    ds_read_b128 v[116:119], v5 offset:1296
    ds_read_b128 v[120:123], v6 offset:1296
    v_mov_b64 v[68:69], 0
    v_mov_b64 v[70:71], 0
    v_mov_b64 v[240:241], 0
    v_mov_b64 v[242:243], 0
    v_smfmac_f32_16x16x32_bf16 v[60:63], v[180:181], v[124:127], v8
    v_smfmac_f32_16x16x32_bf16 v[232:235], v[180:181], v[128:131], v8
    ds_read_b128 v[124:127], v3 offset:32528
    ds_read_b128 v[128:131], v4 offset:32528
    s_lshr_b32 s52, s20, 2
    s_mul_i32 s53, s52, 12288
    s_add_u32 s53, s53, s67
    s_lshl_b32 s52, s52, 6
    s_add_u32 s52, s52, s65
    s_add_u32 m0, s53, 124928
    s_add_u32 s69, s52, 0
    buffer_load_dwordx4 v7, s[40:43], s69 offen lds
    s_waitcnt lgkmcnt(6)
    v_smfmac_f32_16x16x64_bf16 v[64:67], v[182:185], v[132:139], v8
    v_smfmac_f32_16x16x64_bf16 v[64:67], v[186:189], v[140:147], v8
    v_smfmac_f32_16x16x64_bf16 v[236:239], v[182:185], v[136:143], v8
    v_smfmac_f32_16x16x64_bf16 v[236:239], v[186:189], v[144:151], v8
    ds_read_b128 v[132:135], v3 offset:1456
    ds_read_b128 v[136:139], v4 offset:1456
    ds_read_b128 v[140:143], v5 offset:1456
    ds_read_b128 v[144:147], v6 offset:1456
    v_mov_b64 v[72:73], 0
    v_mov_b64 v[74:75], 0
    v_mov_b64 v[244:245], 0
    v_mov_b64 v[246:247], 0
    v_mov_b32 v20, v60
    v_mul_f32 v21, v60, v60
    v_add_f32 v20, v20, v61
    v_fmac_f32 v21, v61, v61
    v_add_f32 v20, v20, v62
    v_fmac_f32 v21, v62, v62
    v_add_f32 v20, v20, v63
    v_fmac_f32 v21, v63, v63
    v_smfmac_f32_16x16x32_bf16 v[64:67], v[190:191], v[148:151], v8
    v_smfmac_f32_16x16x32_bf16 v[236:239], v[190:191], v[152:155], v8
    ds_read_b128 v[148:151], v3 offset:32688
    ds_read_b128 v[152:155], v4 offset:32688
    s_add_u32 m0, s53, 125952
    s_add_u32 s69, s52, 24576
    buffer_load_dwordx4 v7, s[40:43], s69 offen lds
    v_mov_b32 v22, v232
    v_mul_f32 v23, v232, v232
    v_add_f32 v22, v22, v233
    v_fmac_f32 v23, v233, v233
    v_add_f32 v22, v22, v234
    v_fmac_f32 v23, v234, v234
    v_add_f32 v22, v22, v235
    v_fmac_f32 v23, v235, v235
    s_setprio 1
    s_waitcnt lgkmcnt(6)
    v_smfmac_f32_16x16x64_bf16 v[68:71], v[192:195], v[108:115], v8
    v_smfmac_f32_16x16x64_bf16 v[68:71], v[196:199], v[116:123], v8
    v_smfmac_f32_16x16x64_bf16 v[240:243], v[192:195], v[112:119], v8
    v_smfmac_f32_16x16x64_bf16 v[240:243], v[196:199], v[120:127], v8
    ds_read_b128 v[108:111], v3 offset:2592
    ds_read_b128 v[112:115], v4 offset:2592
    ds_read_b128 v[116:119], v5 offset:2592
    ds_read_b128 v[120:123], v6 offset:2592
    v_mov_b64 v[76:77], 0
    v_mov_b64 v[78:79], 0
    v_mov_b64 v[248:249], 0
    v_mov_b64 v[250:251], 0
    v_add_f32 v20, v20, v64
    v_fmac_f32 v21, v64, v64
    v_add_f32 v20, v20, v65
    v_fmac_f32 v21, v65, v65
    v_add_f32 v20, v20, v66
    v_fmac_f32 v21, v66, v66
    v_add_f32 v20, v20, v67
    v_fmac_f32 v21, v67, v67
    v_smfmac_f32_16x16x32_bf16 v[68:71], v[200:201], v[124:127], v8
    v_smfmac_f32_16x16x32_bf16 v[240:243], v[200:201], v[128:131], v8
    ds_read_b128 v[124:127], v3 offset:33824
    ds_read_b128 v[128:131], v4 offset:33824
    s_add_u32 m0, s53, 126976
    s_add_u32 s69, s52, 49152
    buffer_load_dwordx4 v7, s[40:43], s69 offen lds
    v_add_f32 v22, v22, v236
    v_fmac_f32 v23, v236, v236
    v_add_f32 v22, v22, v237
    v_fmac_f32 v23, v237, v237
    v_add_f32 v22, v22, v238
    v_fmac_f32 v23, v238, v238
    v_add_f32 v22, v22, v239
    v_fmac_f32 v23, v239, v239
    s_waitcnt lgkmcnt(6)
    v_smfmac_f32_16x16x64_bf16 v[72:75], v[202:205], v[132:139], v8
    v_smfmac_f32_16x16x64_bf16 v[72:75], v[206:209], v[140:147], v8
    v_smfmac_f32_16x16x64_bf16 v[244:247], v[202:205], v[136:143], v8
    v_smfmac_f32_16x16x64_bf16 v[244:247], v[206:209], v[144:151], v8
    ds_read_b128 v[132:135], v3 offset:2752
    ds_read_b128 v[136:139], v4 offset:2752
    ds_read_b128 v[140:143], v5 offset:2752
    ds_read_b128 v[144:147], v6 offset:2752
    v_mov_b64 v[80:81], 0
    v_mov_b64 v[82:83], 0
    v_mov_b64 v[252:253], 0
    v_mov_b64 v[254:255], 0
    v_add_f32 v20, v20, v68
    v_fmac_f32 v21, v68, v68
    v_add_f32 v20, v20, v69
    v_fmac_f32 v21, v69, v69
    v_add_f32 v20, v20, v70
    v_fmac_f32 v21, v70, v70
    v_add_f32 v20, v20, v71
    v_fmac_f32 v21, v71, v71
    v_smfmac_f32_16x16x32_bf16 v[72:75], v[210:211], v[148:151], v8
    v_smfmac_f32_16x16x32_bf16 v[244:247], v[210:211], v[152:155], v8
    ds_read_b128 v[148:151], v3 offset:33984
    ds_read_b128 v[152:155], v4 offset:33984
    ds_read_b64 v[84:85], v28 offset:31232
    ds_read_b64 v[86:87], v28 offset:31392
    ds_read_b64 v[88:89], v28 offset:33824
    ds_read_b64 v[90:91], v28 offset:33984
    ds_read_b64 v[92:93], v28 offset:36416
    ds_read_b64 v[94:95], v28 offset:36576
    v_add_f32 v22, v22, v240
    v_fmac_f32 v23, v240, v240
    v_add_f32 v22, v22, v241
    v_fmac_f32 v23, v241, v241
    v_add_f32 v22, v22, v242
    v_fmac_f32 v23, v242, v242
    v_add_f32 v22, v22, v243
    v_fmac_f32 v23, v243, v243
    s_setprio 0
    s_waitcnt lgkmcnt(12)
    v_smfmac_f32_16x16x64_bf16 v[76:79], v[212:215], v[108:115], v8
    v_smfmac_f32_16x16x64_bf16 v[76:79], v[216:219], v[116:123], v8
    v_smfmac_f32_16x16x64_bf16 v[248:251], v[212:215], v[112:119], v8
    v_smfmac_f32_16x16x64_bf16 v[248:251], v[216:219], v[120:127], v8
    v_add_f32 v20, v20, v72
    v_fmac_f32 v21, v72, v72
    v_add_f32 v20, v20, v73
    v_fmac_f32 v21, v73, v73
    v_add_f32 v20, v20, v74
    v_fmac_f32 v21, v74, v74
    v_add_f32 v20, v20, v75
    v_fmac_f32 v21, v75, v75
    v_smfmac_f32_16x16x32_bf16 v[76:79], v[220:221], v[124:127], v8
    v_smfmac_f32_16x16x32_bf16 v[248:251], v[220:221], v[128:131], v8
    ds_read_b64 v[96:97], v28 offset:39008
    ds_read_b64 v[98:99], v28 offset:39168
    ds_read_b64 v[100:101], v28 offset:41600
    ds_read_b64 v[102:103], v28 offset:41760
    ds_read_b64 v[104:105], v28 offset:44192
    ds_read_b64 v[106:107], v28 offset:44352
    v_add_f32 v22, v22, v244
    v_fmac_f32 v23, v244, v244
    v_add_f32 v22, v22, v245
    v_fmac_f32 v23, v245, v245
    v_add_f32 v22, v22, v246
    v_fmac_f32 v23, v246, v246
    v_add_f32 v22, v22, v247
    v_fmac_f32 v23, v247, v247
    s_waitcnt lgkmcnt(12)
    v_smfmac_f32_16x16x64_bf16 v[80:83], v[222:225], v[132:139], v8
    v_smfmac_f32_16x16x64_bf16 v[80:83], v[226:229], v[140:147], v8
    v_smfmac_f32_16x16x64_bf16 v[252:255], v[222:225], v[136:143], v8
    v_smfmac_f32_16x16x64_bf16 v[252:255], v[226:229], v[144:151], v8
    v_add_f32 v20, v20, v76
    v_fmac_f32 v21, v76, v76
    v_add_f32 v20, v20, v77
    v_fmac_f32 v21, v77, v77
    v_add_f32 v20, v20, v78
    v_fmac_f32 v21, v78, v78
    v_add_f32 v20, v20, v79
    v_fmac_f32 v21, v79, v79
    v_smfmac_f32_16x16x32_bf16 v[80:83], v[230:231], v[148:151], v8
    v_smfmac_f32_16x16x32_bf16 v[252:255], v[230:231], v[152:155], v8
    v_add_f32 v22, v22, v248
    v_fmac_f32 v23, v248, v248
    v_add_f32 v22, v22, v249
    v_fmac_f32 v23, v249, v249
    v_add_f32 v22, v22, v250
    v_fmac_f32 v23, v250, v250
    v_add_f32 v22, v22, v251
    v_fmac_f32 v23, v251, v251
    s_lshl_b32 s26, s20, 10
    v_add_u32 v108, s26, v0
    v_add_f32 v20, v20, v80
    v_fmac_f32 v21, v80, v80
    v_add_f32 v20, v20, v81
    v_fmac_f32 v21, v81, v81
    v_add_f32 v20, v20, v82
    v_fmac_f32 v21, v82, v82
    v_add_f32 v20, v20, v83
    v_fmac_f32 v21, v83, v83
    v_add_f32 v22, v22, v252
    v_fmac_f32 v23, v252, v252
    v_add_f32 v22, v22, v253
    v_fmac_f32 v23, v253, v253
    v_add_f32 v22, v22, v254
    v_fmac_f32 v23, v254, v254
    v_add_f32 v22, v22, v255
    v_fmac_f32 v23, v255, v255
    ds_write_b128 v108, v[20:23]
    v_add_u32 v28, 62464, v28
    ds_read_b64 v[148:149], v28 offset:0
    ds_read_b64 v[150:151], v28 offset:160
    ds_read_b64 v[152:153], v28 offset:2592
    ds_read_b64 v[154:155], v28 offset:2752
    ds_read_b64 v[156:157], v28 offset:5184
    ds_read_b64 v[158:159], v28 offset:5344
    ds_read_b64 v[160:161], v28 offset:7776
    ds_read_b64 v[162:163], v28 offset:7936
    ds_read_b64 v[164:165], v28 offset:10368
    ds_read_b64 v[166:167], v28 offset:10528
    ds_read_b64 v[168:169], v28 offset:12960
    ds_read_b64 v[170:171], v28 offset:13120
    s_waitcnt vmcnt(0) lgkmcnt(0)
    s_barrier
    s_and_b32 s26, s20, 3
    v_lshrrev_b32 v10, 3, v9
    v_mul_u32_u24 v8, 384, v10
    v_bfe_u32 v10, v9, 4, 1
    v_lshlrev_b32 v10, 2, v10
    v_xor_b32 v10, v10, v9
    s_and_b32 s27, s26, 1
    s_lshl_b32 s27, s27, 1
    v_xor_b32 v10, s27, v10
    v_and_b32 v10, 7, v10
    v_lshl_add_u32 v8, v10, 4, v8
    s_mul_i32 s66, s26, 3072
    s_lshl_b32 s68, s26, 10
    s_add_u32 s71, s66, 294912
    s_mul_i32 s31, s29, 12288
    s_add_u32 s66, s66, s31
    s_add_u32 m0, s68, 87296
    s_add_u32 s69, s66, 0
    buffer_load_dwordx4 v8, s[44:47], s69 offen lds
    s_add_u32 m0, s68, 91392
    s_add_u32 s69, s66, 128
    buffer_load_dwordx4 v8, s[44:47], s69 offen lds
    s_add_u32 m0, s68, 95488
    s_add_u32 s69, s66, 256
    buffer_load_dwordx4 v8, s[44:47], s69 offen lds
    s_setprio 3
    ds_read_b128 v[108:111], v0 offset:0
    ds_read_b128 v[112:115], v0 offset:1024
    ds_read_b128 v[116:119], v0 offset:2048
    ds_read_b128 v[120:123], v0 offset:3072
    ds_read_b128 v[124:127], v0 offset:4096
    ds_read_b128 v[128:131], v0 offset:5120
    ds_read_b128 v[132:135], v0 offset:6144
    ds_read_b128 v[136:139], v0 offset:7168
    s_waitcnt lgkmcnt(0)
    v_pk_add_f32 v[108:109], v[108:109], v[112:113]
    v_pk_add_f32 v[110:111], v[110:111], v[114:115]
    v_pk_add_f32 v[116:117], v[116:117], v[120:121]
    v_pk_add_f32 v[118:119], v[118:119], v[122:123]
    v_pk_add_f32 v[124:125], v[124:125], v[128:129]
    v_pk_add_f32 v[126:127], v[126:127], v[130:131]
    v_pk_add_f32 v[132:133], v[132:133], v[136:137]
    v_pk_add_f32 v[134:135], v[134:135], v[138:139]
    v_pk_add_f32 v[108:109], v[108:109], v[116:117]
    v_pk_add_f32 v[110:111], v[110:111], v[118:119]
    v_pk_add_f32 v[124:125], v[124:125], v[132:133]
    v_pk_add_f32 v[126:127], v[126:127], v[134:135]
    v_pk_add_f32 v[140:141], v[108:109], v[124:125]
    v_pk_add_f32 v[142:143], v[110:111], v[126:127]
    v_mul_f32 v140, s18, v140
    v_mul_f32 v141, s18, v141
    v_mul_f32 v142, s18, v142
    v_mul_f32 v143, s18, v143
    v_fma_f32 v141, -v140, v140, v141
    v_fma_f32 v143, -v142, v142, v143
    v_max_f32 v141, 0, v141
    v_max_f32 v143, 0, v143
    v_add_f32 v141, 0x3727c5ac, v141
    v_add_f32 v143, 0x3727c5ac, v143
    v_rsq_f32 v141, v141
    v_rsq_f32 v143, v143
    v_mul_f32 v141, 0x3eeff558, v141
    v_mul_f32 v143, 0x3eeff558, v143
    v_mul_f32_e64 v140, -v140, v141
    v_mul_f32_e64 v142, -v142, v143
    v_pk_fma_f32 v[60:61], v[60:61], v[140:141], v[140:141] op_sel:[0,1,0] op_sel_hi:[1,1,0]
    v_pk_fma_f32 v[62:63], v[62:63], v[140:141], v[140:141] op_sel:[0,1,0] op_sel_hi:[1,1,0]
    v_pk_fma_f32 v[64:65], v[64:65], v[140:141], v[140:141] op_sel:[0,1,0] op_sel_hi:[1,1,0]
    v_pk_fma_f32 v[66:67], v[66:67], v[140:141], v[140:141] op_sel:[0,1,0] op_sel_hi:[1,1,0]
    v_cvt_pk_bf16_f32 v60, v60, v61
    v_cvt_pk_bf16_f32 v61, v62, v63
    v_cvt_pk_bf16_f32 v62, v64, v65
    v_cvt_pk_bf16_f32 v63, v66, v67
    ds_write_b128 v1, v[60:63] offset:0
    v_lshlrev_b32 v172, 16, v12
    v_and_b32 v173, 0xffff0000, v12
    v_lshlrev_b32 v174, 16, v13
    v_and_b32 v175, 0xffff0000, v13
    v_lshlrev_b32 v176, 16, v14
    v_and_b32 v177, 0xffff0000, v14
    v_lshlrev_b32 v178, 16, v15
    v_and_b32 v179, 0xffff0000, v15
    v_lshlrev_b32 v180, 16, v16
    v_and_b32 v181, 0xffff0000, v16
    v_pk_fma_f32 v[68:69], v[68:69], v[140:141], v[140:141] op_sel:[0,1,0] op_sel_hi:[1,1,0]
    v_pk_fma_f32 v[70:71], v[70:71], v[140:141], v[140:141] op_sel:[0,1,0] op_sel_hi:[1,1,0]
    v_pk_fma_f32 v[72:73], v[72:73], v[140:141], v[140:141] op_sel:[0,1,0] op_sel_hi:[1,1,0]
    v_pk_fma_f32 v[74:75], v[74:75], v[140:141], v[140:141] op_sel:[0,1,0] op_sel_hi:[1,1,0]
    v_cvt_pk_bf16_f32 v68, v68, v69
    v_cvt_pk_bf16_f32 v69, v70, v71
    v_cvt_pk_bf16_f32 v70, v72, v73
    v_cvt_pk_bf16_f32 v71, v74, v75
    ds_write_b128 v1, v[68:71] offset:256
    v_lshlrev_b32 v182, 16, v17
    v_and_b32 v183, 0xffff0000, v17
    v_lshlrev_b32 v12, 16, v36
    v_and_b32 v13, 0xffff0000, v36
    v_lshlrev_b32 v14, 16, v37
    v_and_b32 v15, 0xffff0000, v37
    v_lshlrev_b32 v16, 16, v38
    v_and_b32 v17, 0xffff0000, v38
    v_lshlrev_b32 v18, 16, v39
    v_and_b32 v19, 0xffff0000, v39
    v_pk_fma_f32 v[76:77], v[76:77], v[140:141], v[140:141] op_sel:[0,1,0] op_sel_hi:[1,1,0]
    v_pk_fma_f32 v[78:79], v[78:79], v[140:141], v[140:141] op_sel:[0,1,0] op_sel_hi:[1,1,0]
    v_pk_fma_f32 v[80:81], v[80:81], v[140:141], v[140:141] op_sel:[0,1,0] op_sel_hi:[1,1,0]
    v_pk_fma_f32 v[82:83], v[82:83], v[140:141], v[140:141] op_sel:[0,1,0] op_sel_hi:[1,1,0]
    v_cvt_pk_bf16_f32 v76, v76, v77
    v_cvt_pk_bf16_f32 v77, v78, v79
    v_cvt_pk_bf16_f32 v78, v80, v81
    v_cvt_pk_bf16_f32 v79, v82, v83
    ds_write_b128 v1, v[76:79] offset:512
    v_lshlrev_b32 v20, 16, v40
    v_and_b32 v21, 0xffff0000, v40
    v_lshlrev_b32 v22, 16, v41
    v_and_b32 v23, 0xffff0000, v41
    v_lshlrev_b32 v24, 16, v42
    v_and_b32 v25, 0xffff0000, v42
    v_lshlrev_b32 v26, 16, v43
    v_and_b32 v27, 0xffff0000, v43
    v_lshlrev_b32 v28, 16, v44
    v_and_b32 v29, 0xffff0000, v44
    v_pk_fma_f32 v[232:233], v[232:233], v[142:143], v[142:143] op_sel:[0,1,0] op_sel_hi:[1,1,0]
    v_pk_fma_f32 v[234:235], v[234:235], v[142:143], v[142:143] op_sel:[0,1,0] op_sel_hi:[1,1,0]
    v_pk_fma_f32 v[236:237], v[236:237], v[142:143], v[142:143] op_sel:[0,1,0] op_sel_hi:[1,1,0]
    v_pk_fma_f32 v[238:239], v[238:239], v[142:143], v[142:143] op_sel:[0,1,0] op_sel_hi:[1,1,0]
    v_cvt_pk_bf16_f32 v232, v232, v233
    v_cvt_pk_bf16_f32 v233, v234, v235
    v_cvt_pk_bf16_f32 v234, v236, v237
    v_cvt_pk_bf16_f32 v235, v238, v239
    ds_write_b128 v1, v[232:235] offset:6176
    v_lshlrev_b32 v30, 16, v45
    v_and_b32 v31, 0xffff0000, v45
    v_lshlrev_b32 v32, 16, v46
    v_and_b32 v33, 0xffff0000, v46
    v_lshlrev_b32 v34, 16, v47
    v_and_b32 v35, 0xffff0000, v47
    v_lshlrev_b32 v36, 16, v48
    v_and_b32 v37, 0xffff0000, v48
    v_lshlrev_b32 v38, 16, v49
    v_and_b32 v39, 0xffff0000, v49
    v_pk_fma_f32 v[240:241], v[240:241], v[142:143], v[142:143] op_sel:[0,1,0] op_sel_hi:[1,1,0]
    v_pk_fma_f32 v[242:243], v[242:243], v[142:143], v[142:143] op_sel:[0,1,0] op_sel_hi:[1,1,0]
    v_pk_fma_f32 v[244:245], v[244:245], v[142:143], v[142:143] op_sel:[0,1,0] op_sel_hi:[1,1,0]
    v_pk_fma_f32 v[246:247], v[246:247], v[142:143], v[142:143] op_sel:[0,1,0] op_sel_hi:[1,1,0]
    v_cvt_pk_bf16_f32 v240, v240, v241
    v_cvt_pk_bf16_f32 v241, v242, v243
    v_cvt_pk_bf16_f32 v242, v244, v245
    v_cvt_pk_bf16_f32 v243, v246, v247
    ds_write_b128 v1, v[240:243] offset:6432
    v_lshlrev_b32 v40, 16, v50
    v_and_b32 v41, 0xffff0000, v50
    v_lshlrev_b32 v42, 16, v51
    v_and_b32 v43, 0xffff0000, v51
    v_lshlrev_b32 v44, 16, v52
    v_and_b32 v45, 0xffff0000, v52
    v_lshlrev_b32 v46, 16, v53
    v_and_b32 v47, 0xffff0000, v53
    v_lshlrev_b32 v48, 16, v54
    v_and_b32 v49, 0xffff0000, v54
    v_pk_fma_f32 v[248:249], v[248:249], v[142:143], v[142:143] op_sel:[0,1,0] op_sel_hi:[1,1,0]
    v_pk_fma_f32 v[250:251], v[250:251], v[142:143], v[142:143] op_sel:[0,1,0] op_sel_hi:[1,1,0]
    v_pk_fma_f32 v[252:253], v[252:253], v[142:143], v[142:143] op_sel:[0,1,0] op_sel_hi:[1,1,0]
    v_pk_fma_f32 v[254:255], v[254:255], v[142:143], v[142:143] op_sel:[0,1,0] op_sel_hi:[1,1,0]
    v_cvt_pk_bf16_f32 v248, v248, v249
    v_cvt_pk_bf16_f32 v249, v250, v251
    v_cvt_pk_bf16_f32 v250, v252, v253
    v_cvt_pk_bf16_f32 v251, v254, v255
    ds_write_b128 v1, v[248:251] offset:6688
    v_lshlrev_b32 v50, 16, v55
    v_and_b32 v51, 0xffff0000, v55
    v_lshlrev_b32 v52, 16, v56
    v_and_b32 v53, 0xffff0000, v56
    v_lshlrev_b32 v54, 16, v57
    v_and_b32 v55, 0xffff0000, v57
    v_lshlrev_b32 v56, 16, v58
    v_and_b32 v57, 0xffff0000, v58
    v_lshlrev_b32 v58, 16, v59
    v_and_b32 v59, 0xffff0000, v59
    s_waitcnt lgkmcnt(0)
    s_barrier
    s_add_u32 s65, s65, 64
    s_cmp_eq_u32 s65, s70
    s_cselect_b32 s69, 1536, 0
    s_sub_u32 s65, s65, s69
    s_add_u32 s65, s65, 64
    s_cmp_eq_u32 s65, s70
    s_cselect_b32 s69, 1536, 0
    s_sub_u32 s65, s65, s69
    s_add_u32 m0, s67, 112640
    s_add_u32 s69, s65, 0
    buffer_load_dwordx4 v7, s[40:43], s69 offen lds
    s_add_u32 m0, s67, 113664
    s_add_u32 s69, s65, 24576
    buffer_load_dwordx4 v7, s[40:43], s69 offen lds
    s_add_u32 m0, s67, 114688
    s_add_u32 s69, s65, 49152
    buffer_load_dwordx4 v7, s[40:43], s69 offen lds
    s_add_u32 s65, s65, 64
    s_cmp_eq_u32 s65, s70
    s_cselect_b32 s69, 1536, 0
    s_sub_u32 s65, s65, s69
    s_add_u32 s66, s66, 12288
    s_cmp_eq_u32 s66, s71
    s_cselect_b32 s69, 294912, 0
    s_sub_u32 s66, s66, s69
    s_add_u32 m0, s68, 99584
    s_add_u32 s69, s66, 0
    buffer_load_dwordx4 v8, s[44:47], s69 offen lds
    s_add_u32 m0, s68, 103680
    s_add_u32 s69, s66, 128
    buffer_load_dwordx4 v8, s[44:47], s69 offen lds
    s_add_u32 m0, s68, 107776
    s_add_u32 s69, s66, 256
    buffer_load_dwordx4 v8, s[44:47], s69 offen lds
    s_add_u32 s66, s66, 12288
    s_cmp_eq_u32 s66, s71
    s_cselect_b32 s69, 294912, 0
    s_sub_u32 s66, s66, s69
    v_bfe_u32 v10, v9, 2, 2
    v_lshlrev_b32 v1, 7, v10
    v_lshrrev_b32 v10, 1, v10
    v_lshl_add_u32 v1, v10, 6, v1
    v_mov_b32 v3, v1
    v_lshrrev_b32 v10, 5, v9
    v_lshl_add_u32 v1, v10, 10, v1
    v_lshrrev_b32 v11, 4, v9
    v_xor_b32 v10, v10, v11
    v_and_b32 v10, 1, v10
    v_lshl_add_u32 v1, v10, 5, v1
    v_and_b32 v10, 1, v9
    v_lshl_add_u32 v1, v10, 4, v1
    v_bfe_u32 v10, v9, 1, 1
    v_lshl_add_u32 v1, v10, 3, v1
    s_lshl_b32 s26, s25, 6
    v_xor_b32 v1, s26, v1
    v_xor_b32 v2, 64, v1
    s_lshl_b32 s26, s25, 12
    s_add_u32 s27, s26, 75008
    v_add_u32 v1, s27, v1
    s_add_u32 s27, s27, s26
    v_add_u32 v2, s27, v2
    v_lshl_add_u32 v3, v11, 10, v3
    v_and_b32 v10, 1, v11
    v_lshl_add_u32 v3, v10, 5, v3
    v_and_b32 v10, 3, v9
    v_lshl_add_u32 v3, v10, 3, v3
    s_and_b32 s26, s20, 3
    s_mul_i32 s26, s26, 96
    s_add_u32 s27, s26, 64
    s_and_b32 s28, s27, 127
    s_lshr_b32 s27, s27, 7
    s_lshl_b32 s27, s27, 12
    s_add_u32 s27, s27, 75008
    v_xor_b32 v5, s28, v3
    v_add_u32 v5, s27, v5
    s_add_u32 s27, s26, 32
    s_and_b32 s28, s27, 127
    s_lshr_b32 s27, s27, 7
    s_lshl_b32 s27, s27, 12
    s_add_u32 s27, s27, 75008
    v_xor_b32 v4, s28, v3
    v_add_u32 v4, s27, v4
    s_add_u32 s27, s26, 0
    s_and_b32 s28, s27, 127
    s_lshr_b32 s27, s27, 7
    s_lshl_b32 s27, s27, 12
    s_add_u32 s27, s27, 75008
    v_xor_b32 v3, s28, v3
    v_add_u32 v3, s27, v3
    s_lshl_b32 s26, s24, 11
    s_add_u32 s26, s26, 0
    v_lshlrev_b32 v10, 4, v9
    v_add_u32 v0, 12288, v10
    v_and_b32 v10, 15, v9
    v_lshlrev_b32 v10, 4, v10
    v_bfe_u32 v11, v9, 4, 1
    v_lshl_add_u32 v10, v11, 9, v10
    v_lshrrev_b32 v11, 5, v9
    v_lshl_add_u32 v10, v11, 8, v10
    v_add_u32 v6, s26, v10
    v_lshlrev_b32 v60, 16, v84
    v_and_b32 v61, 0xffff0000, v84
    v_lshlrev_b32 v62, 16, v85
    v_and_b32 v63, 0xffff0000, v85
    v_lshlrev_b32 v64, 16, v86
    v_and_b32 v65, 0xffff0000, v86
    v_lshlrev_b32 v66, 16, v87
    v_and_b32 v67, 0xffff0000, v87
    v_lshlrev_b32 v68, 16, v88
    v_and_b32 v69, 0xffff0000, v88
    v_lshlrev_b32 v70, 16, v89
    v_and_b32 v71, 0xffff0000, v89
    v_lshlrev_b32 v72, 16, v90
    v_and_b32 v73, 0xffff0000, v90
    v_lshlrev_b32 v74, 16, v91
    v_and_b32 v75, 0xffff0000, v91
    v_lshlrev_b32 v76, 16, v92
    v_and_b32 v77, 0xffff0000, v92
    v_lshlrev_b32 v78, 16, v93
    v_and_b32 v79, 0xffff0000, v93
    v_lshlrev_b32 v80, 16, v94
    v_and_b32 v81, 0xffff0000, v94
    v_lshlrev_b32 v82, 16, v95
    v_and_b32 v83, 0xffff0000, v95
    v_lshlrev_b32 v84, 16, v96
    v_and_b32 v85, 0xffff0000, v96
    v_lshlrev_b32 v86, 16, v97
    v_and_b32 v87, 0xffff0000, v97
    v_lshlrev_b32 v88, 16, v98
    v_and_b32 v89, 0xffff0000, v98
    v_lshlrev_b32 v90, 16, v99
    v_and_b32 v91, 0xffff0000, v99
    v_lshlrev_b32 v92, 16, v100
    v_and_b32 v93, 0xffff0000, v100
    v_lshlrev_b32 v94, 16, v101
    v_and_b32 v95, 0xffff0000, v101
    v_lshlrev_b32 v96, 16, v102
    v_and_b32 v97, 0xffff0000, v102
    v_lshlrev_b32 v98, 16, v103
    v_and_b32 v99, 0xffff0000, v103
    v_lshlrev_b32 v100, 16, v104
    v_and_b32 v101, 0xffff0000, v104
    v_lshlrev_b32 v102, 16, v105
    v_and_b32 v103, 0xffff0000, v105
    v_lshlrev_b32 v104, 16, v106
    v_and_b32 v105, 0xffff0000, v106
    v_lshlrev_b32 v106, 16, v107
    v_and_b32 v107, 0xffff0000, v107
    v_lshlrev_b32 v124, 16, v148
    v_and_b32 v125, 0xffff0000, v148
    v_lshlrev_b32 v126, 16, v149
    v_and_b32 v127, 0xffff0000, v149
    v_lshlrev_b32 v128, 16, v150
    v_and_b32 v129, 0xffff0000, v150
    v_lshlrev_b32 v130, 16, v151
    v_and_b32 v131, 0xffff0000, v151
    v_lshlrev_b32 v132, 16, v152
    v_and_b32 v133, 0xffff0000, v152
    v_lshlrev_b32 v134, 16, v153
    v_and_b32 v135, 0xffff0000, v153
    v_lshlrev_b32 v136, 16, v154
    v_and_b32 v137, 0xffff0000, v154
    v_lshlrev_b32 v138, 16, v155
    v_and_b32 v139, 0xffff0000, v155
    v_lshlrev_b32 v140, 16, v156
    v_and_b32 v141, 0xffff0000, v156
    v_lshlrev_b32 v142, 16, v157
    v_and_b32 v143, 0xffff0000, v157
    v_lshlrev_b32 v144, 16, v158
    v_and_b32 v145, 0xffff0000, v158
    v_lshlrev_b32 v146, 16, v159
    v_and_b32 v147, 0xffff0000, v159
    v_lshlrev_b32 v148, 16, v160
    v_and_b32 v149, 0xffff0000, v160
    v_lshlrev_b32 v150, 16, v161
    v_and_b32 v151, 0xffff0000, v161
    v_lshlrev_b32 v152, 16, v162
    v_and_b32 v153, 0xffff0000, v162
    v_lshlrev_b32 v154, 16, v163
    v_and_b32 v155, 0xffff0000, v163
    v_lshlrev_b32 v156, 16, v164
    v_and_b32 v157, 0xffff0000, v164
    v_lshlrev_b32 v158, 16, v165
    v_and_b32 v159, 0xffff0000, v165
    v_lshlrev_b32 v160, 16, v166
    v_and_b32 v161, 0xffff0000, v166
    v_lshlrev_b32 v162, 16, v167
    v_and_b32 v163, 0xffff0000, v167
    v_lshlrev_b32 v164, 16, v168
    v_and_b32 v165, 0xffff0000, v168
    v_lshlrev_b32 v166, 16, v169
    v_and_b32 v167, 0xffff0000, v169
    v_lshlrev_b32 v168, 16, v170
    v_and_b32 v169, 0xffff0000, v170
    v_lshlrev_b32 v170, 16, v171
    v_and_b32 v171, 0xffff0000, v171
    s_waitcnt vmcnt(6)
    s_barrier
    s_cmp_eq_u32 s23, 0
    s_cbranch_scc1 L_QN
    s_setprio 0
    s_add_u32 m0, s67, 124928
    s_add_u32 s69, s65, 0
    buffer_load_dwordx4 v7, s[40:43], s69 offen lds
    s_add_u32 m0, s67, 125952
    s_add_u32 s69, s65, 24576
    buffer_load_dwordx4 v7, s[40:43], s69 offen lds
    s_add_u32 m0, s67, 126976
    s_add_u32 s69, s65, 49152
    buffer_load_dwordx4 v7, s[40:43], s69 offen lds
    s_add_u32 m0, s68, 75008
    s_add_u32 s69, s66, 0
    buffer_load_dwordx4 v8, s[44:47], s69 offen lds
    s_add_u32 m0, s68, 79104
    s_add_u32 s69, s66, 128
    buffer_load_dwordx4 v8, s[44:47], s69 offen lds
    s_add_u32 m0, s68, 83200
    s_add_u32 s69, s66, 256
    buffer_load_dwordx4 v8, s[44:47], s69 offen lds
    s_add_u32 s65, s65, 64
    s_cmp_eq_u32 s65, s70
    s_cselect_b32 s69, 1536, 0
    s_sub_u32 s65, s65, s69
    s_add_u32 s66, s66, 12288
    s_cmp_eq_u32 s66, s71
    s_cselect_b32 s69, 294912, 0
    s_sub_u32 s66, s66, s69
    ds_read_b64_tr_b16 v[184:185], v1 offset:12288
    ds_read_b64_tr_b16 v[186:187], v1 offset:12800
    ds_read_b64_tr_b16 v[188:189], v2 offset:12288
    ds_read_b64_tr_b16 v[190:191], v2 offset:12800
    ds_read_b64_tr_b16 v[192:193], v1 offset:16384
    ds_read_b64_tr_b16 v[194:195], v1 offset:16896
    ds_read_b64_tr_b16 v[196:197], v1 offset:14336
    ds_read_b64_tr_b16 v[198:199], v1 offset:14848
    ds_read_b64_tr_b16 v[200:201], v2 offset:14336
    ds_read_b64_tr_b16 v[202:203], v2 offset:14848
    ds_read_b64_tr_b16 v[204:205], v1 offset:18432
    ds_read_b64_tr_b16 v[206:207], v1 offset:18944
    ds_read_b64_tr_b16 v[208:209], v3 offset:12288
    ds_read_b64_tr_b16 v[210:211], v3 offset:12800
    ds_read_b64_tr_b16 v[212:213], v4 offset:12288
    ds_read_b64_tr_b16 v[214:215], v4 offset:12800
    ds_read_b64_tr_b16 v[216:217], v5 offset:12288
    ds_read_b64_tr_b16 v[218:219], v5 offset:12800
    s_waitcnt vmcnt(6) lgkmcnt(0)
    s_barrier
    s_mov_b32 s64, 0
.p2align 3
L_Q_loop:
    ds_read_b128 v[220:223], v6 offset:0
    ds_read_b128 v[224:227], v6 offset:4096
    ds_read_b128 v[228:231], v6 offset:8192
    ds_read_b128 v[232:235], v6 offset:1024
    ds_read_b128 v[236:239], v6 offset:5120
    ds_read_b128 v[240:243], v6 offset:9216
    ds_read_b128 v[244:247], v0 offset:0
    s_waitcnt lgkmcnt(6)
    v_mfma_f32_32x32x16_bf16 v[12:27], v[184:187], v[220:223], v[12:27]
    s_add_u32 m0, s67, 137216
    s_add_u32 s69, s65, 0
    buffer_load_dwordx4 v7, s[40:43], s69 offen lds
    v_mfma_f32_32x32x16_bf16 v[28:43], v[188:191], v[220:223], v[28:43]
    v_mfma_f32_32x32x16_bf16 v[44:59], v[192:195], v[220:223], v[44:59]
    s_add_u32 m0, s67, 138240
    s_add_u32 s69, s65, 24576
    buffer_load_dwordx4 v7, s[40:43], s69 offen lds
    s_waitcnt lgkmcnt(5)
    v_mfma_f32_32x32x16_bf16 v[60:75], v[184:187], v[224:227], v[60:75]
    v_mfma_f32_32x32x16_bf16 v[76:91], v[188:191], v[224:227], v[76:91]
    s_add_u32 m0, s67, 139264
    s_add_u32 s69, s65, 49152
    buffer_load_dwordx4 v7, s[40:43], s69 offen lds
    v_mfma_f32_32x32x16_bf16 v[92:107], v[192:195], v[224:227], v[92:107]
    s_waitcnt lgkmcnt(4)
    v_mfma_f32_32x32x16_bf16 v[124:139], v[184:187], v[228:231], v[124:139]
    s_add_u32 m0, s68, 87296
    s_add_u32 s69, s66, 0
    buffer_load_dwordx4 v8, s[44:47], s69 offen lds
    v_mfma_f32_32x32x16_bf16 v[140:155], v[188:191], v[228:231], v[140:155]
    ds_read_b64_tr_b16 v[184:185], v1 offset:24576
    ds_read_b64_tr_b16 v[186:187], v1 offset:25088
    v_mfma_f32_32x32x16_bf16 v[156:171], v[192:195], v[228:231], v[156:171]
    ds_read_b64_tr_b16 v[188:189], v2 offset:24576
    ds_read_b64_tr_b16 v[190:191], v2 offset:25088
    s_waitcnt lgkmcnt(7)
    v_mfma_f32_32x32x16_bf16 v[12:27], v[196:199], v[232:235], v[12:27]
    ds_read_b64_tr_b16 v[192:193], v1 offset:28672
    ds_read_b64_tr_b16 v[194:195], v1 offset:29184
    v_mfma_f32_32x32x16_bf16 v[28:43], v[200:203], v[232:235], v[28:43]
    s_add_u32 m0, s68, 91392
    s_add_u32 s69, s66, 128
    buffer_load_dwordx4 v8, s[44:47], s69 offen lds
    v_mfma_f32_32x32x16_bf16 v[44:59], v[204:207], v[232:235], v[44:59]
    s_waitcnt lgkmcnt(8)
    v_mfma_f32_32x32x16_bf16 v[60:75], v[196:199], v[236:239], v[60:75]
    s_add_u32 m0, s68, 95488
    s_add_u32 s69, s66, 256
    buffer_load_dwordx4 v8, s[44:47], s69 offen lds
    v_mfma_f32_32x32x16_bf16 v[76:91], v[200:203], v[236:239], v[76:91]
    v_mfma_f32_32x32x16_bf16 v[92:107], v[204:207], v[236:239], v[92:107]
    s_waitcnt lgkmcnt(7)
    v_mfma_f32_32x32x16_bf16 v[124:139], v[196:199], v[240:243], v[124:139]
    v_mfma_f32_32x32x16_bf16 v[140:155], v[200:203], v[240:243], v[140:155]
    ds_read_b64_tr_b16 v[196:197], v1 offset:26624
    ds_read_b64_tr_b16 v[198:199], v1 offset:27136
    v_mfma_f32_32x32x16_bf16 v[156:171], v[204:207], v[240:243], v[156:171]
    ds_read_b64_tr_b16 v[200:201], v2 offset:26624
    ds_read_b64_tr_b16 v[202:203], v2 offset:27136
    s_waitcnt lgkmcnt(10)
    v_mfma_f32_16x16x32_bf16 v[172:175], v[208:211], v[244:247], v[172:175]
    ds_read_b64_tr_b16 v[204:205], v1 offset:30720
    ds_read_b64_tr_b16 v[206:207], v1 offset:31232
    v_mfma_f32_16x16x32_bf16 v[176:179], v[212:215], v[244:247], v[176:179]
    ds_read_b64_tr_b16 v[208:209], v3 offset:24576
    ds_read_b64_tr_b16 v[210:211], v3 offset:25088
    v_mfma_f32_16x16x32_bf16 v[180:183], v[216:219], v[244:247], v[180:183]
    ds_read_b64_tr_b16 v[212:213], v4 offset:24576
    ds_read_b64_tr_b16 v[214:215], v4 offset:25088
    ds_read_b64_tr_b16 v[216:217], v5 offset:24576
    ds_read_b64_tr_b16 v[218:219], v5 offset:25088
    s_add_u32 s65, s65, 64
    s_cmp_eq_u32 s65, s70
    s_cselect_b32 s69, 1536, 0
    s_sub_u32 s65, s65, s69
    s_add_u32 s66, s66, 12288
    s_cmp_eq_u32 s66, s71
    s_cselect_b32 s69, 294912, 0
    s_sub_u32 s66, s66, s69
    s_waitcnt vmcnt(6) lgkmcnt(0)
    s_barrier
    ds_read_b128 v[220:223], v6 offset:13312
    ds_read_b128 v[224:227], v6 offset:17408
    ds_read_b128 v[228:231], v6 offset:21504
    ds_read_b128 v[232:235], v6 offset:14336
    ds_read_b128 v[236:239], v6 offset:18432
    ds_read_b128 v[240:243], v6 offset:22528
    ds_read_b128 v[244:247], v0 offset:13312
    s_waitcnt lgkmcnt(6)
    v_mfma_f32_32x32x16_bf16 v[12:27], v[184:187], v[220:223], v[12:27]
    s_add_u32 m0, s67, 112640
    s_add_u32 s69, s65, 0
    buffer_load_dwordx4 v7, s[40:43], s69 offen lds
    v_mfma_f32_32x32x16_bf16 v[28:43], v[188:191], v[220:223], v[28:43]
    v_mfma_f32_32x32x16_bf16 v[44:59], v[192:195], v[220:223], v[44:59]
    s_add_u32 m0, s67, 113664
    s_add_u32 s69, s65, 24576
    buffer_load_dwordx4 v7, s[40:43], s69 offen lds
    s_waitcnt lgkmcnt(5)
    v_mfma_f32_32x32x16_bf16 v[60:75], v[184:187], v[224:227], v[60:75]
    v_mfma_f32_32x32x16_bf16 v[76:91], v[188:191], v[224:227], v[76:91]
    s_add_u32 m0, s67, 114688
    s_add_u32 s69, s65, 49152
    buffer_load_dwordx4 v7, s[40:43], s69 offen lds
    v_mfma_f32_32x32x16_bf16 v[92:107], v[192:195], v[224:227], v[92:107]
    s_waitcnt lgkmcnt(4)
    v_mfma_f32_32x32x16_bf16 v[124:139], v[184:187], v[228:231], v[124:139]
    s_add_u32 m0, s68, 99584
    s_add_u32 s69, s66, 0
    buffer_load_dwordx4 v8, s[44:47], s69 offen lds
    v_mfma_f32_32x32x16_bf16 v[140:155], v[188:191], v[228:231], v[140:155]
    ds_read_b64_tr_b16 v[184:185], v1 offset:0
    ds_read_b64_tr_b16 v[186:187], v1 offset:512
    v_mfma_f32_32x32x16_bf16 v[156:171], v[192:195], v[228:231], v[156:171]
    ds_read_b64_tr_b16 v[188:189], v2 offset:0
    ds_read_b64_tr_b16 v[190:191], v2 offset:512
    s_waitcnt lgkmcnt(7)
    v_mfma_f32_32x32x16_bf16 v[12:27], v[196:199], v[232:235], v[12:27]
    ds_read_b64_tr_b16 v[192:193], v1 offset:4096
    ds_read_b64_tr_b16 v[194:195], v1 offset:4608
    v_mfma_f32_32x32x16_bf16 v[28:43], v[200:203], v[232:235], v[28:43]
    s_add_u32 m0, s68, 103680
    s_add_u32 s69, s66, 128
    buffer_load_dwordx4 v8, s[44:47], s69 offen lds
    v_mfma_f32_32x32x16_bf16 v[44:59], v[204:207], v[232:235], v[44:59]
    s_waitcnt lgkmcnt(8)
    v_mfma_f32_32x32x16_bf16 v[60:75], v[196:199], v[236:239], v[60:75]
    s_add_u32 m0, s68, 107776
    s_add_u32 s69, s66, 256
    buffer_load_dwordx4 v8, s[44:47], s69 offen lds
    v_mfma_f32_32x32x16_bf16 v[76:91], v[200:203], v[236:239], v[76:91]
    v_mfma_f32_32x32x16_bf16 v[92:107], v[204:207], v[236:239], v[92:107]
    s_waitcnt lgkmcnt(7)
    v_mfma_f32_32x32x16_bf16 v[124:139], v[196:199], v[240:243], v[124:139]
    v_mfma_f32_32x32x16_bf16 v[140:155], v[200:203], v[240:243], v[140:155]
    ds_read_b64_tr_b16 v[196:197], v1 offset:2048
    ds_read_b64_tr_b16 v[198:199], v1 offset:2560
    v_mfma_f32_32x32x16_bf16 v[156:171], v[204:207], v[240:243], v[156:171]
    ds_read_b64_tr_b16 v[200:201], v2 offset:2048
    ds_read_b64_tr_b16 v[202:203], v2 offset:2560
    s_waitcnt lgkmcnt(10)
    v_mfma_f32_16x16x32_bf16 v[172:175], v[208:211], v[244:247], v[172:175]
    ds_read_b64_tr_b16 v[204:205], v1 offset:6144
    ds_read_b64_tr_b16 v[206:207], v1 offset:6656
    v_mfma_f32_16x16x32_bf16 v[176:179], v[212:215], v[244:247], v[176:179]
    ds_read_b64_tr_b16 v[208:209], v3 offset:0
    ds_read_b64_tr_b16 v[210:211], v3 offset:512
    v_mfma_f32_16x16x32_bf16 v[180:183], v[216:219], v[244:247], v[180:183]
    ds_read_b64_tr_b16 v[212:213], v4 offset:0
    ds_read_b64_tr_b16 v[214:215], v4 offset:512
    ds_read_b64_tr_b16 v[216:217], v5 offset:0
    ds_read_b64_tr_b16 v[218:219], v5 offset:512
    s_add_u32 s65, s65, 64
    s_cmp_eq_u32 s65, s70
    s_cselect_b32 s69, 1536, 0
    s_sub_u32 s65, s65, s69
    s_add_u32 s66, s66, 12288
    s_cmp_eq_u32 s66, s71
    s_cselect_b32 s69, 294912, 0
    s_sub_u32 s66, s66, s69
    s_add_u32 s64, s64, 1
    s_cmp_lt_u32 s64, 7
    s_cselect_b32 s42, 294912, 0
    s_waitcnt vmcnt(6) lgkmcnt(0)
    s_barrier
    ds_read_b128 v[220:223], v6 offset:31232
    ds_read_b128 v[224:227], v6 offset:35328
    ds_read_b128 v[228:231], v6 offset:39424
    ds_read_b128 v[232:235], v6 offset:32256
    ds_read_b128 v[236:239], v6 offset:36352
    ds_read_b128 v[240:243], v6 offset:40448
    ds_read_b128 v[244:247], v0 offset:31232
    s_waitcnt lgkmcnt(6)
    v_mfma_f32_32x32x16_bf16 v[12:27], v[184:187], v[220:223], v[12:27]
    s_add_u32 m0, s67, 124928
    s_add_u32 s69, s65, 0
    buffer_load_dwordx4 v7, s[40:43], s69 offen lds
    v_mfma_f32_32x32x16_bf16 v[28:43], v[188:191], v[220:223], v[28:43]
    v_mfma_f32_32x32x16_bf16 v[44:59], v[192:195], v[220:223], v[44:59]
    s_add_u32 m0, s67, 125952
    s_add_u32 s69, s65, 24576
    buffer_load_dwordx4 v7, s[40:43], s69 offen lds
    s_waitcnt lgkmcnt(5)
    v_mfma_f32_32x32x16_bf16 v[60:75], v[184:187], v[224:227], v[60:75]
    v_mfma_f32_32x32x16_bf16 v[76:91], v[188:191], v[224:227], v[76:91]
    s_add_u32 m0, s67, 126976
    s_add_u32 s69, s65, 49152
    buffer_load_dwordx4 v7, s[40:43], s69 offen lds
    v_mfma_f32_32x32x16_bf16 v[92:107], v[192:195], v[224:227], v[92:107]
    s_waitcnt lgkmcnt(4)
    v_mfma_f32_32x32x16_bf16 v[124:139], v[184:187], v[228:231], v[124:139]
    s_add_u32 m0, s68, 75008
    s_add_u32 s69, s66, 0
    buffer_load_dwordx4 v8, s[44:47], s69 offen lds
    v_mfma_f32_32x32x16_bf16 v[140:155], v[188:191], v[228:231], v[140:155]
    ds_read_b64_tr_b16 v[184:185], v1 offset:12288
    ds_read_b64_tr_b16 v[186:187], v1 offset:12800
    v_mfma_f32_32x32x16_bf16 v[156:171], v[192:195], v[228:231], v[156:171]
    ds_read_b64_tr_b16 v[188:189], v2 offset:12288
    ds_read_b64_tr_b16 v[190:191], v2 offset:12800
    s_waitcnt lgkmcnt(7)
    v_mfma_f32_32x32x16_bf16 v[12:27], v[196:199], v[232:235], v[12:27]
    ds_read_b64_tr_b16 v[192:193], v1 offset:16384
    ds_read_b64_tr_b16 v[194:195], v1 offset:16896
    v_mfma_f32_32x32x16_bf16 v[28:43], v[200:203], v[232:235], v[28:43]
    s_add_u32 m0, s68, 79104
    s_add_u32 s69, s66, 128
    buffer_load_dwordx4 v8, s[44:47], s69 offen lds
    v_mfma_f32_32x32x16_bf16 v[44:59], v[204:207], v[232:235], v[44:59]
    s_waitcnt lgkmcnt(8)
    v_mfma_f32_32x32x16_bf16 v[60:75], v[196:199], v[236:239], v[60:75]
    s_add_u32 m0, s68, 83200
    s_add_u32 s69, s66, 256
    buffer_load_dwordx4 v8, s[44:47], s69 offen lds
    v_mfma_f32_32x32x16_bf16 v[76:91], v[200:203], v[236:239], v[76:91]
    v_mfma_f32_32x32x16_bf16 v[92:107], v[204:207], v[236:239], v[92:107]
    s_waitcnt lgkmcnt(7)
    v_mfma_f32_32x32x16_bf16 v[124:139], v[196:199], v[240:243], v[124:139]
    v_mfma_f32_32x32x16_bf16 v[140:155], v[200:203], v[240:243], v[140:155]
    ds_read_b64_tr_b16 v[196:197], v1 offset:14336
    ds_read_b64_tr_b16 v[198:199], v1 offset:14848
    v_mfma_f32_32x32x16_bf16 v[156:171], v[204:207], v[240:243], v[156:171]
    ds_read_b64_tr_b16 v[200:201], v2 offset:14336
    ds_read_b64_tr_b16 v[202:203], v2 offset:14848
    s_waitcnt lgkmcnt(10)
    v_mfma_f32_16x16x32_bf16 v[172:175], v[208:211], v[244:247], v[172:175]
    ds_read_b64_tr_b16 v[204:205], v1 offset:18432
    ds_read_b64_tr_b16 v[206:207], v1 offset:18944
    v_mfma_f32_16x16x32_bf16 v[176:179], v[212:215], v[244:247], v[176:179]
    ds_read_b64_tr_b16 v[208:209], v3 offset:12288
    ds_read_b64_tr_b16 v[210:211], v3 offset:12800
    v_mfma_f32_16x16x32_bf16 v[180:183], v[216:219], v[244:247], v[180:183]
    ds_read_b64_tr_b16 v[212:213], v4 offset:12288
    ds_read_b64_tr_b16 v[214:215], v4 offset:12800
    ds_read_b64_tr_b16 v[216:217], v5 offset:12288
    ds_read_b64_tr_b16 v[218:219], v5 offset:12800
    s_add_u32 s65, s65, 64
    s_cmp_eq_u32 s65, s70
    s_cselect_b32 s69, 1536, 0
    s_sub_u32 s65, s65, s69
    s_add_u32 s66, s66, 12288
    s_cmp_eq_u32 s66, s71
    s_cselect_b32 s69, 294912, 0
    s_sub_u32 s66, s66, s69
    s_waitcnt vmcnt(6) lgkmcnt(0)
    s_cmp_lt_u32 s64, 7
    s_barrier
    s_cbranch_scc1 L_Q_loop
    ds_read_b128 v[220:223], v6 offset:0
    ds_read_b128 v[224:227], v6 offset:4096
    ds_read_b128 v[228:231], v6 offset:8192
    ds_read_b128 v[232:235], v6 offset:1024
    ds_read_b128 v[236:239], v6 offset:5120
    ds_read_b128 v[240:243], v6 offset:9216
    ds_read_b128 v[244:247], v0 offset:0
    s_waitcnt lgkmcnt(6)
    v_mfma_f32_32x32x16_bf16 v[12:27], v[184:187], v[220:223], v[12:27]
    v_mfma_f32_32x32x16_bf16 v[28:43], v[188:191], v[220:223], v[28:43]
    v_mfma_f32_32x32x16_bf16 v[44:59], v[192:195], v[220:223], v[44:59]
    s_waitcnt lgkmcnt(5)
    v_mfma_f32_32x32x16_bf16 v[60:75], v[184:187], v[224:227], v[60:75]
    v_mfma_f32_32x32x16_bf16 v[76:91], v[188:191], v[224:227], v[76:91]
    v_mfma_f32_32x32x16_bf16 v[92:107], v[192:195], v[224:227], v[92:107]
    s_waitcnt lgkmcnt(4)
    v_mfma_f32_32x32x16_bf16 v[124:139], v[184:187], v[228:231], v[124:139]
    v_mfma_f32_32x32x16_bf16 v[140:155], v[188:191], v[228:231], v[140:155]
    ds_read_b64_tr_b16 v[184:185], v1 offset:24576
    ds_read_b64_tr_b16 v[186:187], v1 offset:25088
    v_mfma_f32_32x32x16_bf16 v[156:171], v[192:195], v[228:231], v[156:171]
    ds_read_b64_tr_b16 v[188:189], v2 offset:24576
    ds_read_b64_tr_b16 v[190:191], v2 offset:25088
    s_waitcnt lgkmcnt(7)
    v_mfma_f32_32x32x16_bf16 v[12:27], v[196:199], v[232:235], v[12:27]
    ds_read_b64_tr_b16 v[192:193], v1 offset:28672
    ds_read_b64_tr_b16 v[194:195], v1 offset:29184
    v_mfma_f32_32x32x16_bf16 v[28:43], v[200:203], v[232:235], v[28:43]
    v_mfma_f32_32x32x16_bf16 v[44:59], v[204:207], v[232:235], v[44:59]
    s_waitcnt lgkmcnt(8)
    v_mfma_f32_32x32x16_bf16 v[60:75], v[196:199], v[236:239], v[60:75]
    v_mfma_f32_32x32x16_bf16 v[76:91], v[200:203], v[236:239], v[76:91]
    v_mfma_f32_32x32x16_bf16 v[92:107], v[204:207], v[236:239], v[92:107]
    s_waitcnt lgkmcnt(7)
    v_mfma_f32_32x32x16_bf16 v[124:139], v[196:199], v[240:243], v[124:139]
    v_mfma_f32_32x32x16_bf16 v[140:155], v[200:203], v[240:243], v[140:155]
    ds_read_b64_tr_b16 v[196:197], v1 offset:26624
    ds_read_b64_tr_b16 v[198:199], v1 offset:27136
    v_mfma_f32_32x32x16_bf16 v[156:171], v[204:207], v[240:243], v[156:171]
    ds_read_b64_tr_b16 v[200:201], v2 offset:26624
    ds_read_b64_tr_b16 v[202:203], v2 offset:27136
    s_waitcnt lgkmcnt(10)
    v_mfma_f32_16x16x32_bf16 v[172:175], v[208:211], v[244:247], v[172:175]
    ds_read_b64_tr_b16 v[204:205], v1 offset:30720
    ds_read_b64_tr_b16 v[206:207], v1 offset:31232
    v_mfma_f32_16x16x32_bf16 v[176:179], v[212:215], v[244:247], v[176:179]
    ds_read_b64_tr_b16 v[208:209], v3 offset:24576
    ds_read_b64_tr_b16 v[210:211], v3 offset:25088
    v_mfma_f32_16x16x32_bf16 v[180:183], v[216:219], v[244:247], v[180:183]
    ds_read_b64_tr_b16 v[212:213], v4 offset:24576
    ds_read_b64_tr_b16 v[214:215], v4 offset:25088
    ds_read_b64_tr_b16 v[216:217], v5 offset:24576
    ds_read_b64_tr_b16 v[218:219], v5 offset:25088
    s_waitcnt vmcnt(0) lgkmcnt(0)
    s_barrier
    ds_read_b128 v[220:223], v6 offset:13312
    ds_read_b128 v[224:227], v6 offset:17408
    ds_read_b128 v[228:231], v6 offset:21504
    ds_read_b128 v[232:235], v6 offset:14336
    ds_read_b128 v[236:239], v6 offset:18432
    ds_read_b128 v[240:243], v6 offset:22528
    ds_read_b128 v[244:247], v0 offset:13312
    s_waitcnt lgkmcnt(6)
    v_mfma_f32_32x32x16_bf16 v[12:27], v[184:187], v[220:223], v[12:27]
    v_mfma_f32_32x32x16_bf16 v[28:43], v[188:191], v[220:223], v[28:43]
    v_mfma_f32_32x32x16_bf16 v[44:59], v[192:195], v[220:223], v[44:59]
    s_waitcnt lgkmcnt(5)
    v_mfma_f32_32x32x16_bf16 v[60:75], v[184:187], v[224:227], v[60:75]
    v_mfma_f32_32x32x16_bf16 v[76:91], v[188:191], v[224:227], v[76:91]
    v_mfma_f32_32x32x16_bf16 v[92:107], v[192:195], v[224:227], v[92:107]
    s_waitcnt lgkmcnt(4)
    v_mfma_f32_32x32x16_bf16 v[124:139], v[184:187], v[228:231], v[124:139]
    v_mfma_f32_32x32x16_bf16 v[140:155], v[188:191], v[228:231], v[140:155]
    ds_read_b64_tr_b16 v[184:185], v1 offset:0
    ds_read_b64_tr_b16 v[186:187], v1 offset:512
    v_mfma_f32_32x32x16_bf16 v[156:171], v[192:195], v[228:231], v[156:171]
    ds_read_b64_tr_b16 v[188:189], v2 offset:0
    ds_read_b64_tr_b16 v[190:191], v2 offset:512
    s_waitcnt lgkmcnt(7)
    v_mfma_f32_32x32x16_bf16 v[12:27], v[196:199], v[232:235], v[12:27]
    ds_read_b64_tr_b16 v[192:193], v1 offset:4096
    ds_read_b64_tr_b16 v[194:195], v1 offset:4608
    v_mfma_f32_32x32x16_bf16 v[28:43], v[200:203], v[232:235], v[28:43]
    v_mfma_f32_32x32x16_bf16 v[44:59], v[204:207], v[232:235], v[44:59]
    s_waitcnt lgkmcnt(8)
    v_mfma_f32_32x32x16_bf16 v[60:75], v[196:199], v[236:239], v[60:75]
    v_mfma_f32_32x32x16_bf16 v[76:91], v[200:203], v[236:239], v[76:91]
    v_mfma_f32_32x32x16_bf16 v[92:107], v[204:207], v[236:239], v[92:107]
    s_waitcnt lgkmcnt(7)
    v_mfma_f32_32x32x16_bf16 v[124:139], v[196:199], v[240:243], v[124:139]
    v_mfma_f32_32x32x16_bf16 v[140:155], v[200:203], v[240:243], v[140:155]
    ds_read_b64_tr_b16 v[196:197], v1 offset:2048
    ds_read_b64_tr_b16 v[198:199], v1 offset:2560
    v_mfma_f32_32x32x16_bf16 v[156:171], v[204:207], v[240:243], v[156:171]
    ds_read_b64_tr_b16 v[200:201], v2 offset:2048
    ds_read_b64_tr_b16 v[202:203], v2 offset:2560
    s_waitcnt lgkmcnt(10)
    v_mfma_f32_16x16x32_bf16 v[172:175], v[208:211], v[244:247], v[172:175]
    ds_read_b64_tr_b16 v[204:205], v1 offset:6144
    ds_read_b64_tr_b16 v[206:207], v1 offset:6656
    v_mfma_f32_16x16x32_bf16 v[176:179], v[212:215], v[244:247], v[176:179]
    ds_read_b64_tr_b16 v[208:209], v3 offset:0
    ds_read_b64_tr_b16 v[210:211], v3 offset:512
    v_mfma_f32_16x16x32_bf16 v[180:183], v[216:219], v[244:247], v[180:183]
    ds_read_b64_tr_b16 v[212:213], v4 offset:0
    ds_read_b64_tr_b16 v[214:215], v4 offset:512
    ds_read_b64_tr_b16 v[216:217], v5 offset:0
    ds_read_b64_tr_b16 v[218:219], v5 offset:512
    s_waitcnt vmcnt(0) lgkmcnt(0)
    v_mbcnt_lo_u32_b32 v9, -1, 0
    v_mbcnt_hi_u32_b32 v9, -1, v9
    s_and_b32 s29, s20, 3
    s_mul_i32 s31, s29, 19968
    s_add_u32 s31, s31, 44544
    v_and_b32 v10, 31, v9
    v_mul_u32_u24 v7, 208, v10
    v_lshrrev_b32 v10, 5, v9
    v_lshl_add_u32 v7, v10, 4, v7
    v_add_u32 v7, s31, v7
    v_and_b32 v10, 15, v9
    v_mul_u32_u24 v10, 384, v10
    v_lshrrev_b32 v11, 4, v9
    v_lshl_add_u32 v11, v11, 3, v10
    v_add_u32 v10, 0, v9
    v_mul_u32_u24 v8, 171, v10
    v_lshrrev_b32 v8, 11, v8
    v_mul_u32_u24 v108, 12, v8
    v_sub_u32 v10, v10, v108
    v_lshlrev_b32 v10, 4, v10
    v_mul_u32_u24 v108, 208, v8
    v_add3_u32 v108, v108, v10, s31
    v_mul_u32_u24 v111, 384, v8
    v_add_u32 v111, v111, v10
    v_add_u32 v10, 64, v9
    v_mul_u32_u24 v8, 171, v10
    v_lshrrev_b32 v8, 11, v8
    v_mul_u32_u24 v109, 12, v8
    v_sub_u32 v10, v10, v109
    v_lshlrev_b32 v10, 4, v10
    v_mul_u32_u24 v109, 208, v8
    v_add3_u32 v109, v109, v10, s31
    v_mul_u32_u24 v112, 384, v8
    v_add_u32 v112, v112, v10
    v_add_u32 v10, 128, v9
    v_mul_u32_u24 v8, 171, v10
    v_lshrrev_b32 v8, 11, v8
    v_mul_u32_u24 v110, 12, v8
    v_sub_u32 v10, v10, v110
    v_lshlrev_b32 v10, 4, v10
    v_mul_u32_u24 v110, 208, v8
    v_add3_u32 v110, v110, v10, s31
    v_mul_u32_u24 v113, 384, v8
    v_add_u32 v113, v113, v10
    s_add_u32 s26, s24, s21
    s_add_u32 s26, s26, 1
    s_mul_i32 s26, s26, 224
    s_add_u32 s26, s26, s22
    s_mul_i32 s26, s26, 384
    s_mul_i32 s27, s25, 192
    s_add_u32 s26, s26, s27
    s_add_u32 s27, s26, 172032
    s_mul_i32 s28, s21, 224
    s_add_u32 s28, s28, s22
    s_mul_i32 s28, s28, 384
    s_mul_i32 s29, s29, 96
    s_add_u32 s28, s28, s29
    s_barrier
    ds_read_b128 v[220:223], v6 offset:31232
    ds_read_b128 v[232:235], v6 offset:32256
    ds_read_b128 v[224:227], v6 offset:35328
    ds_read_b128 v[236:239], v6 offset:36352
    ds_read_b128 v[228:231], v6 offset:39424
    ds_read_b128 v[240:243], v6 offset:40448
    ds_read_b128 v[244:247], v0 offset:31232
    s_waitcnt lgkmcnt(6)
    v_mfma_f32_32x32x16_bf16 v[12:27], v[184:187], v[220:223], v[12:27]
    v_mfma_f32_32x32x16_bf16 v[28:43], v[188:191], v[220:223], v[28:43]
    v_mfma_f32_32x32x16_bf16 v[44:59], v[192:195], v[220:223], v[44:59]
    s_waitcnt lgkmcnt(5)
    v_mfma_f32_32x32x16_bf16 v[12:27], v[196:199], v[232:235], v[12:27]
    v_mfma_f32_32x32x16_bf16 v[28:43], v[200:203], v[232:235], v[28:43]
    v_mfma_f32_32x32x16_bf16 v[44:59], v[204:207], v[232:235], v[44:59]
    s_waitcnt lgkmcnt(4)
    v_mfma_f32_32x32x16_bf16 v[60:75], v[184:187], v[224:227], v[60:75]
    s_nop 7
    v_cvt_pk_bf16_f32 v12, v12, v13
    v_cvt_pk_bf16_f32 v13, v14, v15
    v_cvt_pk_bf16_f32 v14, v16, v17
    v_cvt_pk_bf16_f32 v15, v18, v19
    v_mfma_f32_32x32x16_bf16 v[76:91], v[188:191], v[224:227], v[76:91]
    ds_write_b128 v7, v[12:15] offset:0
    v_cvt_pk_bf16_f32 v20, v20, v21
    v_cvt_pk_bf16_f32 v21, v22, v23
    v_cvt_pk_bf16_f32 v22, v24, v25
    v_cvt_pk_bf16_f32 v23, v26, v27
    v_mfma_f32_32x32x16_bf16 v[92:107], v[192:195], v[224:227], v[92:107]
    ds_write_b128 v7, v[20:23] offset:32
    v_cvt_pk_bf16_f32 v28, v28, v29
    v_cvt_pk_bf16_f32 v29, v30, v31
    v_cvt_pk_bf16_f32 v30, v32, v33
    v_cvt_pk_bf16_f32 v31, v34, v35
    s_waitcnt lgkmcnt(5)
    v_mfma_f32_32x32x16_bf16 v[60:75], v[196:199], v[236:239], v[60:75]
    ds_write_b128 v7, v[28:31] offset:64
    v_cvt_pk_bf16_f32 v36, v36, v37
    v_cvt_pk_bf16_f32 v37, v38, v39
    v_cvt_pk_bf16_f32 v38, v40, v41
    v_cvt_pk_bf16_f32 v39, v42, v43
    v_mfma_f32_32x32x16_bf16 v[76:91], v[200:203], v[236:239], v[76:91]
    ds_write_b128 v7, v[36:39] offset:96
    v_cvt_pk_bf16_f32 v44, v44, v45
    v_cvt_pk_bf16_f32 v45, v46, v47
    v_cvt_pk_bf16_f32 v46, v48, v49
    v_cvt_pk_bf16_f32 v47, v50, v51
    v_mfma_f32_32x32x16_bf16 v[92:107], v[204:207], v[236:239], v[92:107]
    ds_write_b128 v7, v[44:47] offset:128
    v_cvt_pk_bf16_f32 v52, v52, v53
    v_cvt_pk_bf16_f32 v53, v54, v55
    v_cvt_pk_bf16_f32 v54, v56, v57
    v_cvt_pk_bf16_f32 v55, v58, v59
    ds_write_b128 v7, v[52:55] offset:160
    ds_read_b128 v[16:19], v108 offset:0
    ds_read_b128 v[24:27], v109 offset:0
    ds_read_b128 v[32:35], v110 offset:0
    ds_read_b128 v[40:43], v108 offset:3328
    ds_read_b128 v[48:51], v109 offset:3328
    ds_read_b128 v[56:59], v110 offset:3328
    s_waitcnt lgkmcnt(14)
    v_mfma_f32_32x32x16_bf16 v[124:139], v[184:187], v[228:231], v[124:139]
    s_waitcnt lgkmcnt(5)
    buffer_store_dwordx4 v[16:19], v111, s[36:39], s26 offen sc0 sc1
    v_cvt_pk_bf16_f32 v60, v60, v61
    v_cvt_pk_bf16_f32 v61, v62, v63
    v_cvt_pk_bf16_f32 v62, v64, v65
    v_cvt_pk_bf16_f32 v63, v66, v67
    v_mfma_f32_32x32x16_bf16 v[140:155], v[188:191], v[228:231], v[140:155]
    ds_write_b128 v7, v[60:63] offset:6656
    s_waitcnt lgkmcnt(5)
    buffer_store_dwordx4 v[24:27], v112, s[36:39], s26 offen sc0 sc1
    v_cvt_pk_bf16_f32 v68, v68, v69
    v_cvt_pk_bf16_f32 v69, v70, v71
    v_cvt_pk_bf16_f32 v70, v72, v73
    v_cvt_pk_bf16_f32 v71, v74, v75
    v_mfma_f32_32x32x16_bf16 v[156:171], v[192:195], v[228:231], v[156:171]
    ds_write_b128 v7, v[68:71] offset:6688
    s_waitcnt lgkmcnt(5)
    buffer_store_dwordx4 v[32:35], v113, s[36:39], s26 offen sc0 sc1
    v_cvt_pk_bf16_f32 v76, v76, v77
    v_cvt_pk_bf16_f32 v77, v78, v79
    v_cvt_pk_bf16_f32 v78, v80, v81
    v_cvt_pk_bf16_f32 v79, v82, v83
    s_waitcnt lgkmcnt(15)
    v_mfma_f32_32x32x16_bf16 v[124:139], v[196:199], v[240:243], v[124:139]
    ds_write_b128 v7, v[76:79] offset:6720
    s_waitcnt lgkmcnt(5)
    buffer_store_dwordx4 v[40:43], v111, s[36:39], s27 offen sc0 sc1
    v_cvt_pk_bf16_f32 v84, v84, v85
    v_cvt_pk_bf16_f32 v85, v86, v87
    v_cvt_pk_bf16_f32 v86, v88, v89
    v_cvt_pk_bf16_f32 v87, v90, v91
    v_mfma_f32_32x32x16_bf16 v[140:155], v[200:203], v[240:243], v[140:155]
    ds_write_b128 v7, v[84:87] offset:6752
    s_waitcnt lgkmcnt(5)
    buffer_store_dwordx4 v[48:51], v112, s[36:39], s27 offen sc0 sc1
    v_cvt_pk_bf16_f32 v92, v92, v93
    v_cvt_pk_bf16_f32 v93, v94, v95
    v_cvt_pk_bf16_f32 v94, v96, v97
    v_cvt_pk_bf16_f32 v95, v98, v99
    v_mfma_f32_32x32x16_bf16 v[156:171], v[204:207], v[240:243], v[156:171]
    ds_write_b128 v7, v[92:95] offset:6784
    s_waitcnt lgkmcnt(5)
    buffer_store_dwordx4 v[56:59], v113, s[36:39], s27 offen sc0 sc1
    v_cvt_pk_bf16_f32 v100, v100, v101
    v_cvt_pk_bf16_f32 v101, v102, v103
    v_cvt_pk_bf16_f32 v102, v104, v105
    v_cvt_pk_bf16_f32 v103, v106, v107
    s_add_u32 s26, s26, 344064
    s_add_u32 s27, s27, 344064
    ds_write_b128 v7, v[100:103] offset:6816
    ds_read_b128 v[64:67], v108 offset:6656
    ds_read_b128 v[72:75], v109 offset:6656
    ds_read_b128 v[80:83], v110 offset:6656
    ds_read_b128 v[88:91], v108 offset:9984
    ds_read_b128 v[96:99], v109 offset:9984
    ds_read_b128 v[104:107], v110 offset:9984
    s_waitcnt lgkmcnt(15)
    v_mfma_f32_16x16x32_bf16 v[172:175], v[208:211], v[244:247], v[172:175]
    v_mfma_f32_16x16x32_bf16 v[176:179], v[212:215], v[244:247], v[176:179]
    v_mfma_f32_16x16x32_bf16 v[180:183], v[216:219], v[244:247], v[180:183]
    v_cvt_pk_bf16_f32 v124, v124, v125
    v_cvt_pk_bf16_f32 v125, v126, v127
    v_cvt_pk_bf16_f32 v126, v128, v129
    v_cvt_pk_bf16_f32 v127, v130, v131
    ds_write_b128 v7, v[124:127] offset:13312
    s_waitcnt lgkmcnt(6)
    buffer_store_dwordx4 v[64:67], v111, s[36:39], s26 offen sc0 sc1
    v_cvt_pk_bf16_f32 v132, v132, v133
    v_cvt_pk_bf16_f32 v133, v134, v135
    v_cvt_pk_bf16_f32 v134, v136, v137
    v_cvt_pk_bf16_f32 v135, v138, v139
    ds_write_b128 v7, v[132:135] offset:13344
    s_waitcnt lgkmcnt(6)
    buffer_store_dwordx4 v[72:75], v112, s[36:39], s26 offen sc0 sc1
    v_cvt_pk_bf16_f32 v140, v140, v141
    v_cvt_pk_bf16_f32 v141, v142, v143
    v_cvt_pk_bf16_f32 v142, v144, v145
    v_cvt_pk_bf16_f32 v143, v146, v147
    ds_write_b128 v7, v[140:143] offset:13376
    s_waitcnt lgkmcnt(6)
    buffer_store_dwordx4 v[80:83], v113, s[36:39], s26 offen sc0 sc1
    v_cvt_pk_bf16_f32 v148, v148, v149
    v_cvt_pk_bf16_f32 v149, v150, v151
    v_cvt_pk_bf16_f32 v150, v152, v153
    v_cvt_pk_bf16_f32 v151, v154, v155
    ds_write_b128 v7, v[148:151] offset:13408
    s_waitcnt lgkmcnt(6)
    buffer_store_dwordx4 v[88:91], v111, s[36:39], s27 offen sc0 sc1
    v_cvt_pk_bf16_f32 v156, v156, v157
    v_cvt_pk_bf16_f32 v157, v158, v159
    v_cvt_pk_bf16_f32 v158, v160, v161
    v_cvt_pk_bf16_f32 v159, v162, v163
    ds_write_b128 v7, v[156:159] offset:13440
    s_waitcnt lgkmcnt(6)
    buffer_store_dwordx4 v[96:99], v112, s[36:39], s27 offen sc0 sc1
    v_cvt_pk_bf16_f32 v164, v164, v165
    v_cvt_pk_bf16_f32 v165, v166, v167
    v_cvt_pk_bf16_f32 v166, v168, v169
    v_cvt_pk_bf16_f32 v167, v170, v171
    ds_write_b128 v7, v[164:167] offset:13472
    s_waitcnt lgkmcnt(6)
    buffer_store_dwordx4 v[104:107], v113, s[36:39], s27 offen sc0 sc1
    s_add_u32 s26, s26, 344064
    s_add_u32 s27, s27, 344064
    ds_read_b128 v[128:131], v108 offset:13312
    ds_read_b128 v[136:139], v109 offset:13312
    ds_read_b128 v[144:147], v110 offset:13312
    ds_read_b128 v[152:155], v108 offset:16640
    ds_read_b128 v[160:163], v109 offset:16640
    ds_read_b128 v[168:171], v110 offset:16640
    v_cvt_pk_bf16_f32 v172, v172, v173
    v_cvt_pk_bf16_f32 v173, v174, v175
    buffer_store_dwordx2 v[172:173], v11, s[36:39], s28 offen offset:0 nt
    v_cvt_pk_bf16_f32 v176, v176, v177
    v_cvt_pk_bf16_f32 v177, v178, v179
    buffer_store_dwordx2 v[176:177], v11, s[36:39], s28 offen offset:32 nt
    v_cvt_pk_bf16_f32 v180, v180, v181
    v_cvt_pk_bf16_f32 v181, v182, v183
    buffer_store_dwordx2 v[180:181], v11, s[36:39], s28 offen offset:64 nt
    s_waitcnt lgkmcnt(5)
    buffer_store_dwordx4 v[128:131], v111, s[36:39], s26 offen nt
    s_waitcnt lgkmcnt(4)
    buffer_store_dwordx4 v[136:139], v112, s[36:39], s26 offen nt
    s_waitcnt lgkmcnt(3)
    buffer_store_dwordx4 v[144:147], v113, s[36:39], s26 offen nt
    s_waitcnt lgkmcnt(2)
    buffer_store_dwordx4 v[152:155], v111, s[36:39], s27 offen nt
    s_waitcnt lgkmcnt(1)
    buffer_store_dwordx4 v[160:163], v112, s[36:39], s27 offen nt
    s_waitcnt lgkmcnt(0)
    buffer_store_dwordx4 v[168:171], v113, s[36:39], s27 offen nt
    s_add_u32 s26, s26, 344064
    s_add_u32 s27, s27, 344064
    s_branch L_Qepi
L_QN:
    s_setprio 0
    s_add_u32 m0, s67, 124928
    s_add_u32 s69, s65, 0
    buffer_load_dwordx4 v7, s[40:43], s69 offen lds
    s_add_u32 m0, s67, 125952
    s_add_u32 s69, s65, 24576
    buffer_load_dwordx4 v7, s[40:43], s69 offen lds
    s_add_u32 m0, s67, 126976
    s_add_u32 s69, s65, 49152
    buffer_load_dwordx4 v7, s[40:43], s69 offen lds
    s_add_u32 m0, s68, 75008
    s_add_u32 s69, s66, 0
    buffer_load_dwordx4 v8, s[44:47], s69 offen lds
    s_add_u32 m0, s68, 79104
    s_add_u32 s69, s66, 128
    buffer_load_dwordx4 v8, s[44:47], s69 offen lds
    s_add_u32 m0, s68, 83200
    s_add_u32 s69, s66, 256
    buffer_load_dwordx4 v8, s[44:47], s69 offen lds
    s_add_u32 s65, s65, 64
    s_cmp_eq_u32 s65, s70
    s_cselect_b32 s69, 1536, 0
    s_sub_u32 s65, s65, s69
    s_add_u32 s66, s66, 12288
    s_cmp_eq_u32 s66, s71
    s_cselect_b32 s69, 294912, 0
    s_sub_u32 s66, s66, s69
    ds_read_b64_tr_b16 v[184:185], v1 offset:12288
    ds_read_b64_tr_b16 v[186:187], v1 offset:12800
    ds_read_b64_tr_b16 v[188:189], v2 offset:12288
    ds_read_b64_tr_b16 v[190:191], v2 offset:12800
    ds_read_b64_tr_b16 v[192:193], v1 offset:16384
    ds_read_b64_tr_b16 v[194:195], v1 offset:16896
    ds_read_b64_tr_b16 v[196:197], v1 offset:14336
    ds_read_b64_tr_b16 v[198:199], v1 offset:14848
    ds_read_b64_tr_b16 v[200:201], v2 offset:14336
    ds_read_b64_tr_b16 v[202:203], v2 offset:14848
    ds_read_b64_tr_b16 v[204:205], v1 offset:18432
    ds_read_b64_tr_b16 v[206:207], v1 offset:18944
    s_waitcnt vmcnt(6) lgkmcnt(0)
    s_barrier
    ds_read_b128 v[220:223], v6 offset:0
    ds_read_b128 v[224:227], v6 offset:4096
    ds_read_b128 v[228:231], v6 offset:8192
    ds_read_b128 v[232:235], v6 offset:1024
    ds_read_b128 v[236:239], v6 offset:5120
    ds_read_b128 v[240:243], v6 offset:9216
    s_waitcnt lgkmcnt(5)
    v_mfma_f32_32x32x16_bf16 v[12:27], v[184:187], v[220:223], v[12:27]
    s_add_u32 m0, s67, 137216
    s_add_u32 s69, s65, 0
    buffer_load_dwordx4 v7, s[40:43], s69 offen lds
    v_mfma_f32_32x32x16_bf16 v[28:43], v[188:191], v[220:223], v[28:43]
    v_mfma_f32_32x32x16_bf16 v[44:59], v[192:195], v[220:223], v[44:59]
    s_add_u32 m0, s67, 138240
    s_add_u32 s69, s65, 24576
    buffer_load_dwordx4 v7, s[40:43], s69 offen lds
    s_waitcnt lgkmcnt(4)
    v_mfma_f32_32x32x16_bf16 v[60:75], v[184:187], v[224:227], v[60:75]
    v_mfma_f32_32x32x16_bf16 v[76:91], v[188:191], v[224:227], v[76:91]
    s_add_u32 m0, s67, 139264
    s_add_u32 s69, s65, 49152
    buffer_load_dwordx4 v7, s[40:43], s69 offen lds
    v_mfma_f32_32x32x16_bf16 v[92:107], v[192:195], v[224:227], v[92:107]
    s_waitcnt lgkmcnt(3)
    v_mfma_f32_32x32x16_bf16 v[124:139], v[184:187], v[228:231], v[124:139]
    s_add_u32 m0, s68, 87296
    s_add_u32 s69, s66, 0
    buffer_load_dwordx4 v8, s[44:47], s69 offen lds
    v_mfma_f32_32x32x16_bf16 v[140:155], v[188:191], v[228:231], v[140:155]
    ds_read_b64_tr_b16 v[184:185], v1 offset:24576
    ds_read_b64_tr_b16 v[186:187], v1 offset:25088
    v_mfma_f32_32x32x16_bf16 v[156:171], v[192:195], v[228:231], v[156:171]
    ds_read_b64_tr_b16 v[188:189], v2 offset:24576
    ds_read_b64_tr_b16 v[190:191], v2 offset:25088
    s_waitcnt lgkmcnt(6)
    v_mfma_f32_32x32x16_bf16 v[12:27], v[196:199], v[232:235], v[12:27]
    ds_read_b64_tr_b16 v[192:193], v1 offset:28672
    ds_read_b64_tr_b16 v[194:195], v1 offset:29184
    v_mfma_f32_32x32x16_bf16 v[28:43], v[200:203], v[232:235], v[28:43]
    s_add_u32 m0, s68, 91392
    s_add_u32 s69, s66, 128
    buffer_load_dwordx4 v8, s[44:47], s69 offen lds
    v_mfma_f32_32x32x16_bf16 v[44:59], v[204:207], v[232:235], v[44:59]
    s_waitcnt lgkmcnt(7)
    v_mfma_f32_32x32x16_bf16 v[60:75], v[196:199], v[236:239], v[60:75]
    s_add_u32 m0, s68, 95488
    s_add_u32 s69, s66, 256
    buffer_load_dwordx4 v8, s[44:47], s69 offen lds
    v_mfma_f32_32x32x16_bf16 v[76:91], v[200:203], v[236:239], v[76:91]
    v_mfma_f32_32x32x16_bf16 v[92:107], v[204:207], v[236:239], v[92:107]
    s_waitcnt lgkmcnt(6)
    v_mfma_f32_32x32x16_bf16 v[124:139], v[196:199], v[240:243], v[124:139]
    v_mfma_f32_32x32x16_bf16 v[140:155], v[200:203], v[240:243], v[140:155]
    ds_read_b64_tr_b16 v[196:197], v1 offset:26624
    ds_read_b64_tr_b16 v[198:199], v1 offset:27136
    v_mfma_f32_32x32x16_bf16 v[156:171], v[204:207], v[240:243], v[156:171]
    ds_read_b64_tr_b16 v[200:201], v2 offset:26624
    ds_read_b64_tr_b16 v[202:203], v2 offset:27136
    ds_read_b64_tr_b16 v[204:205], v1 offset:30720
    ds_read_b64_tr_b16 v[206:207], v1 offset:31232
    s_add_u32 s65, s65, 64
    s_cmp_eq_u32 s65, s70
    s_cselect_b32 s69, 1536, 0
    s_sub_u32 s65, s65, s69
    s_add_u32 s66, s66, 12288
    s_cmp_eq_u32 s66, s71
    s_cselect_b32 s69, 294912, 0
    s_sub_u32 s66, s66, s69
    s_waitcnt vmcnt(6) lgkmcnt(0)
    s_barrier
    ds_read_b128 v[220:223], v6 offset:13312
    ds_read_b128 v[224:227], v6 offset:17408
    ds_read_b128 v[228:231], v6 offset:21504
    ds_read_b128 v[232:235], v6 offset:14336
    ds_read_b128 v[236:239], v6 offset:18432
    ds_read_b128 v[240:243], v6 offset:22528
    s_waitcnt lgkmcnt(5)
    v_mfma_f32_32x32x16_bf16 v[12:27], v[184:187], v[220:223], v[12:27]
    s_add_u32 m0, s67, 112640
    s_add_u32 s69, s65, 0
    buffer_load_dwordx4 v7, s[40:43], s69 offen lds
    v_mfma_f32_32x32x16_bf16 v[28:43], v[188:191], v[220:223], v[28:43]
    v_mfma_f32_32x32x16_bf16 v[44:59], v[192:195], v[220:223], v[44:59]
    s_add_u32 m0, s67, 113664
    s_add_u32 s69, s65, 24576
    buffer_load_dwordx4 v7, s[40:43], s69 offen lds
    s_waitcnt lgkmcnt(4)
    v_mfma_f32_32x32x16_bf16 v[60:75], v[184:187], v[224:227], v[60:75]
    v_mfma_f32_32x32x16_bf16 v[76:91], v[188:191], v[224:227], v[76:91]
    s_add_u32 m0, s67, 114688
    s_add_u32 s69, s65, 49152
    buffer_load_dwordx4 v7, s[40:43], s69 offen lds
    v_mfma_f32_32x32x16_bf16 v[92:107], v[192:195], v[224:227], v[92:107]
    s_waitcnt lgkmcnt(3)
    v_mfma_f32_32x32x16_bf16 v[124:139], v[184:187], v[228:231], v[124:139]
    s_add_u32 m0, s68, 99584
    s_add_u32 s69, s66, 0
    buffer_load_dwordx4 v8, s[44:47], s69 offen lds
    v_mfma_f32_32x32x16_bf16 v[140:155], v[188:191], v[228:231], v[140:155]
    ds_read_b64_tr_b16 v[184:185], v1 offset:0
    ds_read_b64_tr_b16 v[186:187], v1 offset:512
    v_mfma_f32_32x32x16_bf16 v[156:171], v[192:195], v[228:231], v[156:171]
    ds_read_b64_tr_b16 v[188:189], v2 offset:0
    ds_read_b64_tr_b16 v[190:191], v2 offset:512
    s_waitcnt lgkmcnt(6)
    v_mfma_f32_32x32x16_bf16 v[12:27], v[196:199], v[232:235], v[12:27]
    ds_read_b64_tr_b16 v[192:193], v1 offset:4096
    ds_read_b64_tr_b16 v[194:195], v1 offset:4608
    v_mfma_f32_32x32x16_bf16 v[28:43], v[200:203], v[232:235], v[28:43]
    s_add_u32 m0, s68, 103680
    s_add_u32 s69, s66, 128
    buffer_load_dwordx4 v8, s[44:47], s69 offen lds
    v_mfma_f32_32x32x16_bf16 v[44:59], v[204:207], v[232:235], v[44:59]
    s_waitcnt lgkmcnt(7)
    v_mfma_f32_32x32x16_bf16 v[60:75], v[196:199], v[236:239], v[60:75]
    s_add_u32 m0, s68, 107776
    s_add_u32 s69, s66, 256
    buffer_load_dwordx4 v8, s[44:47], s69 offen lds
    v_mfma_f32_32x32x16_bf16 v[76:91], v[200:203], v[236:239], v[76:91]
    v_mfma_f32_32x32x16_bf16 v[92:107], v[204:207], v[236:239], v[92:107]
    s_waitcnt lgkmcnt(6)
    v_mfma_f32_32x32x16_bf16 v[124:139], v[196:199], v[240:243], v[124:139]
    v_mfma_f32_32x32x16_bf16 v[140:155], v[200:203], v[240:243], v[140:155]
    ds_read_b64_tr_b16 v[196:197], v1 offset:2048
    ds_read_b64_tr_b16 v[198:199], v1 offset:2560
    v_mfma_f32_32x32x16_bf16 v[156:171], v[204:207], v[240:243], v[156:171]
    ds_read_b64_tr_b16 v[200:201], v2 offset:2048
    ds_read_b64_tr_b16 v[202:203], v2 offset:2560
    ds_read_b64_tr_b16 v[204:205], v1 offset:6144
    ds_read_b64_tr_b16 v[206:207], v1 offset:6656
    s_add_u32 s65, s65, 64
    s_cmp_eq_u32 s65, s70
    s_cselect_b32 s69, 1536, 0
    s_sub_u32 s65, s65, s69
    s_add_u32 s66, s66, 12288
    s_cmp_eq_u32 s66, s71
    s_cselect_b32 s69, 294912, 0
    s_sub_u32 s66, s66, s69
    s_waitcnt vmcnt(6) lgkmcnt(0)
    s_barrier
    ds_read_b128 v[220:223], v6 offset:31232
    ds_read_b128 v[224:227], v6 offset:35328
    ds_read_b128 v[228:231], v6 offset:39424
    ds_read_b128 v[232:235], v6 offset:32256
    ds_read_b128 v[236:239], v6 offset:36352
    ds_read_b128 v[240:243], v6 offset:40448
    s_waitcnt lgkmcnt(5)
    v_mfma_f32_32x32x16_bf16 v[12:27], v[184:187], v[220:223], v[12:27]
    s_add_u32 m0, s67, 124928
    s_add_u32 s69, s65, 0
    buffer_load_dwordx4 v7, s[40:43], s69 offen lds
    v_mfma_f32_32x32x16_bf16 v[28:43], v[188:191], v[220:223], v[28:43]
    v_mfma_f32_32x32x16_bf16 v[44:59], v[192:195], v[220:223], v[44:59]
    s_add_u32 m0, s67, 125952
    s_add_u32 s69, s65, 24576
    buffer_load_dwordx4 v7, s[40:43], s69 offen lds
    s_waitcnt lgkmcnt(4)
    v_mfma_f32_32x32x16_bf16 v[60:75], v[184:187], v[224:227], v[60:75]
    v_mfma_f32_32x32x16_bf16 v[76:91], v[188:191], v[224:227], v[76:91]
    s_add_u32 m0, s67, 126976
    s_add_u32 s69, s65, 49152
    buffer_load_dwordx4 v7, s[40:43], s69 offen lds
    v_mfma_f32_32x32x16_bf16 v[92:107], v[192:195], v[224:227], v[92:107]
    s_waitcnt lgkmcnt(3)
    v_mfma_f32_32x32x16_bf16 v[124:139], v[184:187], v[228:231], v[124:139]
    s_add_u32 m0, s68, 75008
    s_add_u32 s69, s66, 0
    buffer_load_dwordx4 v8, s[44:47], s69 offen lds
    v_mfma_f32_32x32x16_bf16 v[140:155], v[188:191], v[228:231], v[140:155]
    ds_read_b64_tr_b16 v[184:185], v1 offset:12288
    ds_read_b64_tr_b16 v[186:187], v1 offset:12800
    v_mfma_f32_32x32x16_bf16 v[156:171], v[192:195], v[228:231], v[156:171]
    ds_read_b64_tr_b16 v[188:189], v2 offset:12288
    ds_read_b64_tr_b16 v[190:191], v2 offset:12800
    s_waitcnt lgkmcnt(6)
    v_mfma_f32_32x32x16_bf16 v[12:27], v[196:199], v[232:235], v[12:27]
    ds_read_b64_tr_b16 v[192:193], v1 offset:16384
    ds_read_b64_tr_b16 v[194:195], v1 offset:16896
    v_mfma_f32_32x32x16_bf16 v[28:43], v[200:203], v[232:235], v[28:43]
    s_add_u32 m0, s68, 79104
    s_add_u32 s69, s66, 128
    buffer_load_dwordx4 v8, s[44:47], s69 offen lds
    v_mfma_f32_32x32x16_bf16 v[44:59], v[204:207], v[232:235], v[44:59]
    s_waitcnt lgkmcnt(7)
    v_mfma_f32_32x32x16_bf16 v[60:75], v[196:199], v[236:239], v[60:75]
    s_add_u32 m0, s68, 83200
    s_add_u32 s69, s66, 256
    buffer_load_dwordx4 v8, s[44:47], s69 offen lds
    v_mfma_f32_32x32x16_bf16 v[76:91], v[200:203], v[236:239], v[76:91]
    v_mfma_f32_32x32x16_bf16 v[92:107], v[204:207], v[236:239], v[92:107]
    s_waitcnt lgkmcnt(6)
    v_mfma_f32_32x32x16_bf16 v[124:139], v[196:199], v[240:243], v[124:139]
    v_mfma_f32_32x32x16_bf16 v[140:155], v[200:203], v[240:243], v[140:155]
    ds_read_b64_tr_b16 v[196:197], v1 offset:14336
    ds_read_b64_tr_b16 v[198:199], v1 offset:14848
    v_mfma_f32_32x32x16_bf16 v[156:171], v[204:207], v[240:243], v[156:171]
    ds_read_b64_tr_b16 v[200:201], v2 offset:14336
    ds_read_b64_tr_b16 v[202:203], v2 offset:14848
    ds_read_b64_tr_b16 v[204:205], v1 offset:18432
    ds_read_b64_tr_b16 v[206:207], v1 offset:18944
    s_add_u32 s65, s65, 64
    s_cmp_eq_u32 s65, s70
    s_cselect_b32 s69, 1536, 0
    s_sub_u32 s65, s65, s69
    s_add_u32 s66, s66, 12288
    s_cmp_eq_u32 s66, s71
    s_cselect_b32 s69, 294912, 0
    s_sub_u32 s66, s66, s69
    s_waitcnt vmcnt(6) lgkmcnt(0)
    s_barrier
    s_mov_b32 s64, 1
.p2align 3
L_QN_loop:
    ds_read_b128 v[220:223], v6 offset:0
    ds_read_b128 v[224:227], v6 offset:4096
    ds_read_b128 v[228:231], v6 offset:8192
    ds_read_b128 v[232:235], v6 offset:1024
    ds_read_b128 v[236:239], v6 offset:5120
    ds_read_b128 v[240:243], v6 offset:9216
    s_waitcnt lgkmcnt(5)
    v_mfma_f32_32x32x16_bf16 v[12:27], v[184:187], v[220:223], v[12:27]
    s_add_u32 m0, s67, 137216
    s_add_u32 s69, s65, 0
    buffer_load_dwordx4 v7, s[40:43], s69 offen lds
    v_mfma_f32_32x32x16_bf16 v[28:43], v[188:191], v[220:223], v[28:43]
    v_mfma_f32_32x32x16_bf16 v[44:59], v[192:195], v[220:223], v[44:59]
    s_add_u32 m0, s67, 138240
    s_add_u32 s69, s65, 24576
    buffer_load_dwordx4 v7, s[40:43], s69 offen lds
    s_waitcnt lgkmcnt(4)
    v_mfma_f32_32x32x16_bf16 v[60:75], v[184:187], v[224:227], v[60:75]
    v_mfma_f32_32x32x16_bf16 v[76:91], v[188:191], v[224:227], v[76:91]
    s_add_u32 m0, s67, 139264
    s_add_u32 s69, s65, 49152
    buffer_load_dwordx4 v7, s[40:43], s69 offen lds
    v_mfma_f32_32x32x16_bf16 v[92:107], v[192:195], v[224:227], v[92:107]
    s_waitcnt lgkmcnt(3)
    v_mfma_f32_32x32x16_bf16 v[124:139], v[184:187], v[228:231], v[124:139]
    s_add_u32 m0, s68, 87296
    s_add_u32 s69, s66, 0
    buffer_load_dwordx4 v8, s[44:47], s69 offen lds
    v_mfma_f32_32x32x16_bf16 v[140:155], v[188:191], v[228:231], v[140:155]
    ds_read_b64_tr_b16 v[184:185], v1 offset:24576
    ds_read_b64_tr_b16 v[186:187], v1 offset:25088
    v_mfma_f32_32x32x16_bf16 v[156:171], v[192:195], v[228:231], v[156:171]
    ds_read_b64_tr_b16 v[188:189], v2 offset:24576
    ds_read_b64_tr_b16 v[190:191], v2 offset:25088
    s_waitcnt lgkmcnt(6)
    v_mfma_f32_32x32x16_bf16 v[12:27], v[196:199], v[232:235], v[12:27]
    ds_read_b64_tr_b16 v[192:193], v1 offset:28672
    ds_read_b64_tr_b16 v[194:195], v1 offset:29184
    v_mfma_f32_32x32x16_bf16 v[28:43], v[200:203], v[232:235], v[28:43]
    s_add_u32 m0, s68, 91392
    s_add_u32 s69, s66, 128
    buffer_load_dwordx4 v8, s[44:47], s69 offen lds
    v_mfma_f32_32x32x16_bf16 v[44:59], v[204:207], v[232:235], v[44:59]
    s_waitcnt lgkmcnt(7)
    v_mfma_f32_32x32x16_bf16 v[60:75], v[196:199], v[236:239], v[60:75]
    s_add_u32 m0, s68, 95488
    s_add_u32 s69, s66, 256
    buffer_load_dwordx4 v8, s[44:47], s69 offen lds
    v_mfma_f32_32x32x16_bf16 v[76:91], v[200:203], v[236:239], v[76:91]
    v_mfma_f32_32x32x16_bf16 v[92:107], v[204:207], v[236:239], v[92:107]
    s_waitcnt lgkmcnt(6)
    v_mfma_f32_32x32x16_bf16 v[124:139], v[196:199], v[240:243], v[124:139]
    v_mfma_f32_32x32x16_bf16 v[140:155], v[200:203], v[240:243], v[140:155]
    ds_read_b64_tr_b16 v[196:197], v1 offset:26624
    ds_read_b64_tr_b16 v[198:199], v1 offset:27136
    v_mfma_f32_32x32x16_bf16 v[156:171], v[204:207], v[240:243], v[156:171]
    ds_read_b64_tr_b16 v[200:201], v2 offset:26624
    ds_read_b64_tr_b16 v[202:203], v2 offset:27136
    ds_read_b64_tr_b16 v[204:205], v1 offset:30720
    ds_read_b64_tr_b16 v[206:207], v1 offset:31232
    s_add_u32 s65, s65, 64
    s_cmp_eq_u32 s65, s70
    s_cselect_b32 s69, 1536, 0
    s_sub_u32 s65, s65, s69
    s_add_u32 s66, s66, 12288
    s_cmp_eq_u32 s66, s71
    s_cselect_b32 s69, 294912, 0
    s_sub_u32 s66, s66, s69
    s_waitcnt vmcnt(6) lgkmcnt(0)
    s_barrier
    ds_read_b128 v[220:223], v6 offset:13312
    ds_read_b128 v[224:227], v6 offset:17408
    ds_read_b128 v[228:231], v6 offset:21504
    ds_read_b128 v[232:235], v6 offset:14336
    ds_read_b128 v[236:239], v6 offset:18432
    ds_read_b128 v[240:243], v6 offset:22528
    s_waitcnt lgkmcnt(5)
    v_mfma_f32_32x32x16_bf16 v[12:27], v[184:187], v[220:223], v[12:27]
    s_add_u32 m0, s67, 112640
    s_add_u32 s69, s65, 0
    buffer_load_dwordx4 v7, s[40:43], s69 offen lds
    v_mfma_f32_32x32x16_bf16 v[28:43], v[188:191], v[220:223], v[28:43]
    v_mfma_f32_32x32x16_bf16 v[44:59], v[192:195], v[220:223], v[44:59]
    s_add_u32 m0, s67, 113664
    s_add_u32 s69, s65, 24576
    buffer_load_dwordx4 v7, s[40:43], s69 offen lds
    s_waitcnt lgkmcnt(4)
    v_mfma_f32_32x32x16_bf16 v[60:75], v[184:187], v[224:227], v[60:75]
    v_mfma_f32_32x32x16_bf16 v[76:91], v[188:191], v[224:227], v[76:91]
    s_add_u32 m0, s67, 114688
    s_add_u32 s69, s65, 49152
    buffer_load_dwordx4 v7, s[40:43], s69 offen lds
    v_mfma_f32_32x32x16_bf16 v[92:107], v[192:195], v[224:227], v[92:107]
    s_waitcnt lgkmcnt(3)
    v_mfma_f32_32x32x16_bf16 v[124:139], v[184:187], v[228:231], v[124:139]
    s_add_u32 m0, s68, 99584
    s_add_u32 s69, s66, 0
    buffer_load_dwordx4 v8, s[44:47], s69 offen lds
    v_mfma_f32_32x32x16_bf16 v[140:155], v[188:191], v[228:231], v[140:155]
    ds_read_b64_tr_b16 v[184:185], v1 offset:0
    ds_read_b64_tr_b16 v[186:187], v1 offset:512
    v_mfma_f32_32x32x16_bf16 v[156:171], v[192:195], v[228:231], v[156:171]
    ds_read_b64_tr_b16 v[188:189], v2 offset:0
    ds_read_b64_tr_b16 v[190:191], v2 offset:512
    s_waitcnt lgkmcnt(6)
    v_mfma_f32_32x32x16_bf16 v[12:27], v[196:199], v[232:235], v[12:27]
    ds_read_b64_tr_b16 v[192:193], v1 offset:4096
    ds_read_b64_tr_b16 v[194:195], v1 offset:4608
    v_mfma_f32_32x32x16_bf16 v[28:43], v[200:203], v[232:235], v[28:43]
    s_add_u32 m0, s68, 103680
    s_add_u32 s69, s66, 128
    buffer_load_dwordx4 v8, s[44:47], s69 offen lds
    v_mfma_f32_32x32x16_bf16 v[44:59], v[204:207], v[232:235], v[44:59]
    s_waitcnt lgkmcnt(7)
    v_mfma_f32_32x32x16_bf16 v[60:75], v[196:199], v[236:239], v[60:75]
    s_add_u32 m0, s68, 107776
    s_add_u32 s69, s66, 256
    buffer_load_dwordx4 v8, s[44:47], s69 offen lds
    v_mfma_f32_32x32x16_bf16 v[76:91], v[200:203], v[236:239], v[76:91]
    v_mfma_f32_32x32x16_bf16 v[92:107], v[204:207], v[236:239], v[92:107]
    s_waitcnt lgkmcnt(6)
    v_mfma_f32_32x32x16_bf16 v[124:139], v[196:199], v[240:243], v[124:139]
    v_mfma_f32_32x32x16_bf16 v[140:155], v[200:203], v[240:243], v[140:155]
    ds_read_b64_tr_b16 v[196:197], v1 offset:2048
    ds_read_b64_tr_b16 v[198:199], v1 offset:2560
    v_mfma_f32_32x32x16_bf16 v[156:171], v[204:207], v[240:243], v[156:171]
    ds_read_b64_tr_b16 v[200:201], v2 offset:2048
    ds_read_b64_tr_b16 v[202:203], v2 offset:2560
    ds_read_b64_tr_b16 v[204:205], v1 offset:6144
    ds_read_b64_tr_b16 v[206:207], v1 offset:6656
    s_add_u32 s65, s65, 64
    s_cmp_eq_u32 s65, s70
    s_cselect_b32 s69, 1536, 0
    s_sub_u32 s65, s65, s69
    s_add_u32 s66, s66, 12288
    s_cmp_eq_u32 s66, s71
    s_cselect_b32 s69, 294912, 0
    s_sub_u32 s66, s66, s69
    s_waitcnt vmcnt(6) lgkmcnt(0)
    s_barrier
    ds_read_b128 v[220:223], v6 offset:31232
    ds_read_b128 v[224:227], v6 offset:35328
    ds_read_b128 v[228:231], v6 offset:39424
    ds_read_b128 v[232:235], v6 offset:32256
    ds_read_b128 v[236:239], v6 offset:36352
    ds_read_b128 v[240:243], v6 offset:40448
    s_waitcnt lgkmcnt(5)
    v_mfma_f32_32x32x16_bf16 v[12:27], v[184:187], v[220:223], v[12:27]
    s_add_u32 m0, s67, 124928
    s_add_u32 s69, s65, 0
    buffer_load_dwordx4 v7, s[40:43], s69 offen lds
    v_mfma_f32_32x32x16_bf16 v[28:43], v[188:191], v[220:223], v[28:43]
    v_mfma_f32_32x32x16_bf16 v[44:59], v[192:195], v[220:223], v[44:59]
    s_add_u32 m0, s67, 125952
    s_add_u32 s69, s65, 24576
    buffer_load_dwordx4 v7, s[40:43], s69 offen lds
    s_waitcnt lgkmcnt(4)
    v_mfma_f32_32x32x16_bf16 v[60:75], v[184:187], v[224:227], v[60:75]
    v_mfma_f32_32x32x16_bf16 v[76:91], v[188:191], v[224:227], v[76:91]
    s_add_u32 m0, s67, 126976
    s_add_u32 s69, s65, 49152
    buffer_load_dwordx4 v7, s[40:43], s69 offen lds
    v_mfma_f32_32x32x16_bf16 v[92:107], v[192:195], v[224:227], v[92:107]
    s_waitcnt lgkmcnt(3)
    v_mfma_f32_32x32x16_bf16 v[124:139], v[184:187], v[228:231], v[124:139]
    s_add_u32 m0, s68, 75008
    s_add_u32 s69, s66, 0
    buffer_load_dwordx4 v8, s[44:47], s69 offen lds
    v_mfma_f32_32x32x16_bf16 v[140:155], v[188:191], v[228:231], v[140:155]
    ds_read_b64_tr_b16 v[184:185], v1 offset:12288
    ds_read_b64_tr_b16 v[186:187], v1 offset:12800
    v_mfma_f32_32x32x16_bf16 v[156:171], v[192:195], v[228:231], v[156:171]
    ds_read_b64_tr_b16 v[188:189], v2 offset:12288
    ds_read_b64_tr_b16 v[190:191], v2 offset:12800
    s_waitcnt lgkmcnt(6)
    v_mfma_f32_32x32x16_bf16 v[12:27], v[196:199], v[232:235], v[12:27]
    ds_read_b64_tr_b16 v[192:193], v1 offset:16384
    ds_read_b64_tr_b16 v[194:195], v1 offset:16896
    v_mfma_f32_32x32x16_bf16 v[28:43], v[200:203], v[232:235], v[28:43]
    s_add_u32 m0, s68, 79104
    s_add_u32 s69, s66, 128
    buffer_load_dwordx4 v8, s[44:47], s69 offen lds
    v_mfma_f32_32x32x16_bf16 v[44:59], v[204:207], v[232:235], v[44:59]
    s_waitcnt lgkmcnt(7)
    v_mfma_f32_32x32x16_bf16 v[60:75], v[196:199], v[236:239], v[60:75]
    s_add_u32 m0, s68, 83200
    s_add_u32 s69, s66, 256
    buffer_load_dwordx4 v8, s[44:47], s69 offen lds
    v_mfma_f32_32x32x16_bf16 v[76:91], v[200:203], v[236:239], v[76:91]
    v_mfma_f32_32x32x16_bf16 v[92:107], v[204:207], v[236:239], v[92:107]
    s_waitcnt lgkmcnt(6)
    v_mfma_f32_32x32x16_bf16 v[124:139], v[196:199], v[240:243], v[124:139]
    v_mfma_f32_32x32x16_bf16 v[140:155], v[200:203], v[240:243], v[140:155]
    ds_read_b64_tr_b16 v[196:197], v1 offset:14336
    ds_read_b64_tr_b16 v[198:199], v1 offset:14848
    v_mfma_f32_32x32x16_bf16 v[156:171], v[204:207], v[240:243], v[156:171]
    ds_read_b64_tr_b16 v[200:201], v2 offset:14336
    ds_read_b64_tr_b16 v[202:203], v2 offset:14848
    ds_read_b64_tr_b16 v[204:205], v1 offset:18432
    ds_read_b64_tr_b16 v[206:207], v1 offset:18944
    s_add_u32 s65, s65, 64
    s_cmp_eq_u32 s65, s70
    s_cselect_b32 s69, 1536, 0
    s_sub_u32 s65, s65, s69
    s_add_u32 s66, s66, 12288
    s_cmp_eq_u32 s66, s71
    s_cselect_b32 s69, 294912, 0
    s_sub_u32 s66, s66, s69
    s_waitcnt vmcnt(6) lgkmcnt(0)
    s_barrier
    ds_read_b128 v[220:223], v6 offset:0
    ds_read_b128 v[224:227], v6 offset:4096
    ds_read_b128 v[228:231], v6 offset:8192
    ds_read_b128 v[232:235], v6 offset:1024
    ds_read_b128 v[236:239], v6 offset:5120
    ds_read_b128 v[240:243], v6 offset:9216
    s_waitcnt lgkmcnt(5)
    v_mfma_f32_32x32x16_bf16 v[12:27], v[184:187], v[220:223], v[12:27]
    s_add_u32 m0, s67, 137216
    s_add_u32 s69, s65, 0
    buffer_load_dwordx4 v7, s[40:43], s69 offen lds
    v_mfma_f32_32x32x16_bf16 v[28:43], v[188:191], v[220:223], v[28:43]
    v_mfma_f32_32x32x16_bf16 v[44:59], v[192:195], v[220:223], v[44:59]
    s_add_u32 m0, s67, 138240
    s_add_u32 s69, s65, 24576
    buffer_load_dwordx4 v7, s[40:43], s69 offen lds
    s_waitcnt lgkmcnt(4)
    v_mfma_f32_32x32x16_bf16 v[60:75], v[184:187], v[224:227], v[60:75]
    v_mfma_f32_32x32x16_bf16 v[76:91], v[188:191], v[224:227], v[76:91]
    s_add_u32 m0, s67, 139264
    s_add_u32 s69, s65, 49152
    buffer_load_dwordx4 v7, s[40:43], s69 offen lds
    v_mfma_f32_32x32x16_bf16 v[92:107], v[192:195], v[224:227], v[92:107]
    s_waitcnt lgkmcnt(3)
    v_mfma_f32_32x32x16_bf16 v[124:139], v[184:187], v[228:231], v[124:139]
    s_add_u32 m0, s68, 87296
    s_add_u32 s69, s66, 0
    buffer_load_dwordx4 v8, s[44:47], s69 offen lds
    v_mfma_f32_32x32x16_bf16 v[140:155], v[188:191], v[228:231], v[140:155]
    ds_read_b64_tr_b16 v[184:185], v1 offset:24576
    ds_read_b64_tr_b16 v[186:187], v1 offset:25088
    v_mfma_f32_32x32x16_bf16 v[156:171], v[192:195], v[228:231], v[156:171]
    ds_read_b64_tr_b16 v[188:189], v2 offset:24576
    ds_read_b64_tr_b16 v[190:191], v2 offset:25088
    s_waitcnt lgkmcnt(6)
    v_mfma_f32_32x32x16_bf16 v[12:27], v[196:199], v[232:235], v[12:27]
    ds_read_b64_tr_b16 v[192:193], v1 offset:28672
    ds_read_b64_tr_b16 v[194:195], v1 offset:29184
    v_mfma_f32_32x32x16_bf16 v[28:43], v[200:203], v[232:235], v[28:43]
    s_add_u32 m0, s68, 91392
    s_add_u32 s69, s66, 128
    buffer_load_dwordx4 v8, s[44:47], s69 offen lds
    v_mfma_f32_32x32x16_bf16 v[44:59], v[204:207], v[232:235], v[44:59]
    s_waitcnt lgkmcnt(7)
    v_mfma_f32_32x32x16_bf16 v[60:75], v[196:199], v[236:239], v[60:75]
    s_add_u32 m0, s68, 95488
    s_add_u32 s69, s66, 256
    buffer_load_dwordx4 v8, s[44:47], s69 offen lds
    v_mfma_f32_32x32x16_bf16 v[76:91], v[200:203], v[236:239], v[76:91]
    v_mfma_f32_32x32x16_bf16 v[92:107], v[204:207], v[236:239], v[92:107]
    s_waitcnt lgkmcnt(6)
    v_mfma_f32_32x32x16_bf16 v[124:139], v[196:199], v[240:243], v[124:139]
    v_mfma_f32_32x32x16_bf16 v[140:155], v[200:203], v[240:243], v[140:155]
    ds_read_b64_tr_b16 v[196:197], v1 offset:26624
    ds_read_b64_tr_b16 v[198:199], v1 offset:27136
    v_mfma_f32_32x32x16_bf16 v[156:171], v[204:207], v[240:243], v[156:171]
    ds_read_b64_tr_b16 v[200:201], v2 offset:26624
    ds_read_b64_tr_b16 v[202:203], v2 offset:27136
    ds_read_b64_tr_b16 v[204:205], v1 offset:30720
    ds_read_b64_tr_b16 v[206:207], v1 offset:31232
    s_add_u32 s65, s65, 64
    s_cmp_eq_u32 s65, s70
    s_cselect_b32 s69, 1536, 0
    s_sub_u32 s65, s65, s69
    s_add_u32 s66, s66, 12288
    s_cmp_eq_u32 s66, s71
    s_cselect_b32 s69, 294912, 0
    s_sub_u32 s66, s66, s69
    s_waitcnt vmcnt(6) lgkmcnt(0)
    s_barrier
    ds_read_b128 v[220:223], v6 offset:13312
    ds_read_b128 v[224:227], v6 offset:17408
    ds_read_b128 v[228:231], v6 offset:21504
    ds_read_b128 v[232:235], v6 offset:14336
    ds_read_b128 v[236:239], v6 offset:18432
    ds_read_b128 v[240:243], v6 offset:22528
    s_waitcnt lgkmcnt(5)
    v_mfma_f32_32x32x16_bf16 v[12:27], v[184:187], v[220:223], v[12:27]
    s_add_u32 m0, s67, 112640
    s_add_u32 s69, s65, 0
    buffer_load_dwordx4 v7, s[40:43], s69 offen lds
    v_mfma_f32_32x32x16_bf16 v[28:43], v[188:191], v[220:223], v[28:43]
    v_mfma_f32_32x32x16_bf16 v[44:59], v[192:195], v[220:223], v[44:59]
    s_add_u32 m0, s67, 113664
    s_add_u32 s69, s65, 24576
    buffer_load_dwordx4 v7, s[40:43], s69 offen lds
    s_waitcnt lgkmcnt(4)
    v_mfma_f32_32x32x16_bf16 v[60:75], v[184:187], v[224:227], v[60:75]
    v_mfma_f32_32x32x16_bf16 v[76:91], v[188:191], v[224:227], v[76:91]
    s_add_u32 m0, s67, 114688
    s_add_u32 s69, s65, 49152
    buffer_load_dwordx4 v7, s[40:43], s69 offen lds
    v_mfma_f32_32x32x16_bf16 v[92:107], v[192:195], v[224:227], v[92:107]
    s_waitcnt lgkmcnt(3)
    v_mfma_f32_32x32x16_bf16 v[124:139], v[184:187], v[228:231], v[124:139]
    s_add_u32 m0, s68, 99584
    s_add_u32 s69, s66, 0
    buffer_load_dwordx4 v8, s[44:47], s69 offen lds
    v_mfma_f32_32x32x16_bf16 v[140:155], v[188:191], v[228:231], v[140:155]
    ds_read_b64_tr_b16 v[184:185], v1 offset:0
    ds_read_b64_tr_b16 v[186:187], v1 offset:512
    v_mfma_f32_32x32x16_bf16 v[156:171], v[192:195], v[228:231], v[156:171]
    ds_read_b64_tr_b16 v[188:189], v2 offset:0
    ds_read_b64_tr_b16 v[190:191], v2 offset:512
    s_waitcnt lgkmcnt(6)
    v_mfma_f32_32x32x16_bf16 v[12:27], v[196:199], v[232:235], v[12:27]
    ds_read_b64_tr_b16 v[192:193], v1 offset:4096
    ds_read_b64_tr_b16 v[194:195], v1 offset:4608
    v_mfma_f32_32x32x16_bf16 v[28:43], v[200:203], v[232:235], v[28:43]
    s_add_u32 m0, s68, 103680
    s_add_u32 s69, s66, 128
    buffer_load_dwordx4 v8, s[44:47], s69 offen lds
    v_mfma_f32_32x32x16_bf16 v[44:59], v[204:207], v[232:235], v[44:59]
    s_waitcnt lgkmcnt(7)
    v_mfma_f32_32x32x16_bf16 v[60:75], v[196:199], v[236:239], v[60:75]
    s_add_u32 m0, s68, 107776
    s_add_u32 s69, s66, 256
    buffer_load_dwordx4 v8, s[44:47], s69 offen lds
    v_mfma_f32_32x32x16_bf16 v[76:91], v[200:203], v[236:239], v[76:91]
    v_mfma_f32_32x32x16_bf16 v[92:107], v[204:207], v[236:239], v[92:107]
    s_waitcnt lgkmcnt(6)
    v_mfma_f32_32x32x16_bf16 v[124:139], v[196:199], v[240:243], v[124:139]
    v_mfma_f32_32x32x16_bf16 v[140:155], v[200:203], v[240:243], v[140:155]
    ds_read_b64_tr_b16 v[196:197], v1 offset:2048
    ds_read_b64_tr_b16 v[198:199], v1 offset:2560
    v_mfma_f32_32x32x16_bf16 v[156:171], v[204:207], v[240:243], v[156:171]
    ds_read_b64_tr_b16 v[200:201], v2 offset:2048
    ds_read_b64_tr_b16 v[202:203], v2 offset:2560
    ds_read_b64_tr_b16 v[204:205], v1 offset:6144
    ds_read_b64_tr_b16 v[206:207], v1 offset:6656
    s_add_u32 s65, s65, 64
    s_cmp_eq_u32 s65, s70
    s_cselect_b32 s69, 1536, 0
    s_sub_u32 s65, s65, s69
    s_add_u32 s66, s66, 12288
    s_cmp_eq_u32 s66, s71
    s_cselect_b32 s69, 294912, 0
    s_sub_u32 s66, s66, s69
    s_add_u32 s64, s64, 2
    s_cmp_lt_u32 s64, 7
    s_cselect_b32 s42, 294912, 0
    s_waitcnt vmcnt(6) lgkmcnt(0)
    s_barrier
    ds_read_b128 v[220:223], v6 offset:31232
    ds_read_b128 v[224:227], v6 offset:35328
    ds_read_b128 v[228:231], v6 offset:39424
    ds_read_b128 v[232:235], v6 offset:32256
    ds_read_b128 v[236:239], v6 offset:36352
    ds_read_b128 v[240:243], v6 offset:40448
    s_waitcnt lgkmcnt(5)
    v_mfma_f32_32x32x16_bf16 v[12:27], v[184:187], v[220:223], v[12:27]
    s_add_u32 m0, s67, 124928
    s_add_u32 s69, s65, 0
    buffer_load_dwordx4 v7, s[40:43], s69 offen lds
    v_mfma_f32_32x32x16_bf16 v[28:43], v[188:191], v[220:223], v[28:43]
    v_mfma_f32_32x32x16_bf16 v[44:59], v[192:195], v[220:223], v[44:59]
    s_add_u32 m0, s67, 125952
    s_add_u32 s69, s65, 24576
    buffer_load_dwordx4 v7, s[40:43], s69 offen lds
    s_waitcnt lgkmcnt(4)
    v_mfma_f32_32x32x16_bf16 v[60:75], v[184:187], v[224:227], v[60:75]
    v_mfma_f32_32x32x16_bf16 v[76:91], v[188:191], v[224:227], v[76:91]
    s_add_u32 m0, s67, 126976
    s_add_u32 s69, s65, 49152
    buffer_load_dwordx4 v7, s[40:43], s69 offen lds
    v_mfma_f32_32x32x16_bf16 v[92:107], v[192:195], v[224:227], v[92:107]
    s_waitcnt lgkmcnt(3)
    v_mfma_f32_32x32x16_bf16 v[124:139], v[184:187], v[228:231], v[124:139]
    s_add_u32 m0, s68, 75008
    s_add_u32 s69, s66, 0
    buffer_load_dwordx4 v8, s[44:47], s69 offen lds
    v_mfma_f32_32x32x16_bf16 v[140:155], v[188:191], v[228:231], v[140:155]
    ds_read_b64_tr_b16 v[184:185], v1 offset:12288
    ds_read_b64_tr_b16 v[186:187], v1 offset:12800
    v_mfma_f32_32x32x16_bf16 v[156:171], v[192:195], v[228:231], v[156:171]
    ds_read_b64_tr_b16 v[188:189], v2 offset:12288
    ds_read_b64_tr_b16 v[190:191], v2 offset:12800
    s_waitcnt lgkmcnt(6)
    v_mfma_f32_32x32x16_bf16 v[12:27], v[196:199], v[232:235], v[12:27]
    ds_read_b64_tr_b16 v[192:193], v1 offset:16384
    ds_read_b64_tr_b16 v[194:195], v1 offset:16896
    v_mfma_f32_32x32x16_bf16 v[28:43], v[200:203], v[232:235], v[28:43]
    s_add_u32 m0, s68, 79104
    s_add_u32 s69, s66, 128
    buffer_load_dwordx4 v8, s[44:47], s69 offen lds
    v_mfma_f32_32x32x16_bf16 v[44:59], v[204:207], v[232:235], v[44:59]
    s_waitcnt lgkmcnt(7)
    v_mfma_f32_32x32x16_bf16 v[60:75], v[196:199], v[236:239], v[60:75]
    s_add_u32 m0, s68, 83200
    s_add_u32 s69, s66, 256
    buffer_load_dwordx4 v8, s[44:47], s69 offen lds
    v_mfma_f32_32x32x16_bf16 v[76:91], v[200:203], v[236:239], v[76:91]
    v_mfma_f32_32x32x16_bf16 v[92:107], v[204:207], v[236:239], v[92:107]
    s_waitcnt lgkmcnt(6)
    v_mfma_f32_32x32x16_bf16 v[124:139], v[196:199], v[240:243], v[124:139]
    v_mfma_f32_32x32x16_bf16 v[140:155], v[200:203], v[240:243], v[140:155]
    ds_read_b64_tr_b16 v[196:197], v1 offset:14336
    ds_read_b64_tr_b16 v[198:199], v1 offset:14848
    v_mfma_f32_32x32x16_bf16 v[156:171], v[204:207], v[240:243], v[156:171]
    ds_read_b64_tr_b16 v[200:201], v2 offset:14336
    ds_read_b64_tr_b16 v[202:203], v2 offset:14848
    ds_read_b64_tr_b16 v[204:205], v1 offset:18432
    ds_read_b64_tr_b16 v[206:207], v1 offset:18944
    s_add_u32 s65, s65, 64
    s_cmp_eq_u32 s65, s70
    s_cselect_b32 s69, 1536, 0
    s_sub_u32 s65, s65, s69
    s_add_u32 s66, s66, 12288
    s_cmp_eq_u32 s66, s71
    s_cselect_b32 s69, 294912, 0
    s_sub_u32 s66, s66, s69
    s_waitcnt vmcnt(6) lgkmcnt(0)
    s_cmp_lt_u32 s64, 7
    s_barrier
    s_cbranch_scc1 L_QN_loop
    ds_read_b128 v[220:223], v6 offset:0
    ds_read_b128 v[224:227], v6 offset:4096
    ds_read_b128 v[228:231], v6 offset:8192
    ds_read_b128 v[232:235], v6 offset:1024
    ds_read_b128 v[236:239], v6 offset:5120
    ds_read_b128 v[240:243], v6 offset:9216
    s_waitcnt lgkmcnt(5)
    v_mfma_f32_32x32x16_bf16 v[12:27], v[184:187], v[220:223], v[12:27]
    v_mfma_f32_32x32x16_bf16 v[28:43], v[188:191], v[220:223], v[28:43]
    v_mfma_f32_32x32x16_bf16 v[44:59], v[192:195], v[220:223], v[44:59]
    s_waitcnt lgkmcnt(4)
    v_mfma_f32_32x32x16_bf16 v[60:75], v[184:187], v[224:227], v[60:75]
    v_mfma_f32_32x32x16_bf16 v[76:91], v[188:191], v[224:227], v[76:91]
    v_mfma_f32_32x32x16_bf16 v[92:107], v[192:195], v[224:227], v[92:107]
    s_waitcnt lgkmcnt(3)
    v_mfma_f32_32x32x16_bf16 v[124:139], v[184:187], v[228:231], v[124:139]
    v_mfma_f32_32x32x16_bf16 v[140:155], v[188:191], v[228:231], v[140:155]
    ds_read_b64_tr_b16 v[184:185], v1 offset:24576
    ds_read_b64_tr_b16 v[186:187], v1 offset:25088
    v_mfma_f32_32x32x16_bf16 v[156:171], v[192:195], v[228:231], v[156:171]
    ds_read_b64_tr_b16 v[188:189], v2 offset:24576
    ds_read_b64_tr_b16 v[190:191], v2 offset:25088
    s_waitcnt lgkmcnt(6)
    v_mfma_f32_32x32x16_bf16 v[12:27], v[196:199], v[232:235], v[12:27]
    ds_read_b64_tr_b16 v[192:193], v1 offset:28672
    ds_read_b64_tr_b16 v[194:195], v1 offset:29184
    v_mfma_f32_32x32x16_bf16 v[28:43], v[200:203], v[232:235], v[28:43]
    v_mfma_f32_32x32x16_bf16 v[44:59], v[204:207], v[232:235], v[44:59]
    s_waitcnt lgkmcnt(7)
    v_mfma_f32_32x32x16_bf16 v[60:75], v[196:199], v[236:239], v[60:75]
    v_mfma_f32_32x32x16_bf16 v[76:91], v[200:203], v[236:239], v[76:91]
    v_mfma_f32_32x32x16_bf16 v[92:107], v[204:207], v[236:239], v[92:107]
    s_waitcnt lgkmcnt(6)
    v_mfma_f32_32x32x16_bf16 v[124:139], v[196:199], v[240:243], v[124:139]
    v_mfma_f32_32x32x16_bf16 v[140:155], v[200:203], v[240:243], v[140:155]
    ds_read_b64_tr_b16 v[196:197], v1 offset:26624
    ds_read_b64_tr_b16 v[198:199], v1 offset:27136
    v_mfma_f32_32x32x16_bf16 v[156:171], v[204:207], v[240:243], v[156:171]
    ds_read_b64_tr_b16 v[200:201], v2 offset:26624
    ds_read_b64_tr_b16 v[202:203], v2 offset:27136
    ds_read_b64_tr_b16 v[204:205], v1 offset:30720
    ds_read_b64_tr_b16 v[206:207], v1 offset:31232
    s_waitcnt vmcnt(0) lgkmcnt(0)
    s_barrier
    ds_read_b128 v[220:223], v6 offset:13312
    ds_read_b128 v[224:227], v6 offset:17408
    ds_read_b128 v[228:231], v6 offset:21504
    ds_read_b128 v[232:235], v6 offset:14336
    ds_read_b128 v[236:239], v6 offset:18432
    ds_read_b128 v[240:243], v6 offset:22528
    s_waitcnt lgkmcnt(5)
    v_mfma_f32_32x32x16_bf16 v[12:27], v[184:187], v[220:223], v[12:27]
    v_mfma_f32_32x32x16_bf16 v[28:43], v[188:191], v[220:223], v[28:43]
    v_mfma_f32_32x32x16_bf16 v[44:59], v[192:195], v[220:223], v[44:59]
    s_waitcnt lgkmcnt(4)
    v_mfma_f32_32x32x16_bf16 v[60:75], v[184:187], v[224:227], v[60:75]
    v_mfma_f32_32x32x16_bf16 v[76:91], v[188:191], v[224:227], v[76:91]
    v_mfma_f32_32x32x16_bf16 v[92:107], v[192:195], v[224:227], v[92:107]
    s_waitcnt lgkmcnt(3)
    v_mfma_f32_32x32x16_bf16 v[124:139], v[184:187], v[228:231], v[124:139]
    v_mfma_f32_32x32x16_bf16 v[140:155], v[188:191], v[228:231], v[140:155]
    ds_read_b64_tr_b16 v[184:185], v1 offset:0
    ds_read_b64_tr_b16 v[186:187], v1 offset:512
    v_mfma_f32_32x32x16_bf16 v[156:171], v[192:195], v[228:231], v[156:171]
    ds_read_b64_tr_b16 v[188:189], v2 offset:0
    ds_read_b64_tr_b16 v[190:191], v2 offset:512
    s_waitcnt lgkmcnt(6)
    v_mfma_f32_32x32x16_bf16 v[12:27], v[196:199], v[232:235], v[12:27]
    ds_read_b64_tr_b16 v[192:193], v1 offset:4096
    ds_read_b64_tr_b16 v[194:195], v1 offset:4608
    v_mfma_f32_32x32x16_bf16 v[28:43], v[200:203], v[232:235], v[28:43]
    v_mfma_f32_32x32x16_bf16 v[44:59], v[204:207], v[232:235], v[44:59]
    s_waitcnt lgkmcnt(7)
    v_mfma_f32_32x32x16_bf16 v[60:75], v[196:199], v[236:239], v[60:75]
    v_mfma_f32_32x32x16_bf16 v[76:91], v[200:203], v[236:239], v[76:91]
    v_mfma_f32_32x32x16_bf16 v[92:107], v[204:207], v[236:239], v[92:107]
    s_waitcnt lgkmcnt(6)
    v_mfma_f32_32x32x16_bf16 v[124:139], v[196:199], v[240:243], v[124:139]
    v_mfma_f32_32x32x16_bf16 v[140:155], v[200:203], v[240:243], v[140:155]
    ds_read_b64_tr_b16 v[196:197], v1 offset:2048
    ds_read_b64_tr_b16 v[198:199], v1 offset:2560
    v_mfma_f32_32x32x16_bf16 v[156:171], v[204:207], v[240:243], v[156:171]
    ds_read_b64_tr_b16 v[200:201], v2 offset:2048
    ds_read_b64_tr_b16 v[202:203], v2 offset:2560
    ds_read_b64_tr_b16 v[204:205], v1 offset:6144
    ds_read_b64_tr_b16 v[206:207], v1 offset:6656
    s_waitcnt vmcnt(0) lgkmcnt(0)
    v_mbcnt_lo_u32_b32 v9, -1, 0
    v_mbcnt_hi_u32_b32 v9, -1, v9
    s_and_b32 s29, s20, 3
    s_mul_i32 s31, s29, 19968
    s_add_u32 s31, s31, 44544
    v_and_b32 v10, 31, v9
    v_mul_u32_u24 v7, 208, v10
    v_lshrrev_b32 v10, 5, v9
    v_lshl_add_u32 v7, v10, 4, v7
    v_add_u32 v7, s31, v7
    v_and_b32 v10, 15, v9
    v_mul_u32_u24 v10, 384, v10
    v_lshrrev_b32 v11, 4, v9
    v_lshl_add_u32 v11, v11, 3, v10
    v_add_u32 v10, 0, v9
    v_mul_u32_u24 v8, 171, v10
    v_lshrrev_b32 v8, 11, v8
    v_mul_u32_u24 v108, 12, v8
    v_sub_u32 v10, v10, v108
    v_lshlrev_b32 v10, 4, v10
    v_mul_u32_u24 v108, 208, v8
    v_add3_u32 v108, v108, v10, s31
    v_mul_u32_u24 v111, 384, v8
    v_add_u32 v111, v111, v10
    v_add_u32 v10, 64, v9
    v_mul_u32_u24 v8, 171, v10
    v_lshrrev_b32 v8, 11, v8
    v_mul_u32_u24 v109, 12, v8
    v_sub_u32 v10, v10, v109
    v_lshlrev_b32 v10, 4, v10
    v_mul_u32_u24 v109, 208, v8
    v_add3_u32 v109, v109, v10, s31
    v_mul_u32_u24 v112, 384, v8
    v_add_u32 v112, v112, v10
    v_add_u32 v10, 128, v9
    v_mul_u32_u24 v8, 171, v10
    v_lshrrev_b32 v8, 11, v8
    v_mul_u32_u24 v110, 12, v8
    v_sub_u32 v10, v10, v110
    v_lshlrev_b32 v10, 4, v10
    v_mul_u32_u24 v110, 208, v8
    v_add3_u32 v110, v110, v10, s31
    v_mul_u32_u24 v113, 384, v8
    v_add_u32 v113, v113, v10
    s_add_u32 s26, s24, s21
    s_add_u32 s26, s26, 1
    s_mul_i32 s26, s26, 224
    s_add_u32 s26, s26, s22
    s_mul_i32 s26, s26, 384
    s_mul_i32 s27, s25, 192
    s_add_u32 s26, s26, s27
    s_add_u32 s27, s26, 172032
    s_mul_i32 s28, s21, 224
    s_add_u32 s28, s28, s22
    s_mul_i32 s28, s28, 384
    s_mul_i32 s29, s29, 96
    s_add_u32 s28, s28, s29
    s_barrier
    ds_read_b128 v[220:223], v6 offset:31232
    ds_read_b128 v[232:235], v6 offset:32256
    ds_read_b128 v[224:227], v6 offset:35328
    ds_read_b128 v[236:239], v6 offset:36352
    ds_read_b128 v[228:231], v6 offset:39424
    ds_read_b128 v[240:243], v6 offset:40448
    s_waitcnt lgkmcnt(5)
    v_mfma_f32_32x32x16_bf16 v[12:27], v[184:187], v[220:223], v[12:27]
    v_mfma_f32_32x32x16_bf16 v[28:43], v[188:191], v[220:223], v[28:43]
    v_mfma_f32_32x32x16_bf16 v[44:59], v[192:195], v[220:223], v[44:59]
    s_waitcnt lgkmcnt(4)
    v_mfma_f32_32x32x16_bf16 v[12:27], v[196:199], v[232:235], v[12:27]
    v_mfma_f32_32x32x16_bf16 v[28:43], v[200:203], v[232:235], v[28:43]
    v_mfma_f32_32x32x16_bf16 v[44:59], v[204:207], v[232:235], v[44:59]
    s_waitcnt lgkmcnt(3)
    v_mfma_f32_32x32x16_bf16 v[60:75], v[184:187], v[224:227], v[60:75]
    s_nop 7
    v_cvt_pk_bf16_f32 v12, v12, v13
    v_cvt_pk_bf16_f32 v13, v14, v15
    v_cvt_pk_bf16_f32 v14, v16, v17
    v_cvt_pk_bf16_f32 v15, v18, v19
    v_mfma_f32_32x32x16_bf16 v[76:91], v[188:191], v[224:227], v[76:91]
    ds_write_b128 v7, v[12:15] offset:0
    v_cvt_pk_bf16_f32 v20, v20, v21
    v_cvt_pk_bf16_f32 v21, v22, v23
    v_cvt_pk_bf16_f32 v22, v24, v25
    v_cvt_pk_bf16_f32 v23, v26, v27
    v_mfma_f32_32x32x16_bf16 v[92:107], v[192:195], v[224:227], v[92:107]
    ds_write_b128 v7, v[20:23] offset:32
    v_cvt_pk_bf16_f32 v28, v28, v29
    v_cvt_pk_bf16_f32 v29, v30, v31
    v_cvt_pk_bf16_f32 v30, v32, v33
    v_cvt_pk_bf16_f32 v31, v34, v35
    s_waitcnt lgkmcnt(4)
    v_mfma_f32_32x32x16_bf16 v[60:75], v[196:199], v[236:239], v[60:75]
    ds_write_b128 v7, v[28:31] offset:64
    v_cvt_pk_bf16_f32 v36, v36, v37
    v_cvt_pk_bf16_f32 v37, v38, v39
    v_cvt_pk_bf16_f32 v38, v40, v41
    v_cvt_pk_bf16_f32 v39, v42, v43
    v_mfma_f32_32x32x16_bf16 v[76:91], v[200:203], v[236:239], v[76:91]
    ds_write_b128 v7, v[36:39] offset:96
    v_cvt_pk_bf16_f32 v44, v44, v45
    v_cvt_pk_bf16_f32 v45, v46, v47
    v_cvt_pk_bf16_f32 v46, v48, v49
    v_cvt_pk_bf16_f32 v47, v50, v51
    v_mfma_f32_32x32x16_bf16 v[92:107], v[204:207], v[236:239], v[92:107]
    ds_write_b128 v7, v[44:47] offset:128
    v_cvt_pk_bf16_f32 v52, v52, v53
    v_cvt_pk_bf16_f32 v53, v54, v55
    v_cvt_pk_bf16_f32 v54, v56, v57
    v_cvt_pk_bf16_f32 v55, v58, v59
    ds_write_b128 v7, v[52:55] offset:160
    ds_read_b128 v[16:19], v108 offset:0
    ds_read_b128 v[24:27], v109 offset:0
    ds_read_b128 v[32:35], v110 offset:0
    ds_read_b128 v[40:43], v108 offset:3328
    ds_read_b128 v[48:51], v109 offset:3328
    ds_read_b128 v[56:59], v110 offset:3328
    s_waitcnt lgkmcnt(13)
    v_mfma_f32_32x32x16_bf16 v[124:139], v[184:187], v[228:231], v[124:139]
    s_waitcnt lgkmcnt(5)
    buffer_store_dwordx4 v[16:19], v111, s[36:39], s26 offen sc0 sc1
    v_cvt_pk_bf16_f32 v60, v60, v61
    v_cvt_pk_bf16_f32 v61, v62, v63
    v_cvt_pk_bf16_f32 v62, v64, v65
    v_cvt_pk_bf16_f32 v63, v66, v67
    v_mfma_f32_32x32x16_bf16 v[140:155], v[188:191], v[228:231], v[140:155]
    ds_write_b128 v7, v[60:63] offset:6656
    s_waitcnt lgkmcnt(5)
    buffer_store_dwordx4 v[24:27], v112, s[36:39], s26 offen sc0 sc1
    v_cvt_pk_bf16_f32 v68, v68, v69
    v_cvt_pk_bf16_f32 v69, v70, v71
    v_cvt_pk_bf16_f32 v70, v72, v73
    v_cvt_pk_bf16_f32 v71, v74, v75
    v_mfma_f32_32x32x16_bf16 v[156:171], v[192:195], v[228:231], v[156:171]
    ds_write_b128 v7, v[68:71] offset:6688
    s_waitcnt lgkmcnt(5)
    buffer_store_dwordx4 v[32:35], v113, s[36:39], s26 offen sc0 sc1
    v_cvt_pk_bf16_f32 v76, v76, v77
    v_cvt_pk_bf16_f32 v77, v78, v79
    v_cvt_pk_bf16_f32 v78, v80, v81
    v_cvt_pk_bf16_f32 v79, v82, v83
    s_waitcnt lgkmcnt(14)
    v_mfma_f32_32x32x16_bf16 v[124:139], v[196:199], v[240:243], v[124:139]
    ds_write_b128 v7, v[76:79] offset:6720
    s_waitcnt lgkmcnt(5)
    buffer_store_dwordx4 v[40:43], v111, s[36:39], s27 offen sc0 sc1
    v_cvt_pk_bf16_f32 v84, v84, v85
    v_cvt_pk_bf16_f32 v85, v86, v87
    v_cvt_pk_bf16_f32 v86, v88, v89
    v_cvt_pk_bf16_f32 v87, v90, v91
    v_mfma_f32_32x32x16_bf16 v[140:155], v[200:203], v[240:243], v[140:155]
    ds_write_b128 v7, v[84:87] offset:6752
    s_waitcnt lgkmcnt(5)
    buffer_store_dwordx4 v[48:51], v112, s[36:39], s27 offen sc0 sc1
    v_cvt_pk_bf16_f32 v92, v92, v93
    v_cvt_pk_bf16_f32 v93, v94, v95
    v_cvt_pk_bf16_f32 v94, v96, v97
    v_cvt_pk_bf16_f32 v95, v98, v99
    v_mfma_f32_32x32x16_bf16 v[156:171], v[204:207], v[240:243], v[156:171]
    ds_write_b128 v7, v[92:95] offset:6784
    s_waitcnt lgkmcnt(5)
    buffer_store_dwordx4 v[56:59], v113, s[36:39], s27 offen sc0 sc1
    v_cvt_pk_bf16_f32 v100, v100, v101
    v_cvt_pk_bf16_f32 v101, v102, v103
    v_cvt_pk_bf16_f32 v102, v104, v105
    v_cvt_pk_bf16_f32 v103, v106, v107
    s_add_u32 s26, s26, 344064
    s_add_u32 s27, s27, 344064
    ds_write_b128 v7, v[100:103] offset:6816
    ds_read_b128 v[64:67], v108 offset:6656
    ds_read_b128 v[72:75], v109 offset:6656
    ds_read_b128 v[80:83], v110 offset:6656
    ds_read_b128 v[88:91], v108 offset:9984
    ds_read_b128 v[96:99], v109 offset:9984
    ds_read_b128 v[104:107], v110 offset:9984
    v_cvt_pk_bf16_f32 v124, v124, v125
    v_cvt_pk_bf16_f32 v125, v126, v127
    v_cvt_pk_bf16_f32 v126, v128, v129
    v_cvt_pk_bf16_f32 v127, v130, v131
    ds_write_b128 v7, v[124:127] offset:13312
    s_waitcnt lgkmcnt(6)
    buffer_store_dwordx4 v[64:67], v111, s[36:39], s26 offen sc0 sc1
    v_cvt_pk_bf16_f32 v132, v132, v133
    v_cvt_pk_bf16_f32 v133, v134, v135
    v_cvt_pk_bf16_f32 v134, v136, v137
    v_cvt_pk_bf16_f32 v135, v138, v139
    ds_write_b128 v7, v[132:135] offset:13344
    s_waitcnt lgkmcnt(6)
    buffer_store_dwordx4 v[72:75], v112, s[36:39], s26 offen sc0 sc1
    v_cvt_pk_bf16_f32 v140, v140, v141
    v_cvt_pk_bf16_f32 v141, v142, v143
    v_cvt_pk_bf16_f32 v142, v144, v145
    v_cvt_pk_bf16_f32 v143, v146, v147
    ds_write_b128 v7, v[140:143] offset:13376
    s_waitcnt lgkmcnt(6)
    buffer_store_dwordx4 v[80:83], v113, s[36:39], s26 offen sc0 sc1
    v_cvt_pk_bf16_f32 v148, v148, v149
    v_cvt_pk_bf16_f32 v149, v150, v151
    v_cvt_pk_bf16_f32 v150, v152, v153
    v_cvt_pk_bf16_f32 v151, v154, v155
    ds_write_b128 v7, v[148:151] offset:13408
    s_waitcnt lgkmcnt(6)
    buffer_store_dwordx4 v[88:91], v111, s[36:39], s27 offen sc0 sc1
    v_cvt_pk_bf16_f32 v156, v156, v157
    v_cvt_pk_bf16_f32 v157, v158, v159
    v_cvt_pk_bf16_f32 v158, v160, v161
    v_cvt_pk_bf16_f32 v159, v162, v163
    ds_write_b128 v7, v[156:159] offset:13440
    s_waitcnt lgkmcnt(6)
    buffer_store_dwordx4 v[96:99], v112, s[36:39], s27 offen sc0 sc1
    v_cvt_pk_bf16_f32 v164, v164, v165
    v_cvt_pk_bf16_f32 v165, v166, v167
    v_cvt_pk_bf16_f32 v166, v168, v169
    v_cvt_pk_bf16_f32 v167, v170, v171
    ds_write_b128 v7, v[164:167] offset:13472
    s_waitcnt lgkmcnt(6)
    buffer_store_dwordx4 v[104:107], v113, s[36:39], s27 offen sc0 sc1
    s_add_u32 s26, s26, 344064
    s_add_u32 s27, s27, 344064
    ds_read_b128 v[128:131], v108 offset:13312
    ds_read_b128 v[136:139], v109 offset:13312
    ds_read_b128 v[144:147], v110 offset:13312
    ds_read_b128 v[152:155], v108 offset:16640
    ds_read_b128 v[160:163], v109 offset:16640
    ds_read_b128 v[168:171], v110 offset:16640
    s_waitcnt lgkmcnt(5)
    buffer_store_dwordx4 v[128:131], v111, s[36:39], s26 offen nt
    s_waitcnt lgkmcnt(4)
    buffer_store_dwordx4 v[136:139], v112, s[36:39], s26 offen nt
    s_waitcnt lgkmcnt(3)
    buffer_store_dwordx4 v[144:147], v113, s[36:39], s26 offen nt
    s_waitcnt lgkmcnt(2)
    buffer_store_dwordx4 v[152:155], v111, s[36:39], s27 offen nt
    s_waitcnt lgkmcnt(1)
    buffer_store_dwordx4 v[160:163], v112, s[36:39], s27 offen nt
    s_waitcnt lgkmcnt(0)
    buffer_store_dwordx4 v[168:171], v113, s[36:39], s27 offen nt
    s_add_u32 s26, s26, 344064
    s_add_u32 s27, s27, 344064
L_Qepi:
L_end:
    s_endpgm
L_code_end:
.section .rodata,"a"
.p2align 6
.amdhsa_kernel standalone__modern_conv_block_replknet__vision_kernel
  .amdhsa_next_free_vgpr 256
  .amdhsa_next_free_sgpr 102
  .amdhsa_accum_offset 256
  .amdhsa_group_segment_fixed_size 0
  .amdhsa_kernarg_size 64
  .amdhsa_user_sgpr_count 2
  .amdhsa_user_sgpr_kernarg_segment_ptr 1
  .amdhsa_system_sgpr_workgroup_id_x 1
  .amdhsa_float_denorm_mode_32 3
  .amdhsa_float_denorm_mode_16_64 3
.end_amdhsa_kernel
```
